```python
import torch

def _softmax(x, axis=-1):
    return torch.softmax(x, dim=axis)
def _gelu(x):
    return torch.nn.functional.gelu(x, approximate="tanh")
def _silu(x):
    return torch.nn.functional.silu(x)
def _sigmoid(x):
    return torch.sigmoid(x)
def _layernorm(x, axis=-1, eps=1e-5):
    m = x.mean(dim=axis, keepdim=True)
    v = x.var(dim=axis, keepdim=True, unbiased=False)
    return (x - m) / torch.sqrt(v + eps)
def _scatter_add(tgt, idx, src, axis=0):
    return tgt.clone().index_add_(axis, idx, src)
def _segment_sum(src, seg, n):
    out = torch.zeros((n,) + src.shape[1:], dtype=src.dtype)
    return out.index_add_(0, seg, src)
def _pad(x, pw):
    flat = tuple(v for pair in reversed(pw) for v in pair)
    return torch.nn.functional.pad(x, flat)

kernel_name = 'recurrent_scan__linear_attn_block__glu_gated_reglu__prompt'

def setup_inputs():

    _w = (lambda a: (lambda t: t.to(torch.bfloat16) if t.is_floating_point() else t)(torch.as_tensor(a)))
    def _A_setup():
        B, S, D = 1, 2048, 640
        return {
            "x": _w((lambda *s: torch.randn(*s, dtype=torch.bfloat16) * 0.05)(B, S, D)),
            "wqkv": _w((lambda *s: torch.randn(*s, dtype=torch.bfloat16) * 0.8)(D, 3 * D)),
            "wo": _w((lambda *s: torch.randn(*s, dtype=torch.bfloat16) * 0.8)(D, D)),
        }
    _A_in = _A_setup()

    def _B_setup():
        B, S, D, F = 1, 2048, 640, 1728
        return {
            "x": _w((lambda *s: torch.randn(*s, dtype=torch.bfloat16) * 0.05)(B, S, D)),
            "W_gate": _w((lambda *s: torch.randn(*s, dtype=torch.bfloat16) * 0.2)(D, F) * (2.0 / D) ** 0.5),
            "W_up": _w((lambda *s: torch.randn(*s, dtype=torch.bfloat16) * 0.2)(D, F) * (2.0 / D) ** 0.5),
            "W_down": _w((lambda *s: torch.randn(*s, dtype=torch.bfloat16) * 0.2)(F, D) * (1.0 / F) ** 0.5),
        }
    _B_in = _B_setup()

    return {
        "A_x": _A_in["x"],
        "A_wqkv": _A_in["wqkv"],
        "A_wo": _A_in["wo"],
        "B_x": _B_in["x"],
        "B_W_gate": _B_in["W_gate"],
        "B_W_up": _B_in["W_up"],
        "B_W_down": _B_in["W_down"],
    }

def reference(A_x, A_wqkv, A_wo, B_x, B_W_gate, B_W_up, B_W_down):
    def _A_ref(x, wqkv, wo):
        B, S, D = x.shape
        H = 32; Dh = D // H
        qkv = (lambda x, *d: x.permute(*d))((x @ wqkv).reshape(B, S, 3, H, Dh), 2, 0, 3, 1, 4)
        q, k, v = qkv[0], qkv[1], qkv[2]
        phi = lambda t: torch.where(t > 0, t + 1, torch.exp(t)) + 1e-6
        pq, pk = phi(q), phi(k)
        kv = torch.einsum("bhsd,bhse->bhde", pk, v)
        z = torch.einsum("bhsd->bhd", pk)
        num = torch.einsum("bhqd,bhde->bhqe", pq, kv)
        den = torch.einsum("bhqd,bhd->bhq", pq, z)[..., None] + 1e-6
        o = num / den
        return (lambda x, *d: x.permute(*d))(o, 0, 2, 1, 3).reshape(B, S, D) @ wo

    def _B_ref(x, W_gate, W_up, W_down):
        gate = torch.einsum("bsd,df->bsf", x, W_gate)
        up = torch.einsum("bsd,df->bsf", x, W_up)
        gate = gate * (lambda x, dt: x.to(dt))(gate > 0, gate.dtype)
        h = gate * up
        return torch.einsum("bsf,fd->bsd", h, W_down)

    x = A_x
    xn = _layernorm(x, axis=-1)
    s = _A_ref(xn, A_wqkv, A_wo)
    g = _silu(_B_ref(xn, B_W_gate, B_W_up, B_W_down))
    return x + s * g
```

```asm
; @launch grid=(256,1,1) block=(512,1,1) lds=162304
.amdgcn_target "amdgcn-amd-amdhsa--gfx950"
.text
.globl recurrent_scan__linear_attn_block__glu_gated_reglu__prompt_kernel
.p2align 8
.type recurrent_scan__linear_attn_block__glu_gated_reglu__prompt_kernel,@function
recurrent_scan__linear_attn_block__glu_gated_reglu__prompt_kernel:
    s_cmp_ge_u32 s2, 256
    s_cbranch_scc1 L_k1_exit
    s_memrealtime s[76:77]
    s_load_dwordx16 s[20:35], s[0:1], 0
    s_load_dwordx4 s[36:39], s[0:1], 64
    v_lshrrev_b32 v2, 6, v0
    v_and_b32 v1, 63, v0
    v_readfirstlane_b32 s40, v2
    s_and_b32 s60, s2, 7
    s_lshr_b32 s61, s2, 3
    s_and_b32 s62, s60, 1
    s_lshl_b32 s62, s62, 3
    s_and_b32 s41, s61, 7
    s_add_u32 s41, s41, s62
    s_lshr_b32 s60, s60, 1
    s_lshl_b32 s60, s60, 2
    s_lshr_b32 s42, s61, 3
    s_add_u32 s42, s42, s60
    s_lshr_b32 s45, s40, 2
    s_and_b32 s46, s40, 3
    s_mov_b32 s83, 0
    s_and_b32 s60, s2, 4
    s_lshr_b32 s61, s2, 6
    s_add_u32 s60, s60, s61
    s_lshl_b32 s16, s40, 10
    s_lshl_b32 s17, s45, 10
    s_add_u32 s17, s17, 8192
    s_sub_u32 s18, s17, s16
    s_cmp_eq_u32 s46, 0
    s_cselect_b32 s19, 1, 0
    s_mul_i32 s3, s60, 378880
    s_add_u32 s3, s3, 10485760
    s_add_u32 s3, s3, s16
    s_mov_b32 s59, 0
    s_cmp_eq_u32 s42, 15
    s_cbranch_scc1 L_helper
    s_cmp_ge_u32 s42, 9
    s_cbranch_scc1 L_k1_notgu
    s_mov_b32 s47, s42
    s_mov_b32 s43, 3456
    s_mul_i32 s44, s47, 384
    s_mov_b32 s69, s45
    s_branch L_k1_par
L_k1_notgu:
    s_mov_b32 s43, 3840
    s_mov_b32 s69, 2
    s_cmp_ge_u32 s42, 13
    s_cbranch_scc1 L_k1_q
    s_sub_u32 s47, s42, 9
    s_mul_i32 s44, s47, 320
    s_mul_i32 s60, s45, 1280
    s_add_u32 s44, s44, s60
    s_add_u32 s44, s44, 1280
    s_and_b32 s44, s44, 0xffffff80
    s_branch L_k1_par
L_k1_q:
    s_sub_u32 s47, s42, 13
    s_mul_i32 s44, s47, 640
    s_mul_i32 s60, s45, 384
    s_add_u32 s44, s44, s60
L_k1_par:
    v_lshrrev_b32 v2, 3, v1
    v_and_b32 v3, 7, v1
    v_xor_b32 v3, v3, v2
    s_lshl_b32 s60, s41, 7
    s_lshl_b32 s61, s40, 4
    s_add_u32 s60, s60, s61
    v_add_u32 v2, s60, v2
    v_mul_u32_u24 v2, 1280, v2
    v_lshl_add_u32 v10, v3, 4, v2
    s_mul_i32 s60, s46, 192
    v_add_u32 v2, s60, v1
    v_mul_u32_u24 v3, 2731, v2
    v_lshrrev_b32 v3, 16, v3
    v_mul_u32_u24 v4, 24, v3
    v_sub_u32 v4, v2, v4
    v_bfe_u32 v5, v3, 1, 1
    v_bfe_u32 v6, v3, 3, 1
    v_lshl_or_b32 v5, v6, 1, v5
    v_lshlrev_b32 v5, 1, v5
    v_xor_b32 v4, v4, v5
    v_mul_lo_u32 v3, v3, s43
    v_lshl_add_u32 v3, v4, 4, v3
    v_add_u32 v11, s44, v3
    v_add_u32 v2, s60, v1
    v_add_u32 v2, 64, v2
    v_mul_u32_u24 v3, 2731, v2
    v_lshrrev_b32 v3, 16, v3
    v_mul_u32_u24 v4, 24, v3
    v_sub_u32 v4, v2, v4
    v_bfe_u32 v5, v3, 1, 1
    v_bfe_u32 v6, v3, 3, 1
    v_lshl_or_b32 v5, v6, 1, v5
    v_lshlrev_b32 v5, 1, v5
    v_xor_b32 v4, v4, v5
    v_mul_lo_u32 v3, v3, s43
    v_lshl_add_u32 v3, v4, 4, v3
    v_add_u32 v12, s44, v3
    v_add_u32 v2, s60, v1
    v_add_u32 v2, 128, v2
    v_mul_u32_u24 v3, 2731, v2
    v_lshrrev_b32 v3, 16, v3
    v_mul_u32_u24 v4, 24, v3
    v_sub_u32 v4, v2, v4
    v_bfe_u32 v5, v3, 1, 1
    v_bfe_u32 v6, v3, 3, 1
    v_lshl_or_b32 v5, v6, 1, v5
    v_lshlrev_b32 v5, 1, v5
    v_xor_b32 v4, v4, v5
    v_mul_lo_u32 v3, v3, s43
    v_lshl_add_u32 v3, v4, 4, v3
    v_add_u32 v13, s44, v3
    s_lshl_b32 s55, s43, 5
    s_mul_i32 s48, s45, 12288
    s_mul_i32 s60, s46, 3072
    s_add_u32 s48, s48, s60
    s_add_u32 s48, s48, 49152
    s_mov_b32 s58, s48
    s_lshl_b32 s51, s40, 11
    s_mov_b32 s57, s51
    s_mov_b32 s53, 0
    s_mov_b32 s50, 0
    s_lshl_b32 s70, s43, 1
    s_add_u32 s71, s70, s43
    s_lshl_b32 s72, s43, 2
    s_mul_i32 s10, s43, 640
    s_mov_b32 s68, 0x358637bd
    s_mov_b32 s73, 0xffff0000
    s_waitcnt lgkmcnt(0)
    s_mov_b32 s4, s20
    s_and_b32 s5, s21, 0xffff
    s_mov_b32 s6, 0x280000
    s_mov_b32 s7, 0x20000
    s_cmp_eq_u32 s69, 0
    s_cselect_b32 s8, s28, s30
    s_cselect_b32 s9, s29, s31
    s_cmp_eq_u32 s69, 2
    s_cselect_b32 s8, s22, s8
    s_cselect_b32 s9, s23, s9
    s_and_b32 s9, s9, 0xffff
    s_mov_b32 s11, 0x20000
    s_add_u32 m0, s51, 0
    s_add_u32 s56, s53, 10240
    buffer_load_dwordx4 v10, s[4:7], s53 offen lds
    s_add_u32 m0, s51, 1024
    s_add_u32 s53, s53, 128
    buffer_load_dwordx4 v10, s[4:7], s56 offen lds
    s_cmp_ge_u32 s53, 1280
    s_cselect_b32 s53, 0, s53
    s_add_u32 m0, s48, 0
    s_nop 0
    buffer_load_dwordx4 v11, s[8:11], s50 offen lds
    s_add_u32 m0, s48, 1024
    s_nop 0
    buffer_load_dwordx4 v12, s[8:11], s50 offen lds
    s_add_u32 m0, s48, 2048
    s_nop 0
    buffer_load_dwordx4 v13, s[8:11], s50 offen lds
    s_add_u32 s50, s50, s55
    s_cmp_ge_u32 s50, s10
    s_cselect_b32 s50, 0, s50
    s_barrier
    s_add_u32 m0, s48, 24576
    s_nop 0
    buffer_load_dwordx4 v11, s[8:11], s50 offen lds
    s_add_u32 m0, s48, 25600
    s_nop 0
    buffer_load_dwordx4 v12, s[8:11], s50 offen lds
    s_add_u32 m0, s48, 26624
    s_nop 0
    buffer_load_dwordx4 v13, s[8:11], s50 offen lds
    s_add_u32 s50, s50, s55
    s_cmp_ge_u32 s50, s10
    s_cselect_b32 s50, 0, s50
    s_add_u32 m0, s51, 16384
    s_add_u32 s56, s53, 10240
    buffer_load_dwordx4 v10, s[4:7], s53 offen lds
    s_add_u32 m0, s51, 17408
    s_add_u32 s53, s53, 128
    buffer_load_dwordx4 v10, s[4:7], s56 offen lds
    s_cmp_ge_u32 s53, 1280
    s_cselect_b32 s53, 0, s53
    s_add_u32 m0, s48, 49152
    s_nop 0
    buffer_load_dwordx4 v11, s[8:11], s50 offen lds
    s_add_u32 m0, s48, 50176
    s_nop 0
    buffer_load_dwordx4 v12, s[8:11], s50 offen lds
    s_add_u32 m0, s48, 51200
    s_nop 0
    buffer_load_dwordx4 v13, s[8:11], s50 offen lds
    s_add_u32 s50, s50, s55
    s_cmp_ge_u32 s50, s10
    s_cselect_b32 s50, 0, s50
    s_mov_b32 s12, s38
    s_and_b32 s13, s39, 0xffff
    s_mov_b32 s14, 0x1100000
    s_mov_b32 s15, 0x20000
    v_cmp_le_u32 vcc, 24, v1
    s_nop 1
    v_cndmask_b32 v2, 0, 1, vcc
    v_mul_u32_u24 v3, 24, v2
    v_sub_u32 v3, v1, v3
    s_lshl_b32 s60, s46, 1
    v_add_u32 v2, s60, v2
    v_and_b32 v4, 1, v2
    s_lshl_b32 s60, s46, 5
    s_lshl_b32 s61, s41, 1
    s_add_u32 s60, s60, s61
    v_add_u32 v4, s60, v4
    v_mul_lo_u32 v4, v4, s43
    v_lshl_add_u32 v4, v3, 4, v4
    v_add_u32 v27, s44, v4
    v_mul_u32_u24 v4, 1536, v2
    v_lshl_add_u32 v4, v3, 5, v4
    s_mul_i32 s60, s45, 768
    s_add_u32 s60, s60, 147456
    v_add_u32 v28, s60, v4
    v_and_b32 v2, 15, v1
    v_lshrrev_b32 v3, 4, v1
    v_and_b32 v4, 7, v1
    v_xor_b32 v4, v4, v3
    s_lshl_b32 s60, s45, 13
    v_lshlrev_b32 v5, 7, v2
    v_add_u32 v5, s60, v5
    v_lshl_add_u32 v14, v4, 4, v5
    v_xor_b32 v15, 64, v14
    v_bfe_u32 v4, v1, 2, 2
    v_lshl_add_u32 v5, v3, 3, v4
    v_mul_u32_u24 v5, 384, v5
    v_add_u32 v5, 49152, v5
    v_lshrrev_b32 v6, 1, v4
    v_and_b32 v7, 1, v3
    v_lshl_or_b32 v6, v7, 1, v6
    v_mov_b32 v7, 12288
    v_and_b32 v8, 3, v1
    v_mov_b32 v9, v3
    v_mul_u32_u24 v2, 683, v0
    v_lshrrev_b32 v2, 16, v2
    v_mul_u32_u24 v3, 96, v2
    v_sub_u32 v3, v0, v3
    v_mul_u32_u24 v4, 6144, v2
    v_lshl_add_u32 v4, v3, 4, v4
    s_mul_i32 s60, s42, 24576
    s_add_u32 s60, s60, 14680064
    v_add_u32 v29, s60, v4
    v_mov_b32 v39, v29
    v_mul_u32_u24 v4, 1536, v2
    v_lshl_add_u32 v4, v3, 4, v4
    v_add_u32 v30, 147456, v4
    s_cmp_lt_u32 s40, 6
    s_cbranch_scc1 L_k1_c1
    v_mov_b32 v39, 0x7ff00000
    v_subrev_u32 v2, 384, v0
    s_lshl_b32 s60, s41, 10
    s_add_u32 s60, s60, 15204352
    v_lshlrev_b32 v3, 3, v2
    v_add_u32 v29, s60, v3
    v_lshlrev_b32 v3, 2, v2
    v_add_u32 v30, 161280, v3
L_k1_c1:
    s_mov_b32 s67, 4608
    s_lshl_b32 s60, s41, 3
    s_add_u32 s60, s60, 16910336
    s_lshl_b32 s61, s42, 7
    s_add_u32 s61, s61, 16908288
    v_lshl_add_u32 v37, v1, 3, s61
    s_mov_b32 s61, 16922752
    v_lshl_add_u32 v2, v1, 3, s61
    v_cmp_le_u32 vcc, 16, v1
    s_nop 1
    v_cndmask_b32 v37, v37, v2, vcc
    v_lshlrev_b32 v21, 4, v1
    s_lshr_b32 s64, s2, 5
    s_add_u32 s64, s64, 2
    s_cmp_eq_u32 s40, 7
    s_cselect_b32 s64, s64, 99
    s_sub_u32 s76, s76, 200
    s_subb_u32 s77, s77, 0
    s_cmp_ge_u32 s42, 13
    s_cbranch_scc1 L_Q
    s_cmp_ge_u32 s42, 9
    s_cbranch_scc1 L_KV
    s_and_b32 s60, s46, 1
    s_mul_i32 s61, s46, 96
    s_add_u32 s62, s60, 0
    s_cmp_ge_u32 s62, 3
    s_cselect_b32 s62, 0, s62
    s_lshl_b32 s62, s62, 5
    s_add_u32 s62, s62, s61
    v_lshl_add_u32 v2, v8, 3, s62
    v_cmp_le_u32 vcc, 384, v2
    v_subrev_u32 v3, 384, v2
    s_nop 0
    v_cndmask_b32 v3, v2, v3, vcc
    v_cndmask_b32 v4, 0, v7, vcc
    v_lshrrev_b32 v16, 5, v3
    v_xor_b32 v16, v16, v6
    v_lshlrev_b32 v16, 5, v16
    v_and_b32 v3, 31, v3
    v_add3_u32 v16, v16, v3, v5
    v_add_u32 v16, v16, v4
    v_lshl_add_u32 v2, v9, 3, s62
    v_lshlrev_b32 v2, 1, v2
    v_add_u32 v31, 159744, v2
    s_add_u32 s62, s60, 1
    s_cmp_ge_u32 s62, 3
    s_cselect_b32 s62, 0, s62
    s_lshl_b32 s62, s62, 5
    s_add_u32 s62, s62, s61
    v_lshl_add_u32 v2, v8, 3, s62
    v_cmp_le_u32 vcc, 384, v2
    v_subrev_u32 v3, 384, v2
    s_nop 0
    v_cndmask_b32 v3, v2, v3, vcc
    v_cndmask_b32 v4, 0, v7, vcc
    v_lshrrev_b32 v17, 5, v3
    v_xor_b32 v17, v17, v6
    v_lshlrev_b32 v17, 5, v17
    v_and_b32 v3, 31, v3
    v_add3_u32 v17, v17, v3, v5
    v_add_u32 v17, v17, v4
    v_lshl_add_u32 v2, v9, 3, s62
    v_lshlrev_b32 v2, 1, v2
    v_add_u32 v32, 159744, v2
    s_add_u32 s62, s60, 2
    s_cmp_ge_u32 s62, 3
    s_cselect_b32 s62, 0, s62
    s_lshl_b32 s62, s62, 5
    s_add_u32 s62, s62, s61
    v_lshl_add_u32 v2, v8, 3, s62
    v_cmp_le_u32 vcc, 384, v2
    v_subrev_u32 v3, 384, v2
    s_nop 0
    v_cndmask_b32 v3, v2, v3, vcc
    v_cndmask_b32 v4, 0, v7, vcc
    v_lshrrev_b32 v18, 5, v3
    v_xor_b32 v18, v18, v6
    v_lshlrev_b32 v18, 5, v18
    v_and_b32 v3, 31, v3
    v_add3_u32 v18, v18, v3, v5
    v_add_u32 v18, v18, v4
    v_lshl_add_u32 v2, v9, 3, s62
    v_lshlrev_b32 v2, 1, v2
    v_add_u32 v33, 159744, v2
    v_add_u32 v22, 49152, v16
    v_add_u32 v23, 49152, v17
    v_add_u32 v24, 49152, v18
    v_add_u32 v25, 49152, v19
    v_add_u32 v26, 49152, v20
    s_waitcnt vmcnt(8)
    s_barrier
    ds_read_b128 v[48:51], v14 offset:0
    ds_read_b128 v[52:55], v14 offset:2048
    ds_read_b128 v[56:59], v14 offset:4096
    ds_read_b128 v[60:63], v14 offset:6144
    ds_read_b64_tr_b16 v[64:65], v16 offset:0
    ds_read_b64_tr_b16 v[66:67], v16 offset:1536
    ds_read_b64_tr_b16 v[68:69], v17 offset:0
    ds_read_b64_tr_b16 v[70:71], v17 offset:1536
    ds_read_b64_tr_b16 v[72:73], v18 offset:0
    ds_read_b64_tr_b16 v[74:75], v18 offset:1536
    ds_read_b64_tr_b16 v[76:77], v16 offset:12288
    ds_read_b64_tr_b16 v[78:79], v16 offset:13824
    ds_read_b64_tr_b16 v[80:81], v17 offset:12288
    ds_read_b64_tr_b16 v[82:83], v17 offset:13824
    ds_read_b64_tr_b16 v[84:85], v18 offset:12288
    ds_read_b64_tr_b16 v[86:87], v18 offset:13824
    s_add_u32 m0, s58, 73728
    s_nop 0
    buffer_load_dwordx4 v11, s[8:11], s50 offen lds
    s_add_u32 m0, s58, 74752
    s_nop 0
    buffer_load_dwordx4 v12, s[8:11], s50 offen lds
    s_add_u32 m0, s58, 75776
    s_nop 0
    buffer_load_dwordx4 v13, s[8:11], s50 offen lds
    s_add_u32 s50, s50, s55
    s_lshl_b32 s71, s43, 7
    s_mov_b32 s70, s71
    s_mov_b32 exec_hi, 0xffff
    buffer_load_dwordx4 v[228:231], v27, s[8:11], s70 offen
    s_mov_b64 exec, -1
    s_waitcnt vmcnt(9) lgkmcnt(0)
    s_barrier
    v_mfma_f32_16x16x32_bf16 v[128:131], v[64:67], v[48:51], 0
    ds_read_b128 v[88:91], v15 offset:0
    s_add_u32 m0, s57, 32768
    s_movk_i32 s53, 256
    v_mfma_f32_16x16x32_bf16 v[152:155], v[64:67], v[52:55], 0
    ds_read_b128 v[92:95], v15 offset:2048
    buffer_load_dwordx4 v10, s[4:7], s53 offen lds
    v_mfma_f32_16x16x32_bf16 v[176:179], v[64:67], v[56:59], 0
    ds_read_b128 v[96:99], v15 offset:4096
    s_add_u32 m0, s57, 33792
    s_movk_i32 s56, 10496
    v_mfma_f32_16x16x32_bf16 v[200:203], v[64:67], v[60:63], 0
    ds_read_b128 v[100:103], v15 offset:6144
    buffer_load_dwordx4 v10, s[4:7], s56 offen lds
    v_mfma_f32_16x16x32_bf16 v[132:135], v[68:71], v[48:51], 0
    ds_read_b64_tr_b16 v[104:105], v16 offset:24576
    s_add_u32 m0, s58, 0
    v_mfma_f32_16x16x32_bf16 v[156:159], v[68:71], v[52:55], 0
    ds_read_b64_tr_b16 v[106:107], v16 offset:26112
    buffer_load_dwordx4 v11, s[8:11], s50 offen lds
    v_mfma_f32_16x16x32_bf16 v[180:183], v[68:71], v[56:59], 0
    ds_read_b64_tr_b16 v[108:109], v17 offset:24576
    s_add_u32 m0, s58, 1024
    v_mfma_f32_16x16x32_bf16 v[204:207], v[68:71], v[60:63], 0
    ds_read_b64_tr_b16 v[110:111], v17 offset:26112
    buffer_load_dwordx4 v12, s[8:11], s50 offen lds
    v_mfma_f32_16x16x32_bf16 v[136:139], v[72:75], v[48:51], 0
    ds_read_b64_tr_b16 v[112:113], v18 offset:24576
    s_add_u32 m0, s58, 2048
    v_mfma_f32_16x16x32_bf16 v[160:163], v[72:75], v[52:55], 0
    ds_read_b64_tr_b16 v[114:115], v18 offset:26112
    buffer_load_dwordx4 v13, s[8:11], s50 offen lds
    s_add_u32 s50, s50, s55
    v_mfma_f32_16x16x32_bf16 v[184:187], v[72:75], v[56:59], 0
    ds_read_b64_tr_b16 v[116:117], v16 offset:36864
    v_mfma_f32_16x16x32_bf16 v[208:211], v[72:75], v[60:63], 0
    ds_read_b64_tr_b16 v[118:119], v16 offset:38400
    v_mfma_f32_16x16x32_bf16 v[140:143], v[76:79], v[48:51], 0
    ds_read_b64_tr_b16 v[120:121], v17 offset:36864
    v_mfma_f32_16x16x32_bf16 v[164:167], v[76:79], v[52:55], 0
    ds_read_b64_tr_b16 v[122:123], v17 offset:38400
    v_mfma_f32_16x16x32_bf16 v[188:191], v[76:79], v[56:59], 0
    ds_read_b64_tr_b16 v[124:125], v18 offset:36864
    v_mfma_f32_16x16x32_bf16 v[212:215], v[76:79], v[60:63], 0
    ds_read_b64_tr_b16 v[126:127], v18 offset:38400
    v_mfma_f32_16x16x32_bf16 v[144:147], v[80:83], v[48:51], 0
    v_mfma_f32_16x16x32_bf16 v[168:171], v[80:83], v[52:55], 0
    v_mfma_f32_16x16x32_bf16 v[192:195], v[80:83], v[56:59], 0
    v_mfma_f32_16x16x32_bf16 v[216:219], v[80:83], v[60:63], 0
    v_mfma_f32_16x16x32_bf16 v[148:151], v[84:87], v[48:51], 0
    v_mfma_f32_16x16x32_bf16 v[172:175], v[84:87], v[52:55], 0
    v_mfma_f32_16x16x32_bf16 v[196:199], v[84:87], v[56:59], 0
    v_mfma_f32_16x16x32_bf16 v[220:223], v[84:87], v[60:63], 0
    s_add_u32 s70, s70, s71
    s_mov_b32 exec_hi, 0xffff
    buffer_load_dwordx4 v[232:235], v27, s[8:11], s70 offen
    s_mov_b64 exec, -1
    s_waitcnt vmcnt(10) lgkmcnt(0)
    s_barrier
    v_mfma_f32_16x16x32_bf16 v[128:131], v[104:107], v[88:91], v[128:131]
    ds_read_b128 v[48:51], v14 offset:16384
    v_mfma_f32_16x16x32_bf16 v[152:155], v[104:107], v[92:95], v[152:155]
    ds_read_b128 v[52:55], v14 offset:18432
    v_mfma_f32_16x16x32_bf16 v[176:179], v[104:107], v[96:99], v[176:179]
    ds_read_b128 v[56:59], v14 offset:20480
    v_mfma_f32_16x16x32_bf16 v[200:203], v[104:107], v[100:103], v[200:203]
    ds_read_b128 v[60:63], v14 offset:22528
    v_mfma_f32_16x16x32_bf16 v[132:135], v[108:111], v[88:91], v[132:135]
    ds_read_b64_tr_b16 v[64:65], v22 offset:0
    v_mfma_f32_16x16x32_bf16 v[156:159], v[108:111], v[92:95], v[156:159]
    ds_read_b64_tr_b16 v[66:67], v22 offset:1536
    v_mfma_f32_16x16x32_bf16 v[180:183], v[108:111], v[96:99], v[180:183]
    ds_read_b64_tr_b16 v[68:69], v23 offset:0
    v_mfma_f32_16x16x32_bf16 v[204:207], v[108:111], v[100:103], v[204:207]
    ds_read_b64_tr_b16 v[70:71], v23 offset:1536
    v_mfma_f32_16x16x32_bf16 v[136:139], v[112:115], v[88:91], v[136:139]
    ds_read_b64_tr_b16 v[72:73], v24 offset:0
    v_mfma_f32_16x16x32_bf16 v[160:163], v[112:115], v[92:95], v[160:163]
    ds_read_b64_tr_b16 v[74:75], v24 offset:1536
    v_mfma_f32_16x16x32_bf16 v[184:187], v[112:115], v[96:99], v[184:187]
    ds_read_b64_tr_b16 v[76:77], v22 offset:12288
    v_mfma_f32_16x16x32_bf16 v[208:211], v[112:115], v[100:103], v[208:211]
    ds_read_b64_tr_b16 v[78:79], v22 offset:13824
    v_mfma_f32_16x16x32_bf16 v[140:143], v[116:119], v[88:91], v[140:143]
    ds_read_b64_tr_b16 v[80:81], v23 offset:12288
    v_mfma_f32_16x16x32_bf16 v[164:167], v[116:119], v[92:95], v[164:167]
    ds_read_b64_tr_b16 v[82:83], v23 offset:13824
    s_add_u32 m0, s58, 24576
    v_mfma_f32_16x16x32_bf16 v[188:191], v[116:119], v[96:99], v[188:191]
    ds_read_b64_tr_b16 v[84:85], v24 offset:12288
    buffer_load_dwordx4 v11, s[8:11], s50 offen lds
    v_mfma_f32_16x16x32_bf16 v[212:215], v[116:119], v[100:103], v[212:215]
    ds_read_b64_tr_b16 v[86:87], v24 offset:13824
    s_add_u32 m0, s58, 25600
    v_mfma_f32_16x16x32_bf16 v[144:147], v[120:123], v[88:91], v[144:147]
    buffer_load_dwordx4 v12, s[8:11], s50 offen lds
    v_mfma_f32_16x16x32_bf16 v[168:171], v[120:123], v[92:95], v[168:171]
    s_add_u32 m0, s58, 26624
    v_mfma_f32_16x16x32_bf16 v[192:195], v[120:123], v[96:99], v[192:195]
    buffer_load_dwordx4 v13, s[8:11], s50 offen lds
    s_add_u32 s50, s50, s55
    v_mfma_f32_16x16x32_bf16 v[216:219], v[120:123], v[100:103], v[216:219]
    s_add_u32 m0, s57, 0
    s_movk_i32 s53, 384
    v_mfma_f32_16x16x32_bf16 v[148:151], v[124:127], v[88:91], v[148:151]
    buffer_load_dwordx4 v10, s[4:7], s53 offen lds
    v_mfma_f32_16x16x32_bf16 v[172:175], v[124:127], v[92:95], v[172:175]
    s_add_u32 m0, s57, 1024
    s_movk_i32 s56, 10624
    v_mfma_f32_16x16x32_bf16 v[196:199], v[124:127], v[96:99], v[196:199]
    buffer_load_dwordx4 v10, s[4:7], s56 offen lds
    v_mfma_f32_16x16x32_bf16 v[220:223], v[124:127], v[100:103], v[220:223]
    s_add_u32 s70, s70, s71
    s_mov_b32 exec_hi, 0xffff
    buffer_load_dwordx4 v[236:239], v27, s[8:11], s70 offen
    s_mov_b64 exec, -1
    s_waitcnt vmcnt(13) lgkmcnt(0)
    s_barrier
    v_mfma_f32_16x16x32_bf16 v[128:131], v[64:67], v[48:51], v[128:131]
    ds_read_b128 v[88:91], v15 offset:16384
    v_mfma_f32_16x16x32_bf16 v[152:155], v[64:67], v[52:55], v[152:155]
    ds_read_b128 v[92:95], v15 offset:18432
    v_mfma_f32_16x16x32_bf16 v[176:179], v[64:67], v[56:59], v[176:179]
    ds_read_b128 v[96:99], v15 offset:20480
    v_mfma_f32_16x16x32_bf16 v[200:203], v[64:67], v[60:63], v[200:203]
    ds_read_b128 v[100:103], v15 offset:22528
    v_mfma_f32_16x16x32_bf16 v[132:135], v[68:71], v[48:51], v[132:135]
    ds_read_b64_tr_b16 v[104:105], v22 offset:24576
    v_mfma_f32_16x16x32_bf16 v[156:159], v[68:71], v[52:55], v[156:159]
    ds_read_b64_tr_b16 v[106:107], v22 offset:26112
    v_mfma_f32_16x16x32_bf16 v[180:183], v[68:71], v[56:59], v[180:183]
    ds_read_b64_tr_b16 v[108:109], v23 offset:24576
    v_mfma_f32_16x16x32_bf16 v[204:207], v[68:71], v[60:63], v[204:207]
    ds_read_b64_tr_b16 v[110:111], v23 offset:26112
    v_mfma_f32_16x16x32_bf16 v[136:139], v[72:75], v[48:51], v[136:139]
    ds_read_b64_tr_b16 v[112:113], v24 offset:24576
    v_mfma_f32_16x16x32_bf16 v[160:163], v[72:75], v[52:55], v[160:163]
    ds_read_b64_tr_b16 v[114:115], v24 offset:26112
    v_mfma_f32_16x16x32_bf16 v[184:187], v[72:75], v[56:59], v[184:187]
    ds_read_b64_tr_b16 v[116:117], v22 offset:36864
    v_mfma_f32_16x16x32_bf16 v[208:211], v[72:75], v[60:63], v[208:211]
    ds_read_b64_tr_b16 v[118:119], v22 offset:38400
    v_mfma_f32_16x16x32_bf16 v[140:143], v[76:79], v[48:51], v[140:143]
    ds_read_b64_tr_b16 v[120:121], v23 offset:36864
    v_mfma_f32_16x16x32_bf16 v[164:167], v[76:79], v[52:55], v[164:167]
    ds_read_b64_tr_b16 v[122:123], v23 offset:38400
    v_mfma_f32_16x16x32_bf16 v[188:191], v[76:79], v[56:59], v[188:191]
    ds_read_b64_tr_b16 v[124:125], v24 offset:36864
    v_mfma_f32_16x16x32_bf16 v[212:215], v[76:79], v[60:63], v[212:215]
    ds_read_b64_tr_b16 v[126:127], v24 offset:38400
    v_mfma_f32_16x16x32_bf16 v[144:147], v[80:83], v[48:51], v[144:147]
    v_mfma_f32_16x16x32_bf16 v[168:171], v[80:83], v[52:55], v[168:171]
    s_add_u32 m0, s58, 49152
    v_mfma_f32_16x16x32_bf16 v[192:195], v[80:83], v[56:59], v[192:195]
    buffer_load_dwordx4 v11, s[8:11], s50 offen lds
    v_mfma_f32_16x16x32_bf16 v[216:219], v[80:83], v[60:63], v[216:219]
    s_add_u32 m0, s58, 50176
    v_mfma_f32_16x16x32_bf16 v[148:151], v[84:87], v[48:51], v[148:151]
    buffer_load_dwordx4 v12, s[8:11], s50 offen lds
    v_mfma_f32_16x16x32_bf16 v[172:175], v[84:87], v[52:55], v[172:175]
    s_add_u32 m0, s58, 51200
    v_mfma_f32_16x16x32_bf16 v[196:199], v[84:87], v[56:59], v[196:199]
    buffer_load_dwordx4 v13, s[8:11], s50 offen lds
    s_add_u32 s50, s50, s55
    v_mfma_f32_16x16x32_bf16 v[220:223], v[84:87], v[60:63], v[220:223]
    s_cmp_eq_u32 s64, 2
    s_cbranch_scc0 L_GU_ep2
    s_not_b64 s[78:79], s[76:77]
    s_sub_u32 s78, s78, 200
    s_subb_u32 s79, s79, 0
    s_mov_b64 exec, 1
    v_mov_b32 v42, s78
    v_mov_b32 v43, s79
    v_mov_b32 v44, 0
    global_atomic_umax_x2 v44, v[42:43], s[36:37] sc1
    s_mov_b64 exec, -1
L_GU_ep2:
    s_add_u32 s70, s70, s71
    s_mov_b32 exec_hi, 0xffff
    buffer_load_dwordx4 v[240:243], v27, s[8:11], s70 offen
    s_mov_b64 exec, -1
    s_waitcnt vmcnt(11) lgkmcnt(0)
    s_barrier
    v_mfma_f32_16x16x32_bf16 v[128:131], v[104:107], v[88:91], v[128:131]
    ds_read_b128 v[48:51], v14 offset:32768
    v_mfma_f32_16x16x32_bf16 v[152:155], v[104:107], v[92:95], v[152:155]
    ds_read_b128 v[52:55], v14 offset:34816
    v_mfma_f32_16x16x32_bf16 v[176:179], v[104:107], v[96:99], v[176:179]
    ds_read_b128 v[56:59], v14 offset:36864
    v_mfma_f32_16x16x32_bf16 v[200:203], v[104:107], v[100:103], v[200:203]
    ds_read_b128 v[60:63], v14 offset:38912
    v_mfma_f32_16x16x32_bf16 v[132:135], v[108:111], v[88:91], v[132:135]
    ds_read_b64_tr_b16 v[64:65], v16 offset:0
    v_mfma_f32_16x16x32_bf16 v[156:159], v[108:111], v[92:95], v[156:159]
    ds_read_b64_tr_b16 v[66:67], v16 offset:1536
    v_mfma_f32_16x16x32_bf16 v[180:183], v[108:111], v[96:99], v[180:183]
    ds_read_b64_tr_b16 v[68:69], v17 offset:0
    v_mfma_f32_16x16x32_bf16 v[204:207], v[108:111], v[100:103], v[204:207]
    ds_read_b64_tr_b16 v[70:71], v17 offset:1536
    v_mfma_f32_16x16x32_bf16 v[136:139], v[112:115], v[88:91], v[136:139]
    ds_read_b64_tr_b16 v[72:73], v18 offset:0
    v_mfma_f32_16x16x32_bf16 v[160:163], v[112:115], v[92:95], v[160:163]
    ds_read_b64_tr_b16 v[74:75], v18 offset:1536
    v_mfma_f32_16x16x32_bf16 v[184:187], v[112:115], v[96:99], v[184:187]
    ds_read_b64_tr_b16 v[76:77], v16 offset:12288
    v_mfma_f32_16x16x32_bf16 v[208:211], v[112:115], v[100:103], v[208:211]
    ds_read_b64_tr_b16 v[78:79], v16 offset:13824
    v_mfma_f32_16x16x32_bf16 v[140:143], v[116:119], v[88:91], v[140:143]
    ds_read_b64_tr_b16 v[80:81], v17 offset:12288
    v_mfma_f32_16x16x32_bf16 v[164:167], v[116:119], v[92:95], v[164:167]
    ds_read_b64_tr_b16 v[82:83], v17 offset:13824
    s_add_u32 m0, s58, 73728
    v_mfma_f32_16x16x32_bf16 v[188:191], v[116:119], v[96:99], v[188:191]
    ds_read_b64_tr_b16 v[84:85], v18 offset:12288
    buffer_load_dwordx4 v11, s[8:11], s50 offen lds
    v_mfma_f32_16x16x32_bf16 v[212:215], v[116:119], v[100:103], v[212:215]
    ds_read_b64_tr_b16 v[86:87], v18 offset:13824
    s_add_u32 m0, s58, 74752
    v_mfma_f32_16x16x32_bf16 v[144:147], v[120:123], v[88:91], v[144:147]
    buffer_load_dwordx4 v12, s[8:11], s50 offen lds
    v_mfma_f32_16x16x32_bf16 v[168:171], v[120:123], v[92:95], v[168:171]
    s_add_u32 m0, s58, 75776
    v_mfma_f32_16x16x32_bf16 v[192:195], v[120:123], v[96:99], v[192:195]
    buffer_load_dwordx4 v13, s[8:11], s50 offen lds
    s_add_u32 s50, s50, s55
    v_mfma_f32_16x16x32_bf16 v[216:219], v[120:123], v[100:103], v[216:219]
    s_add_u32 m0, s57, 16384
    s_movk_i32 s53, 512
    v_mfma_f32_16x16x32_bf16 v[148:151], v[124:127], v[88:91], v[148:151]
    buffer_load_dwordx4 v10, s[4:7], s53 offen lds
    v_mfma_f32_16x16x32_bf16 v[172:175], v[124:127], v[92:95], v[172:175]
    s_add_u32 m0, s57, 17408
    s_movk_i32 s56, 10752
    v_mfma_f32_16x16x32_bf16 v[196:199], v[124:127], v[96:99], v[196:199]
    buffer_load_dwordx4 v10, s[4:7], s56 offen lds
    v_mfma_f32_16x16x32_bf16 v[220:223], v[124:127], v[100:103], v[220:223]
    s_cmp_eq_u32 s64, 3
    s_cbranch_scc0 L_GU_ep3
    s_not_b64 s[78:79], s[76:77]
    s_sub_u32 s78, s78, 200
    s_subb_u32 s79, s79, 0
    s_mov_b64 exec, 1
    v_mov_b32 v42, s78
    v_mov_b32 v43, s79
    v_mov_b32 v44, 0
    global_atomic_umax_x2 v44, v[42:43], s[36:37] sc1
    s_mov_b64 exec, -1
L_GU_ep3:
    s_mov_b32 s70, 0
    s_mov_b32 exec_hi, 0xffff
    buffer_load_dwordx4 v[224:227], v27, s[8:11], s70 offen
    s_mov_b64 exec, -1
    s_waitcnt vmcnt(13) lgkmcnt(0)
    s_barrier
    v_mfma_f32_16x16x32_bf16 v[128:131], v[64:67], v[48:51], v[128:131]
    ds_read_b128 v[88:91], v15 offset:32768
    v_mfma_f32_16x16x32_bf16 v[152:155], v[64:67], v[52:55], v[152:155]
    ds_read_b128 v[92:95], v15 offset:34816
    v_mfma_f32_16x16x32_bf16 v[176:179], v[64:67], v[56:59], v[176:179]
    ds_read_b128 v[96:99], v15 offset:36864
    v_mfma_f32_16x16x32_bf16 v[200:203], v[64:67], v[60:63], v[200:203]
    ds_read_b128 v[100:103], v15 offset:38912
    v_mfma_f32_16x16x32_bf16 v[132:135], v[68:71], v[48:51], v[132:135]
    ds_read_b64_tr_b16 v[104:105], v16 offset:24576
    v_mfma_f32_16x16x32_bf16 v[156:159], v[68:71], v[52:55], v[156:159]
    ds_read_b64_tr_b16 v[106:107], v16 offset:26112
    v_mfma_f32_16x16x32_bf16 v[180:183], v[68:71], v[56:59], v[180:183]
    ds_read_b64_tr_b16 v[108:109], v17 offset:24576
    v_mfma_f32_16x16x32_bf16 v[204:207], v[68:71], v[60:63], v[204:207]
    ds_read_b64_tr_b16 v[110:111], v17 offset:26112
    v_mfma_f32_16x16x32_bf16 v[136:139], v[72:75], v[48:51], v[136:139]
    ds_read_b64_tr_b16 v[112:113], v18 offset:24576
    v_mfma_f32_16x16x32_bf16 v[160:163], v[72:75], v[52:55], v[160:163]
    ds_read_b64_tr_b16 v[114:115], v18 offset:26112
    v_mfma_f32_16x16x32_bf16 v[184:187], v[72:75], v[56:59], v[184:187]
    ds_read_b64_tr_b16 v[116:117], v16 offset:36864
    v_mfma_f32_16x16x32_bf16 v[208:211], v[72:75], v[60:63], v[208:211]
    ds_read_b64_tr_b16 v[118:119], v16 offset:38400
    v_mfma_f32_16x16x32_bf16 v[140:143], v[76:79], v[48:51], v[140:143]
    ds_read_b64_tr_b16 v[120:121], v17 offset:36864
    v_mfma_f32_16x16x32_bf16 v[164:167], v[76:79], v[52:55], v[164:167]
    ds_read_b64_tr_b16 v[122:123], v17 offset:38400
    v_mfma_f32_16x16x32_bf16 v[188:191], v[76:79], v[56:59], v[188:191]
    ds_read_b64_tr_b16 v[124:125], v18 offset:36864
    v_mfma_f32_16x16x32_bf16 v[212:215], v[76:79], v[60:63], v[212:215]
    ds_read_b64_tr_b16 v[126:127], v18 offset:38400
    v_mfma_f32_16x16x32_bf16 v[144:147], v[80:83], v[48:51], v[144:147]
    v_mfma_f32_16x16x32_bf16 v[168:171], v[80:83], v[52:55], v[168:171]
    s_add_u32 m0, s58, 0
    v_mfma_f32_16x16x32_bf16 v[192:195], v[80:83], v[56:59], v[192:195]
    buffer_load_dwordx4 v11, s[8:11], s50 offen lds
    v_mfma_f32_16x16x32_bf16 v[216:219], v[80:83], v[60:63], v[216:219]
    s_add_u32 m0, s58, 1024
    v_mfma_f32_16x16x32_bf16 v[148:151], v[84:87], v[48:51], v[148:151]
    buffer_load_dwordx4 v12, s[8:11], s50 offen lds
    v_mfma_f32_16x16x32_bf16 v[172:175], v[84:87], v[52:55], v[172:175]
    s_add_u32 m0, s58, 2048
    v_mfma_f32_16x16x32_bf16 v[196:199], v[84:87], v[56:59], v[196:199]
    buffer_load_dwordx4 v13, s[8:11], s50 offen lds
    s_add_u32 s50, s50, s55
    v_mfma_f32_16x16x32_bf16 v[220:223], v[84:87], v[60:63], v[220:223]
    s_cmp_eq_u32 s64, 4
    s_cbranch_scc0 L_GU_ep4
    s_not_b64 s[78:79], s[76:77]
    s_sub_u32 s78, s78, 200
    s_subb_u32 s79, s79, 0
    s_mov_b64 exec, 1
    v_mov_b32 v42, s78
    v_mov_b32 v43, s79
    v_mov_b32 v44, 0
    global_atomic_umax_x2 v44, v[42:43], s[36:37] sc1
    s_mov_b64 exec, -1
L_GU_ep4:
    s_waitcnt vmcnt(10) lgkmcnt(0)
    s_barrier
    v_mfma_f32_16x16x32_bf16 v[128:131], v[104:107], v[88:91], v[128:131]
    ds_read_b128 v[48:51], v14 offset:0
    v_lshlrev_b32 v244, 16, v228
    v_and_b32 v245, s73, v228
    v_mfma_f32_16x16x32_bf16 v[152:155], v[104:107], v[92:95], v[152:155]
    ds_read_b128 v[52:55], v14 offset:2048
    v_lshlrev_b32 v246, 16, v229
    v_and_b32 v247, s73, v229
    v_mfma_f32_16x16x32_bf16 v[176:179], v[104:107], v[96:99], v[176:179]
    ds_read_b128 v[56:59], v14 offset:4096
    v_lshlrev_b32 v248, 16, v230
    v_and_b32 v249, s73, v230
    v_mfma_f32_16x16x32_bf16 v[200:203], v[104:107], v[100:103], v[200:203]
    ds_read_b128 v[60:63], v14 offset:6144
    v_lshlrev_b32 v250, 16, v231
    v_and_b32 v251, s73, v231
    v_mfma_f32_16x16x32_bf16 v[132:135], v[108:111], v[88:91], v[132:135]
    ds_read_b64_tr_b16 v[64:65], v22 offset:0
    v_lshlrev_b32 v2, 16, v232
    v_and_b32 v3, s73, v232
    v_mfma_f32_16x16x32_bf16 v[156:159], v[108:111], v[92:95], v[156:159]
    ds_read_b64_tr_b16 v[66:67], v22 offset:1536
    v_add_f32 v244, v244, v2
    v_add_f32 v245, v245, v3
    v_mfma_f32_16x16x32_bf16 v[180:183], v[108:111], v[96:99], v[180:183]
    ds_read_b64_tr_b16 v[68:69], v23 offset:0
    v_lshlrev_b32 v4, 16, v233
    v_and_b32 v5, s73, v233
    v_mfma_f32_16x16x32_bf16 v[204:207], v[108:111], v[100:103], v[204:207]
    ds_read_b64_tr_b16 v[70:71], v23 offset:1536
    v_add_f32 v246, v246, v4
    v_add_f32 v247, v247, v5
    v_mfma_f32_16x16x32_bf16 v[136:139], v[112:115], v[88:91], v[136:139]
    ds_read_b64_tr_b16 v[72:73], v24 offset:0
    v_lshlrev_b32 v2, 16, v234
    v_and_b32 v3, s73, v234
    v_mfma_f32_16x16x32_bf16 v[160:163], v[112:115], v[92:95], v[160:163]
    ds_read_b64_tr_b16 v[74:75], v24 offset:1536
    v_add_f32 v248, v248, v2
    v_add_f32 v249, v249, v3
    v_mfma_f32_16x16x32_bf16 v[184:187], v[112:115], v[96:99], v[184:187]
    ds_read_b64_tr_b16 v[76:77], v22 offset:12288
    v_lshlrev_b32 v4, 16, v235
    v_and_b32 v5, s73, v235
    v_mfma_f32_16x16x32_bf16 v[208:211], v[112:115], v[100:103], v[208:211]
    ds_read_b64_tr_b16 v[78:79], v22 offset:13824
    v_add_f32 v250, v250, v4
    v_add_f32 v251, v251, v5
    v_mfma_f32_16x16x32_bf16 v[140:143], v[116:119], v[88:91], v[140:143]
    ds_read_b64_tr_b16 v[80:81], v23 offset:12288
    v_lshlrev_b32 v2, 16, v236
    v_and_b32 v3, s73, v236
    v_mfma_f32_16x16x32_bf16 v[164:167], v[116:119], v[92:95], v[164:167]
    ds_read_b64_tr_b16 v[82:83], v23 offset:13824
    s_add_u32 m0, s58, 24576
    v_add_f32 v244, v244, v2
    v_add_f32 v245, v245, v3
    v_mfma_f32_16x16x32_bf16 v[188:191], v[116:119], v[96:99], v[188:191]
    ds_read_b64_tr_b16 v[84:85], v24 offset:12288
    buffer_load_dwordx4 v11, s[8:11], s50 offen lds
    v_lshlrev_b32 v4, 16, v237
    v_and_b32 v5, s73, v237
    v_mfma_f32_16x16x32_bf16 v[212:215], v[116:119], v[100:103], v[212:215]
    ds_read_b64_tr_b16 v[86:87], v24 offset:13824
    s_add_u32 m0, s58, 25600
    v_add_f32 v246, v246, v4
    v_add_f32 v247, v247, v5
    v_mfma_f32_16x16x32_bf16 v[144:147], v[120:123], v[88:91], v[144:147]
    buffer_load_dwordx4 v12, s[8:11], s50 offen lds
    v_lshlrev_b32 v2, 16, v238
    v_and_b32 v3, s73, v238
    v_mfma_f32_16x16x32_bf16 v[168:171], v[120:123], v[92:95], v[168:171]
    s_add_u32 m0, s58, 26624
    v_add_f32 v248, v248, v2
    v_add_f32 v249, v249, v3
    v_mfma_f32_16x16x32_bf16 v[192:195], v[120:123], v[96:99], v[192:195]
    buffer_load_dwordx4 v13, s[8:11], s50 offen lds
    s_add_u32 s50, s50, s55
    v_lshlrev_b32 v4, 16, v239
    v_and_b32 v5, s73, v239
    v_mfma_f32_16x16x32_bf16 v[216:219], v[120:123], v[100:103], v[216:219]
    s_add_u32 m0, s57, 32768
    s_movk_i32 s53, 640
    v_add_f32 v250, v250, v4
    v_add_f32 v251, v251, v5
    v_mfma_f32_16x16x32_bf16 v[148:151], v[124:127], v[88:91], v[148:151]
    buffer_load_dwordx4 v10, s[4:7], s53 offen lds
    v_mfma_f32_16x16x32_bf16 v[172:175], v[124:127], v[92:95], v[172:175]
    s_add_u32 m0, s57, 33792
    s_movk_i32 s56, 10880
    v_mfma_f32_16x16x32_bf16 v[196:199], v[124:127], v[96:99], v[196:199]
    buffer_load_dwordx4 v10, s[4:7], s56 offen lds
    v_mfma_f32_16x16x32_bf16 v[220:223], v[124:127], v[100:103], v[220:223]
    s_cmp_eq_u32 s64, 5
    s_cbranch_scc0 L_GU_ep5
    s_not_b64 s[78:79], s[76:77]
    s_sub_u32 s78, s78, 200
    s_subb_u32 s79, s79, 0
    s_mov_b64 exec, 1
    v_mov_b32 v42, s78
    v_mov_b32 v43, s79
    v_mov_b32 v44, 0
    global_atomic_umax_x2 v44, v[42:43], s[36:37] sc1
    s_mov_b64 exec, -1
L_GU_ep5:
    s_waitcnt vmcnt(8) lgkmcnt(0)
    s_barrier
    v_mfma_f32_16x16x32_bf16 v[128:131], v[64:67], v[48:51], v[128:131]
    ds_read_b128 v[88:91], v15 offset:0
    v_lshlrev_b32 v2, 16, v240
    v_and_b32 v3, s73, v240
    v_mfma_f32_16x16x32_bf16 v[152:155], v[64:67], v[52:55], v[152:155]
    ds_read_b128 v[92:95], v15 offset:2048
    v_add_f32 v244, v244, v2
    v_add_f32 v245, v245, v3
    v_mfma_f32_16x16x32_bf16 v[176:179], v[64:67], v[56:59], v[176:179]
    ds_read_b128 v[96:99], v15 offset:4096
    v_lshlrev_b32 v4, 16, v241
    v_and_b32 v5, s73, v241
    v_mfma_f32_16x16x32_bf16 v[200:203], v[64:67], v[60:63], v[200:203]
    ds_read_b128 v[100:103], v15 offset:6144
    v_add_f32 v246, v246, v4
    v_add_f32 v247, v247, v5
    v_mfma_f32_16x16x32_bf16 v[132:135], v[68:71], v[48:51], v[132:135]
    ds_read_b64_tr_b16 v[104:105], v22 offset:24576
    v_lshlrev_b32 v2, 16, v242
    v_and_b32 v3, s73, v242
    v_mfma_f32_16x16x32_bf16 v[156:159], v[68:71], v[52:55], v[156:159]
    ds_read_b64_tr_b16 v[106:107], v22 offset:26112
    v_add_f32 v248, v248, v2
    v_add_f32 v249, v249, v3
    v_mfma_f32_16x16x32_bf16 v[180:183], v[68:71], v[56:59], v[180:183]
    ds_read_b64_tr_b16 v[108:109], v23 offset:24576
    v_lshlrev_b32 v4, 16, v243
    v_and_b32 v5, s73, v243
    v_mfma_f32_16x16x32_bf16 v[204:207], v[68:71], v[60:63], v[204:207]
    ds_read_b64_tr_b16 v[110:111], v23 offset:26112
    v_add_f32 v250, v250, v4
    v_add_f32 v251, v251, v5
    v_mfma_f32_16x16x32_bf16 v[136:139], v[72:75], v[48:51], v[136:139]
    ds_read_b64_tr_b16 v[112:113], v24 offset:24576
    v_lshlrev_b32 v2, 16, v224
    v_and_b32 v3, s73, v224
    v_mfma_f32_16x16x32_bf16 v[160:163], v[72:75], v[52:55], v[160:163]
    ds_read_b64_tr_b16 v[114:115], v24 offset:26112
    v_add_f32 v244, v244, v2
    v_add_f32 v245, v245, v3
    v_mfma_f32_16x16x32_bf16 v[184:187], v[72:75], v[56:59], v[184:187]
    ds_read_b64_tr_b16 v[116:117], v22 offset:36864
    v_lshlrev_b32 v4, 16, v225
    v_and_b32 v5, s73, v225
    v_mfma_f32_16x16x32_bf16 v[208:211], v[72:75], v[60:63], v[208:211]
    ds_read_b64_tr_b16 v[118:119], v22 offset:38400
    v_add_f32 v246, v246, v4
    v_add_f32 v247, v247, v5
    v_mfma_f32_16x16x32_bf16 v[140:143], v[76:79], v[48:51], v[140:143]
    ds_read_b64_tr_b16 v[120:121], v23 offset:36864
    v_lshlrev_b32 v2, 16, v226
    v_mfma_f32_16x16x32_bf16 v[164:167], v[76:79], v[52:55], v[164:167]
    ds_read_b64_tr_b16 v[122:123], v23 offset:38400
    v_and_b32 v3, s73, v226
    v_mfma_f32_16x16x32_bf16 v[188:191], v[76:79], v[56:59], v[188:191]
    ds_read_b64_tr_b16 v[124:125], v24 offset:36864
    v_add_f32 v248, v248, v2
    v_mfma_f32_16x16x32_bf16 v[212:215], v[76:79], v[60:63], v[212:215]
    ds_read_b64_tr_b16 v[126:127], v24 offset:38400
    v_add_f32 v249, v249, v3
    v_mfma_f32_16x16x32_bf16 v[144:147], v[80:83], v[48:51], v[144:147]
    v_lshlrev_b32 v4, 16, v227
    v_mfma_f32_16x16x32_bf16 v[168:171], v[80:83], v[52:55], v[168:171]
    s_add_u32 m0, s58, 49152
    v_and_b32 v5, s73, v227
    v_mfma_f32_16x16x32_bf16 v[192:195], v[80:83], v[56:59], v[192:195]
    buffer_load_dwordx4 v11, s[8:11], s50 offen lds
    v_add_f32 v250, v250, v4
    v_mfma_f32_16x16x32_bf16 v[216:219], v[80:83], v[60:63], v[216:219]
    s_add_u32 m0, s58, 50176
    v_add_f32 v251, v251, v5
    v_mfma_f32_16x16x32_bf16 v[148:151], v[84:87], v[48:51], v[148:151]
    buffer_load_dwordx4 v12, s[8:11], s50 offen lds
    v_mfma_f32_16x16x32_bf16 v[172:175], v[84:87], v[52:55], v[172:175]
    s_add_u32 m0, s58, 51200
    v_mfma_f32_16x16x32_bf16 v[196:199], v[84:87], v[56:59], v[196:199]
    buffer_load_dwordx4 v13, s[8:11], s50 offen lds
    s_add_u32 s50, s50, s55
    v_mfma_f32_16x16x32_bf16 v[220:223], v[84:87], v[60:63], v[220:223]
    s_cmp_eq_u32 s64, 6
    s_cbranch_scc0 L_GU_ep6
    s_not_b64 s[78:79], s[76:77]
    s_sub_u32 s78, s78, 200
    s_subb_u32 s79, s79, 0
    s_mov_b64 exec, 1
    v_mov_b32 v42, s78
    v_mov_b32 v43, s79
    v_mov_b32 v44, 0
    global_atomic_umax_x2 v44, v[42:43], s[36:37] sc1
    s_mov_b64 exec, -1
L_GU_ep6:
    s_mov_b32 exec_hi, 0xffff
    ds_write_b128 v28, v[244:247]
    ds_write_b128 v28, v[248:251] offset:16
    s_mov_b64 exec, -1
    s_waitcnt vmcnt(8) lgkmcnt(0)
    s_barrier
    v_mfma_f32_16x16x32_bf16 v[128:131], v[104:107], v[88:91], v[128:131]
    ds_read_b128 v[48:51], v14 offset:16384
    v_mfma_f32_16x16x32_bf16 v[152:155], v[104:107], v[92:95], v[152:155]
    ds_read_b128 v[52:55], v14 offset:18432
    v_mfma_f32_16x16x32_bf16 v[176:179], v[104:107], v[96:99], v[176:179]
    ds_read_b128 v[56:59], v14 offset:20480
    v_mfma_f32_16x16x32_bf16 v[200:203], v[104:107], v[100:103], v[200:203]
    ds_read_b128 v[60:63], v14 offset:22528
    v_mfma_f32_16x16x32_bf16 v[132:135], v[108:111], v[88:91], v[132:135]
    ds_read_b64_tr_b16 v[64:65], v16 offset:0
    v_mfma_f32_16x16x32_bf16 v[156:159], v[108:111], v[92:95], v[156:159]
    ds_read_b64_tr_b16 v[66:67], v16 offset:1536
    v_mfma_f32_16x16x32_bf16 v[180:183], v[108:111], v[96:99], v[180:183]
    ds_read_b64_tr_b16 v[68:69], v17 offset:0
    v_mfma_f32_16x16x32_bf16 v[204:207], v[108:111], v[100:103], v[204:207]
    ds_read_b64_tr_b16 v[70:71], v17 offset:1536
    v_mfma_f32_16x16x32_bf16 v[136:139], v[112:115], v[88:91], v[136:139]
    ds_read_b64_tr_b16 v[72:73], v18 offset:0
    v_mfma_f32_16x16x32_bf16 v[160:163], v[112:115], v[92:95], v[160:163]
    ds_read_b64_tr_b16 v[74:75], v18 offset:1536
    v_mfma_f32_16x16x32_bf16 v[184:187], v[112:115], v[96:99], v[184:187]
    ds_read_b64_tr_b16 v[76:77], v16 offset:12288
    v_mfma_f32_16x16x32_bf16 v[208:211], v[112:115], v[100:103], v[208:211]
    ds_read_b64_tr_b16 v[78:79], v16 offset:13824
    v_mfma_f32_16x16x32_bf16 v[140:143], v[116:119], v[88:91], v[140:143]
    ds_read_b64_tr_b16 v[80:81], v17 offset:12288
    v_mfma_f32_16x16x32_bf16 v[164:167], v[116:119], v[92:95], v[164:167]
    ds_read_b64_tr_b16 v[82:83], v17 offset:13824
    s_add_u32 m0, s58, 73728
    v_mfma_f32_16x16x32_bf16 v[188:191], v[116:119], v[96:99], v[188:191]
    ds_read_b64_tr_b16 v[84:85], v18 offset:12288
    buffer_load_dwordx4 v11, s[8:11], s50 offen lds
    v_mfma_f32_16x16x32_bf16 v[212:215], v[116:119], v[100:103], v[212:215]
    ds_read_b64_tr_b16 v[86:87], v18 offset:13824
    s_add_u32 m0, s58, 74752
    v_mfma_f32_16x16x32_bf16 v[144:147], v[120:123], v[88:91], v[144:147]
    buffer_load_dwordx4 v12, s[8:11], s50 offen lds
    v_mfma_f32_16x16x32_bf16 v[168:171], v[120:123], v[92:95], v[168:171]
    s_add_u32 m0, s58, 75776
    v_mfma_f32_16x16x32_bf16 v[192:195], v[120:123], v[96:99], v[192:195]
    buffer_load_dwordx4 v13, s[8:11], s50 offen lds
    s_add_u32 s50, s50, s55
    v_mfma_f32_16x16x32_bf16 v[216:219], v[120:123], v[100:103], v[216:219]
    s_add_u32 m0, s57, 0
    s_movk_i32 s53, 768
    v_mfma_f32_16x16x32_bf16 v[148:151], v[124:127], v[88:91], v[148:151]
    buffer_load_dwordx4 v10, s[4:7], s53 offen lds
    v_mfma_f32_16x16x32_bf16 v[172:175], v[124:127], v[92:95], v[172:175]
    s_add_u32 m0, s57, 1024
    s_movk_i32 s56, 11008
    v_mfma_f32_16x16x32_bf16 v[196:199], v[124:127], v[96:99], v[196:199]
    buffer_load_dwordx4 v10, s[4:7], s56 offen lds
    v_mfma_f32_16x16x32_bf16 v[220:223], v[124:127], v[100:103], v[220:223]
    s_cmp_eq_u32 s64, 7
    s_cbranch_scc0 L_GU_ep7
    s_not_b64 s[78:79], s[76:77]
    s_sub_u32 s78, s78, 200
    s_subb_u32 s79, s79, 0
    s_mov_b64 exec, 1
    v_mov_b32 v42, s78
    v_mov_b32 v43, s79
    v_mov_b32 v44, 0
    global_atomic_umax_x2 v44, v[42:43], s[36:37] sc1
    s_mov_b64 exec, -1
L_GU_ep7:
    s_cmp_lt_u32 s40, 2
    s_cbranch_scc0 L_GU_e6
    v_cmp_gt_u32 vcc, 96, v0
    s_nop 0
    s_and_saveexec_b64 s[60:61], vcc
    v_lshlrev_b32 v2, 4, v0
    v_add_u32 v3, 147456, v2
    ds_read_b128 v[224:227], v3 offset:0
    ds_read_b128 v[228:231], v3 offset:1536
    ds_read_b128 v[232:235], v3 offset:3072
    ds_read_b128 v[236:239], v3 offset:4608
    ds_read_b128 v[240:243], v3 offset:6144
    ds_read_b128 v[244:247], v3 offset:7680
    ds_read_b128 v[248:251], v3 offset:9216
    ds_read_b128 v[252:255], v3 offset:10752
    s_lshl_b32 s62, s42, 4
    s_add_u32 s62, s62, s41
    s_mul_i32 s62, s62, 1536
    s_add_u32 s62, s62, 14680064
    s_waitcnt lgkmcnt(6)
    v_add_f32 v224, v224, v228
    v_add_f32 v225, v225, v229
    v_add_f32 v226, v226, v230
    v_add_f32 v227, v227, v231
    s_waitcnt lgkmcnt(5)
    v_add_f32 v224, v224, v232
    v_add_f32 v225, v225, v233
    v_add_f32 v226, v226, v234
    v_add_f32 v227, v227, v235
    s_waitcnt lgkmcnt(4)
    v_add_f32 v224, v224, v236
    v_add_f32 v225, v225, v237
    v_add_f32 v226, v226, v238
    v_add_f32 v227, v227, v239
    s_waitcnt lgkmcnt(3)
    v_add_f32 v224, v224, v240
    v_add_f32 v225, v225, v241
    v_add_f32 v226, v226, v242
    v_add_f32 v227, v227, v243
    s_waitcnt lgkmcnt(2)
    v_add_f32 v224, v224, v244
    v_add_f32 v225, v225, v245
    v_add_f32 v226, v226, v246
    v_add_f32 v227, v227, v247
    s_waitcnt lgkmcnt(1)
    v_add_f32 v224, v224, v248
    v_add_f32 v225, v225, v249
    v_add_f32 v226, v226, v250
    v_add_f32 v227, v227, v251
    s_waitcnt lgkmcnt(0)
    v_add_f32 v224, v224, v252
    v_add_f32 v225, v225, v253
    v_add_f32 v226, v226, v254
    v_add_f32 v227, v227, v255
    buffer_store_dwordx4 v[224:227], v2, s[12:15], s62 offen sc1
    s_mov_b64 exec, s[60:61]
L_GU_e6:
    s_waitcnt vmcnt(10) lgkmcnt(0)
    s_barrier
    v_mfma_f32_16x16x32_bf16 v[128:131], v[64:67], v[48:51], v[128:131]
    ds_read_b128 v[88:91], v15 offset:16384
    v_mfma_f32_16x16x32_bf16 v[152:155], v[64:67], v[52:55], v[152:155]
    ds_read_b128 v[92:95], v15 offset:18432
    v_mfma_f32_16x16x32_bf16 v[176:179], v[64:67], v[56:59], v[176:179]
    ds_read_b128 v[96:99], v15 offset:20480
    v_mfma_f32_16x16x32_bf16 v[200:203], v[64:67], v[60:63], v[200:203]
    ds_read_b128 v[100:103], v15 offset:22528
    v_mfma_f32_16x16x32_bf16 v[132:135], v[68:71], v[48:51], v[132:135]
    ds_read_b64_tr_b16 v[104:105], v16 offset:24576
    v_mfma_f32_16x16x32_bf16 v[156:159], v[68:71], v[52:55], v[156:159]
    ds_read_b64_tr_b16 v[106:107], v16 offset:26112
    v_mfma_f32_16x16x32_bf16 v[180:183], v[68:71], v[56:59], v[180:183]
    ds_read_b64_tr_b16 v[108:109], v17 offset:24576
    v_mfma_f32_16x16x32_bf16 v[204:207], v[68:71], v[60:63], v[204:207]
    ds_read_b64_tr_b16 v[110:111], v17 offset:26112
    v_mfma_f32_16x16x32_bf16 v[136:139], v[72:75], v[48:51], v[136:139]
    ds_read_b64_tr_b16 v[112:113], v18 offset:24576
    v_mfma_f32_16x16x32_bf16 v[160:163], v[72:75], v[52:55], v[160:163]
    ds_read_b64_tr_b16 v[114:115], v18 offset:26112
    v_mfma_f32_16x16x32_bf16 v[184:187], v[72:75], v[56:59], v[184:187]
    ds_read_b64_tr_b16 v[116:117], v16 offset:36864
    v_mfma_f32_16x16x32_bf16 v[208:211], v[72:75], v[60:63], v[208:211]
    ds_read_b64_tr_b16 v[118:119], v16 offset:38400
    v_mfma_f32_16x16x32_bf16 v[140:143], v[76:79], v[48:51], v[140:143]
    ds_read_b64_tr_b16 v[120:121], v17 offset:36864
    v_mfma_f32_16x16x32_bf16 v[164:167], v[76:79], v[52:55], v[164:167]
    ds_read_b64_tr_b16 v[122:123], v17 offset:38400
    v_mfma_f32_16x16x32_bf16 v[188:191], v[76:79], v[56:59], v[188:191]
    ds_read_b64_tr_b16 v[124:125], v18 offset:36864
    v_mfma_f32_16x16x32_bf16 v[212:215], v[76:79], v[60:63], v[212:215]
    ds_read_b64_tr_b16 v[126:127], v18 offset:38400
    v_mfma_f32_16x16x32_bf16 v[144:147], v[80:83], v[48:51], v[144:147]
    v_mfma_f32_16x16x32_bf16 v[168:171], v[80:83], v[52:55], v[168:171]
    s_add_u32 m0, s58, 0
    v_mfma_f32_16x16x32_bf16 v[192:195], v[80:83], v[56:59], v[192:195]
    buffer_load_dwordx4 v11, s[8:11], s50 offen lds
    v_mfma_f32_16x16x32_bf16 v[216:219], v[80:83], v[60:63], v[216:219]
    s_add_u32 m0, s58, 1024
    v_mfma_f32_16x16x32_bf16 v[148:151], v[84:87], v[48:51], v[148:151]
    buffer_load_dwordx4 v12, s[8:11], s50 offen lds
    v_mfma_f32_16x16x32_bf16 v[172:175], v[84:87], v[52:55], v[172:175]
    s_add_u32 m0, s58, 2048
    v_mfma_f32_16x16x32_bf16 v[196:199], v[84:87], v[56:59], v[196:199]
    buffer_load_dwordx4 v13, s[8:11], s50 offen lds
    s_add_u32 s50, s50, s55
    v_mfma_f32_16x16x32_bf16 v[220:223], v[84:87], v[60:63], v[220:223]
    s_cmp_eq_u32 s64, 8
    s_cbranch_scc0 L_GU_ep8
    s_not_b64 s[78:79], s[76:77]
    s_sub_u32 s78, s78, 200
    s_subb_u32 s79, s79, 0
    s_mov_b64 exec, 1
    v_mov_b32 v42, s78
    v_mov_b32 v43, s79
    v_mov_b32 v44, 0
    global_atomic_umax_x2 v44, v[42:43], s[36:37] sc1
    s_mov_b64 exec, -1
L_GU_ep8:
    s_cmp_ge_u32 s40, 5
    s_cbranch_scc0 L_GU_cpf
    s_getpc_b64 s[60:61]
L_GU_pc:
    s_cmp_eq_u32 s40, 5
    s_cselect_b32 s62, L_GU_ch0-L_GU_pc-2048, 0
    s_cmp_eq_u32 s40, 6
    s_cselect_b32 s62, L_pub-L_GU_pc+0, s62
    s_cmp_eq_u32 s40, 7
    s_cselect_b32 s62, L_pub-L_GU_pc+8192, s62
    v_lshl_add_u32 v44, v1, 7, s62
    v_min_u32 v44, L_code_end-L_GU_pc-4, v44
    v_mov_b32 v45, s61
    v_add_co_u32 v44, vcc, s60, v44
    s_nop 1
    v_addc_co_u32 v45, vcc, 0, v45, vcc
    global_load_dword v46, v[44:45], off
L_GU_cpf:
    s_waitcnt vmcnt(8) lgkmcnt(0)
    s_barrier
    v_mfma_f32_16x16x32_bf16 v[128:131], v[104:107], v[88:91], v[128:131]
    ds_read_b128 v[48:51], v14 offset:32768
    s_add_u32 m0, s58, 24576
    v_mfma_f32_16x16x32_bf16 v[152:155], v[104:107], v[92:95], v[152:155]
    ds_read_b128 v[52:55], v14 offset:34816
    buffer_load_dwordx4 v11, s[8:11], s50 offen lds
    v_mfma_f32_16x16x32_bf16 v[176:179], v[104:107], v[96:99], v[176:179]
    ds_read_b128 v[56:59], v14 offset:36864
    s_add_u32 m0, s58, 25600
    v_mfma_f32_16x16x32_bf16 v[200:203], v[104:107], v[100:103], v[200:203]
    ds_read_b128 v[60:63], v14 offset:38912
    buffer_load_dwordx4 v12, s[8:11], s50 offen lds
    v_mfma_f32_16x16x32_bf16 v[132:135], v[108:111], v[88:91], v[132:135]
    ds_read_b64_tr_b16 v[64:65], v22 offset:0
    s_add_u32 m0, s58, 26624
    v_mfma_f32_16x16x32_bf16 v[156:159], v[108:111], v[92:95], v[156:159]
    ds_read_b64_tr_b16 v[66:67], v22 offset:1536
    buffer_load_dwordx4 v13, s[8:11], s50 offen lds
    s_add_u32 s50, s50, s55
    v_mfma_f32_16x16x32_bf16 v[180:183], v[108:111], v[96:99], v[180:183]
    ds_read_b64_tr_b16 v[68:69], v23 offset:0
    s_add_u32 m0, s57, 16384
    s_movk_i32 s53, 896
    v_mfma_f32_16x16x32_bf16 v[204:207], v[108:111], v[100:103], v[204:207]
    ds_read_b64_tr_b16 v[70:71], v23 offset:1536
    buffer_load_dwordx4 v10, s[4:7], s53 offen lds
    v_mfma_f32_16x16x32_bf16 v[136:139], v[112:115], v[88:91], v[136:139]
    ds_read_b64_tr_b16 v[72:73], v24 offset:0
    s_add_u32 m0, s57, 17408
    s_movk_i32 s56, 11136
    v_mfma_f32_16x16x32_bf16 v[160:163], v[112:115], v[92:95], v[160:163]
    ds_read_b64_tr_b16 v[74:75], v24 offset:1536
    buffer_load_dwordx4 v10, s[4:7], s56 offen lds
    v_mfma_f32_16x16x32_bf16 v[184:187], v[112:115], v[96:99], v[184:187]
    ds_read_b64_tr_b16 v[76:77], v22 offset:12288
    v_mfma_f32_16x16x32_bf16 v[208:211], v[112:115], v[100:103], v[208:211]
    ds_read_b64_tr_b16 v[78:79], v22 offset:13824
    v_mfma_f32_16x16x32_bf16 v[140:143], v[116:119], v[88:91], v[140:143]
    ds_read_b64_tr_b16 v[80:81], v23 offset:12288
    v_mfma_f32_16x16x32_bf16 v[164:167], v[116:119], v[92:95], v[164:167]
    ds_read_b64_tr_b16 v[82:83], v23 offset:13824
    v_mfma_f32_16x16x32_bf16 v[188:191], v[116:119], v[96:99], v[188:191]
    ds_read_b64_tr_b16 v[84:85], v24 offset:12288
    v_mfma_f32_16x16x32_bf16 v[212:215], v[116:119], v[100:103], v[212:215]
    ds_read_b64_tr_b16 v[86:87], v24 offset:13824
    v_mfma_f32_16x16x32_bf16 v[144:147], v[120:123], v[88:91], v[144:147]
    v_mfma_f32_16x16x32_bf16 v[168:171], v[120:123], v[92:95], v[168:171]
    v_mfma_f32_16x16x32_bf16 v[192:195], v[120:123], v[96:99], v[192:195]
    v_mfma_f32_16x16x32_bf16 v[216:219], v[120:123], v[100:103], v[216:219]
    v_mfma_f32_16x16x32_bf16 v[148:151], v[124:127], v[88:91], v[148:151]
    v_mfma_f32_16x16x32_bf16 v[172:175], v[124:127], v[92:95], v[172:175]
    v_mfma_f32_16x16x32_bf16 v[196:199], v[124:127], v[96:99], v[196:199]
    v_mfma_f32_16x16x32_bf16 v[220:223], v[124:127], v[100:103], v[220:223]
    s_cmp_eq_u32 s64, 9
    s_cbranch_scc0 L_GU_ep9
    s_not_b64 s[78:79], s[76:77]
    s_sub_u32 s78, s78, 200
    s_subb_u32 s79, s79, 0
    s_mov_b64 exec, 1
    v_mov_b32 v42, s78
    v_mov_b32 v43, s79
    v_mov_b32 v44, 0
    global_atomic_umax_x2 v44, v[42:43], s[36:37] sc1
    s_mov_b64 exec, -1
L_GU_ep9:
    s_cmp_lt_u32 s40, 2
    s_cbranch_scc0 L_GU_t10
    s_waitcnt vmcnt(0)
L_GU_t10:
    s_waitcnt vmcnt(10) lgkmcnt(0)
    s_barrier
    v_mfma_f32_16x16x32_bf16 v[128:131], v[64:67], v[48:51], v[128:131]
    ds_read_b128 v[88:91], v15 offset:32768
    v_mfma_f32_16x16x32_bf16 v[152:155], v[64:67], v[52:55], v[152:155]
    ds_read_b128 v[92:95], v15 offset:34816
    v_mfma_f32_16x16x32_bf16 v[176:179], v[64:67], v[56:59], v[176:179]
    ds_read_b128 v[96:99], v15 offset:36864
    v_mfma_f32_16x16x32_bf16 v[200:203], v[64:67], v[60:63], v[200:203]
    ds_read_b128 v[100:103], v15 offset:38912
    v_mfma_f32_16x16x32_bf16 v[132:135], v[68:71], v[48:51], v[132:135]
    ds_read_b64_tr_b16 v[104:105], v22 offset:24576
    v_mfma_f32_16x16x32_bf16 v[156:159], v[68:71], v[52:55], v[156:159]
    ds_read_b64_tr_b16 v[106:107], v22 offset:26112
    v_mfma_f32_16x16x32_bf16 v[180:183], v[68:71], v[56:59], v[180:183]
    ds_read_b64_tr_b16 v[108:109], v23 offset:24576
    v_mfma_f32_16x16x32_bf16 v[204:207], v[68:71], v[60:63], v[204:207]
    ds_read_b64_tr_b16 v[110:111], v23 offset:26112
    v_mfma_f32_16x16x32_bf16 v[136:139], v[72:75], v[48:51], v[136:139]
    ds_read_b64_tr_b16 v[112:113], v24 offset:24576
    v_mfma_f32_16x16x32_bf16 v[160:163], v[72:75], v[52:55], v[160:163]
    ds_read_b64_tr_b16 v[114:115], v24 offset:26112
    v_mfma_f32_16x16x32_bf16 v[184:187], v[72:75], v[56:59], v[184:187]
    ds_read_b64_tr_b16 v[116:117], v22 offset:36864
    v_mfma_f32_16x16x32_bf16 v[208:211], v[72:75], v[60:63], v[208:211]
    ds_read_b64_tr_b16 v[118:119], v22 offset:38400
    v_mfma_f32_16x16x32_bf16 v[140:143], v[76:79], v[48:51], v[140:143]
    ds_read_b64_tr_b16 v[120:121], v23 offset:36864
    v_mfma_f32_16x16x32_bf16 v[164:167], v[76:79], v[52:55], v[164:167]
    ds_read_b64_tr_b16 v[122:123], v23 offset:38400
    v_mfma_f32_16x16x32_bf16 v[188:191], v[76:79], v[56:59], v[188:191]
    ds_read_b64_tr_b16 v[124:125], v24 offset:36864
    v_mfma_f32_16x16x32_bf16 v[212:215], v[76:79], v[60:63], v[212:215]
    ds_read_b64_tr_b16 v[126:127], v24 offset:38400
    v_mfma_f32_16x16x32_bf16 v[144:147], v[80:83], v[48:51], v[144:147]
    v_mfma_f32_16x16x32_bf16 v[168:171], v[80:83], v[52:55], v[168:171]
    s_add_u32 m0, s58, 49152
    v_mfma_f32_16x16x32_bf16 v[192:195], v[80:83], v[56:59], v[192:195]
    buffer_load_dwordx4 v11, s[8:11], s50 offen lds
    v_mfma_f32_16x16x32_bf16 v[216:219], v[80:83], v[60:63], v[216:219]
    s_add_u32 m0, s58, 50176
    v_mfma_f32_16x16x32_bf16 v[148:151], v[84:87], v[48:51], v[148:151]
    buffer_load_dwordx4 v12, s[8:11], s50 offen lds
    v_mfma_f32_16x16x32_bf16 v[172:175], v[84:87], v[52:55], v[172:175]
    s_add_u32 m0, s58, 51200
    v_mfma_f32_16x16x32_bf16 v[196:199], v[84:87], v[56:59], v[196:199]
    buffer_load_dwordx4 v13, s[8:11], s50 offen lds
    s_add_u32 s50, s50, s55
    v_mfma_f32_16x16x32_bf16 v[220:223], v[84:87], v[60:63], v[220:223]
    s_cmp_eq_u32 s40, 0
    s_cbranch_scc0 L_GU_e9
    s_lshl_b32 s60, s41, 3
    s_memrealtime s[78:79]
    s_mov_b64 exec, 1
    s_waitcnt lgkmcnt(0)
    v_mov_b32 v40, s78
    v_mov_b32 v41, s79
    buffer_store_dwordx2 v[40:41], v37, s[12:15], s60 offen offset:0 sc1
    s_mov_b64 exec, -1
L_GU_e9:
    s_waitcnt vmcnt(8) lgkmcnt(0)
    s_barrier
    v_mfma_f32_16x16x32_bf16 v[128:131], v[104:107], v[88:91], v[128:131]
    ds_read_b128 v[48:51], v14 offset:0
    v_mfma_f32_16x16x32_bf16 v[152:155], v[104:107], v[92:95], v[152:155]
    ds_read_b128 v[52:55], v14 offset:2048
    v_mfma_f32_16x16x32_bf16 v[176:179], v[104:107], v[96:99], v[176:179]
    ds_read_b128 v[56:59], v14 offset:4096
    v_mfma_f32_16x16x32_bf16 v[200:203], v[104:107], v[100:103], v[200:203]
    ds_read_b128 v[60:63], v14 offset:6144
    v_mfma_f32_16x16x32_bf16 v[132:135], v[108:111], v[88:91], v[132:135]
    ds_read_b64_tr_b16 v[64:65], v16 offset:0
    v_mfma_f32_16x16x32_bf16 v[156:159], v[108:111], v[92:95], v[156:159]
    ds_read_b64_tr_b16 v[66:67], v16 offset:1536
    v_mfma_f32_16x16x32_bf16 v[180:183], v[108:111], v[96:99], v[180:183]
    ds_read_b64_tr_b16 v[68:69], v17 offset:0
    v_mfma_f32_16x16x32_bf16 v[204:207], v[108:111], v[100:103], v[204:207]
    ds_read_b64_tr_b16 v[70:71], v17 offset:1536
    v_mfma_f32_16x16x32_bf16 v[136:139], v[112:115], v[88:91], v[136:139]
    ds_read_b64_tr_b16 v[72:73], v18 offset:0
    v_mfma_f32_16x16x32_bf16 v[160:163], v[112:115], v[92:95], v[160:163]
    ds_read_b64_tr_b16 v[74:75], v18 offset:1536
    v_mfma_f32_16x16x32_bf16 v[184:187], v[112:115], v[96:99], v[184:187]
    ds_read_b64_tr_b16 v[76:77], v16 offset:12288
    v_mfma_f32_16x16x32_bf16 v[208:211], v[112:115], v[100:103], v[208:211]
    ds_read_b64_tr_b16 v[78:79], v16 offset:13824
    v_mfma_f32_16x16x32_bf16 v[140:143], v[116:119], v[88:91], v[140:143]
    ds_read_b64_tr_b16 v[80:81], v17 offset:12288
    v_mfma_f32_16x16x32_bf16 v[164:167], v[116:119], v[92:95], v[164:167]
    ds_read_b64_tr_b16 v[82:83], v17 offset:13824
    s_add_u32 m0, s58, 73728
    v_mfma_f32_16x16x32_bf16 v[188:191], v[116:119], v[96:99], v[188:191]
    ds_read_b64_tr_b16 v[84:85], v18 offset:12288
    buffer_load_dwordx4 v11, s[8:11], s50 offen lds
    v_mfma_f32_16x16x32_bf16 v[212:215], v[116:119], v[100:103], v[212:215]
    ds_read_b64_tr_b16 v[86:87], v18 offset:13824
    s_add_u32 m0, s58, 74752
    v_mfma_f32_16x16x32_bf16 v[144:147], v[120:123], v[88:91], v[144:147]
    buffer_load_dwordx4 v12, s[8:11], s50 offen lds
    v_mfma_f32_16x16x32_bf16 v[168:171], v[120:123], v[92:95], v[168:171]
    s_add_u32 m0, s58, 75776
    v_mfma_f32_16x16x32_bf16 v[192:195], v[120:123], v[96:99], v[192:195]
    buffer_load_dwordx4 v13, s[8:11], s50 offen lds
    s_add_u32 s50, s50, s55
    v_mfma_f32_16x16x32_bf16 v[216:219], v[120:123], v[100:103], v[216:219]
    s_add_u32 m0, s57, 32768
    s_movk_i32 s53, 1024
    v_mfma_f32_16x16x32_bf16 v[148:151], v[124:127], v[88:91], v[148:151]
    buffer_load_dwordx4 v10, s[4:7], s53 offen lds
    v_mfma_f32_16x16x32_bf16 v[172:175], v[124:127], v[92:95], v[172:175]
    s_add_u32 m0, s57, 33792
    s_movk_i32 s56, 11264
    v_mfma_f32_16x16x32_bf16 v[196:199], v[124:127], v[96:99], v[196:199]
    buffer_load_dwordx4 v10, s[4:7], s56 offen lds
    v_mfma_f32_16x16x32_bf16 v[220:223], v[124:127], v[100:103], v[220:223]
    s_waitcnt vmcnt(10) lgkmcnt(0)
    s_barrier
    v_mfma_f32_16x16x32_bf16 v[128:131], v[64:67], v[48:51], v[128:131]
    ds_read_b128 v[88:91], v15 offset:0
    v_mfma_f32_16x16x32_bf16 v[152:155], v[64:67], v[52:55], v[152:155]
    ds_read_b128 v[92:95], v15 offset:2048
    v_mfma_f32_16x16x32_bf16 v[176:179], v[64:67], v[56:59], v[176:179]
    ds_read_b128 v[96:99], v15 offset:4096
    v_mfma_f32_16x16x32_bf16 v[200:203], v[64:67], v[60:63], v[200:203]
    ds_read_b128 v[100:103], v15 offset:6144
    v_mfma_f32_16x16x32_bf16 v[132:135], v[68:71], v[48:51], v[132:135]
    ds_read_b64_tr_b16 v[104:105], v16 offset:24576
    v_mfma_f32_16x16x32_bf16 v[156:159], v[68:71], v[52:55], v[156:159]
    ds_read_b64_tr_b16 v[106:107], v16 offset:26112
    v_mfma_f32_16x16x32_bf16 v[180:183], v[68:71], v[56:59], v[180:183]
    ds_read_b64_tr_b16 v[108:109], v17 offset:24576
    v_mfma_f32_16x16x32_bf16 v[204:207], v[68:71], v[60:63], v[204:207]
    ds_read_b64_tr_b16 v[110:111], v17 offset:26112
    v_mfma_f32_16x16x32_bf16 v[136:139], v[72:75], v[48:51], v[136:139]
    ds_read_b64_tr_b16 v[112:113], v18 offset:24576
    v_mfma_f32_16x16x32_bf16 v[160:163], v[72:75], v[52:55], v[160:163]
    ds_read_b64_tr_b16 v[114:115], v18 offset:26112
    v_mfma_f32_16x16x32_bf16 v[184:187], v[72:75], v[56:59], v[184:187]
    ds_read_b64_tr_b16 v[116:117], v16 offset:36864
    v_mfma_f32_16x16x32_bf16 v[208:211], v[72:75], v[60:63], v[208:211]
    ds_read_b64_tr_b16 v[118:119], v16 offset:38400
    v_mfma_f32_16x16x32_bf16 v[140:143], v[76:79], v[48:51], v[140:143]
    ds_read_b64_tr_b16 v[120:121], v17 offset:36864
    v_mfma_f32_16x16x32_bf16 v[164:167], v[76:79], v[52:55], v[164:167]
    ds_read_b64_tr_b16 v[122:123], v17 offset:38400
    v_mfma_f32_16x16x32_bf16 v[188:191], v[76:79], v[56:59], v[188:191]
    ds_read_b64_tr_b16 v[124:125], v18 offset:36864
    v_mfma_f32_16x16x32_bf16 v[212:215], v[76:79], v[60:63], v[212:215]
    ds_read_b64_tr_b16 v[126:127], v18 offset:38400
    v_mfma_f32_16x16x32_bf16 v[144:147], v[80:83], v[48:51], v[144:147]
    v_mfma_f32_16x16x32_bf16 v[168:171], v[80:83], v[52:55], v[168:171]
    s_add_u32 m0, s58, 0
    v_mfma_f32_16x16x32_bf16 v[192:195], v[80:83], v[56:59], v[192:195]
    buffer_load_dwordx4 v11, s[8:11], s50 offen lds
    v_mfma_f32_16x16x32_bf16 v[216:219], v[80:83], v[60:63], v[216:219]
    s_add_u32 m0, s58, 1024
    v_mfma_f32_16x16x32_bf16 v[148:151], v[84:87], v[48:51], v[148:151]
    buffer_load_dwordx4 v12, s[8:11], s50 offen lds
    v_mfma_f32_16x16x32_bf16 v[172:175], v[84:87], v[52:55], v[172:175]
    s_add_u32 m0, s58, 2048
    v_mfma_f32_16x16x32_bf16 v[196:199], v[84:87], v[56:59], v[196:199]
    buffer_load_dwordx4 v13, s[8:11], s50 offen lds
    s_add_u32 s50, s50, s55
    v_mfma_f32_16x16x32_bf16 v[220:223], v[84:87], v[60:63], v[220:223]
    s_waitcnt vmcnt(8) lgkmcnt(0)
    s_barrier
    v_mfma_f32_16x16x32_bf16 v[128:131], v[104:107], v[88:91], v[128:131]
    ds_read_b128 v[48:51], v14 offset:16384
    v_mfma_f32_16x16x32_bf16 v[152:155], v[104:107], v[92:95], v[152:155]
    ds_read_b128 v[52:55], v14 offset:18432
    v_mfma_f32_16x16x32_bf16 v[176:179], v[104:107], v[96:99], v[176:179]
    ds_read_b128 v[56:59], v14 offset:20480
    v_mfma_f32_16x16x32_bf16 v[200:203], v[104:107], v[100:103], v[200:203]
    ds_read_b128 v[60:63], v14 offset:22528
    v_mfma_f32_16x16x32_bf16 v[132:135], v[108:111], v[88:91], v[132:135]
    ds_read_b64_tr_b16 v[64:65], v22 offset:0
    v_mfma_f32_16x16x32_bf16 v[156:159], v[108:111], v[92:95], v[156:159]
    ds_read_b64_tr_b16 v[66:67], v22 offset:1536
    v_mfma_f32_16x16x32_bf16 v[180:183], v[108:111], v[96:99], v[180:183]
    ds_read_b64_tr_b16 v[68:69], v23 offset:0
    v_mfma_f32_16x16x32_bf16 v[204:207], v[108:111], v[100:103], v[204:207]
    ds_read_b64_tr_b16 v[70:71], v23 offset:1536
    v_mfma_f32_16x16x32_bf16 v[136:139], v[112:115], v[88:91], v[136:139]
    ds_read_b64_tr_b16 v[72:73], v24 offset:0
    v_mfma_f32_16x16x32_bf16 v[160:163], v[112:115], v[92:95], v[160:163]
    ds_read_b64_tr_b16 v[74:75], v24 offset:1536
    v_mfma_f32_16x16x32_bf16 v[184:187], v[112:115], v[96:99], v[184:187]
    ds_read_b64_tr_b16 v[76:77], v22 offset:12288
    v_mfma_f32_16x16x32_bf16 v[208:211], v[112:115], v[100:103], v[208:211]
    ds_read_b64_tr_b16 v[78:79], v22 offset:13824
    v_mfma_f32_16x16x32_bf16 v[140:143], v[116:119], v[88:91], v[140:143]
    ds_read_b64_tr_b16 v[80:81], v23 offset:12288
    v_mfma_f32_16x16x32_bf16 v[164:167], v[116:119], v[92:95], v[164:167]
    ds_read_b64_tr_b16 v[82:83], v23 offset:13824
    s_add_u32 m0, s58, 24576
    v_mfma_f32_16x16x32_bf16 v[188:191], v[116:119], v[96:99], v[188:191]
    ds_read_b64_tr_b16 v[84:85], v24 offset:12288
    buffer_load_dwordx4 v11, s[8:11], s50 offen lds
    v_mfma_f32_16x16x32_bf16 v[212:215], v[116:119], v[100:103], v[212:215]
    ds_read_b64_tr_b16 v[86:87], v24 offset:13824
    s_add_u32 m0, s58, 25600
    v_mfma_f32_16x16x32_bf16 v[144:147], v[120:123], v[88:91], v[144:147]
    buffer_load_dwordx4 v12, s[8:11], s50 offen lds
    v_mfma_f32_16x16x32_bf16 v[168:171], v[120:123], v[92:95], v[168:171]
    s_add_u32 m0, s58, 26624
    v_mfma_f32_16x16x32_bf16 v[192:195], v[120:123], v[96:99], v[192:195]
    buffer_load_dwordx4 v13, s[8:11], s50 offen lds
    s_add_u32 s50, s50, s55
    v_mfma_f32_16x16x32_bf16 v[216:219], v[120:123], v[100:103], v[216:219]
    s_add_u32 m0, s57, 0
    s_movk_i32 s53, 1152
    v_mfma_f32_16x16x32_bf16 v[148:151], v[124:127], v[88:91], v[148:151]
    buffer_load_dwordx4 v10, s[4:7], s53 offen lds
    v_mfma_f32_16x16x32_bf16 v[172:175], v[124:127], v[92:95], v[172:175]
    s_add_u32 m0, s57, 1024
    s_movk_i32 s56, 11392
    v_mfma_f32_16x16x32_bf16 v[196:199], v[124:127], v[96:99], v[196:199]
    buffer_load_dwordx4 v10, s[4:7], s56 offen lds
    v_mfma_f32_16x16x32_bf16 v[220:223], v[124:127], v[100:103], v[220:223]
    s_cmp_eq_u32 s40, 0
    s_cbranch_scc0 L_GU_e12
    s_mov_b64 exec, 0xffffffff
    buffer_load_dwordx2 v[40:41], v37, s[12:15], 0 offen offset:0 sc1
    s_mov_b64 exec, -1
L_GU_e12:
    s_waitcnt vmcnt(10) lgkmcnt(0)
    s_barrier
    v_mfma_f32_16x16x32_bf16 v[128:131], v[64:67], v[48:51], v[128:131]
    ds_read_b128 v[88:91], v15 offset:16384
    v_mfma_f32_16x16x32_bf16 v[152:155], v[64:67], v[52:55], v[152:155]
    ds_read_b128 v[92:95], v15 offset:18432
    v_mfma_f32_16x16x32_bf16 v[176:179], v[64:67], v[56:59], v[176:179]
    ds_read_b128 v[96:99], v15 offset:20480
    v_mfma_f32_16x16x32_bf16 v[200:203], v[64:67], v[60:63], v[200:203]
    ds_read_b128 v[100:103], v15 offset:22528
    v_mfma_f32_16x16x32_bf16 v[132:135], v[68:71], v[48:51], v[132:135]
    ds_read_b64_tr_b16 v[104:105], v22 offset:24576
    v_mfma_f32_16x16x32_bf16 v[156:159], v[68:71], v[52:55], v[156:159]
    ds_read_b64_tr_b16 v[106:107], v22 offset:26112
    v_mfma_f32_16x16x32_bf16 v[180:183], v[68:71], v[56:59], v[180:183]
    ds_read_b64_tr_b16 v[108:109], v23 offset:24576
    v_mfma_f32_16x16x32_bf16 v[204:207], v[68:71], v[60:63], v[204:207]
    ds_read_b64_tr_b16 v[110:111], v23 offset:26112
    v_mfma_f32_16x16x32_bf16 v[136:139], v[72:75], v[48:51], v[136:139]
    ds_read_b64_tr_b16 v[112:113], v24 offset:24576
    v_mfma_f32_16x16x32_bf16 v[160:163], v[72:75], v[52:55], v[160:163]
    ds_read_b64_tr_b16 v[114:115], v24 offset:26112
    v_mfma_f32_16x16x32_bf16 v[184:187], v[72:75], v[56:59], v[184:187]
    ds_read_b64_tr_b16 v[116:117], v22 offset:36864
    v_mfma_f32_16x16x32_bf16 v[208:211], v[72:75], v[60:63], v[208:211]
    ds_read_b64_tr_b16 v[118:119], v22 offset:38400
    v_mfma_f32_16x16x32_bf16 v[140:143], v[76:79], v[48:51], v[140:143]
    ds_read_b64_tr_b16 v[120:121], v23 offset:36864
    v_mfma_f32_16x16x32_bf16 v[164:167], v[76:79], v[52:55], v[164:167]
    ds_read_b64_tr_b16 v[122:123], v23 offset:38400
    v_mfma_f32_16x16x32_bf16 v[188:191], v[76:79], v[56:59], v[188:191]
    ds_read_b64_tr_b16 v[124:125], v24 offset:36864
    v_mfma_f32_16x16x32_bf16 v[212:215], v[76:79], v[60:63], v[212:215]
    ds_read_b64_tr_b16 v[126:127], v24 offset:38400
    v_mfma_f32_16x16x32_bf16 v[144:147], v[80:83], v[48:51], v[144:147]
    v_mfma_f32_16x16x32_bf16 v[168:171], v[80:83], v[52:55], v[168:171]
    s_add_u32 m0, s58, 49152
    v_mfma_f32_16x16x32_bf16 v[192:195], v[80:83], v[56:59], v[192:195]
    buffer_load_dwordx4 v11, s[8:11], s50 offen lds
    v_mfma_f32_16x16x32_bf16 v[216:219], v[80:83], v[60:63], v[216:219]
    s_add_u32 m0, s58, 50176
    v_mfma_f32_16x16x32_bf16 v[148:151], v[84:87], v[48:51], v[148:151]
    buffer_load_dwordx4 v12, s[8:11], s50 offen lds
    v_mfma_f32_16x16x32_bf16 v[172:175], v[84:87], v[52:55], v[172:175]
    s_add_u32 m0, s58, 51200
    v_mfma_f32_16x16x32_bf16 v[196:199], v[84:87], v[56:59], v[196:199]
    buffer_load_dwordx4 v13, s[8:11], s50 offen lds
    s_add_u32 s50, s50, s55
    v_mfma_f32_16x16x32_bf16 v[220:223], v[84:87], v[60:63], v[220:223]
    s_cmp_eq_u32 s40, 0
    s_cbranch_scc0 L_GU_ck15
    s_waitcnt vmcnt(3)
    s_mov_b32 s65, 0
L_GU_sp15:
    s_mov_b64 exec, 0xffffffff
    v_mov_b32 v43, s77
    v_subrev_co_u32 v42, vcc, s76, v40
    s_nop 1
    v_subb_co_u32 v43, vcc, v41, v43, vcc
    v_lshrrev_b32 v42, 30, v42
    v_or_b32 v42, v42, v43
    v_cmp_ne_u32 vcc, 0, v42
    s_mov_b64 exec, -1
    s_cmp_eq_u64 vcc, 0
    s_cbranch_scc1 L_GU_ck15
    s_add_u32 s65, s65, 1
    s_cmp_ge_u32 s65, 0x400000
    s_cbranch_scc1 L_GU_ck15
    s_sleep 4
    s_mov_b64 exec, 0xffffffff
    buffer_load_dwordx2 v[40:41], v37, s[12:15], 0 offen offset:0 sc1
    s_mov_b64 exec, -1
    s_and_b32 s66, s65, 15
    s_cmp_lg_u32 s66, 0
    s_cbranch_scc1 L_GU_sp15_w
    v_mov_b32 v42, 0
    global_load_dwordx2 v[42:43], v42, s[36:37] sc1
    s_waitcnt vmcnt(0)
    v_readfirstlane_b32 s78, v42
    v_readfirstlane_b32 s79, v43
    s_nop 0
    s_cmp_eq_u64 s[78:79], 0
    s_cbranch_scc1 L_GU_sp15_w
    s_not_b64 s[78:79], s[78:79]
    s_sub_u32 s78, s78, 200
    s_subb_u32 s79, s79, 0
    s_sub_u32 s66, s78, s76
    s_subb_u32 s66, s79, s77
    s_cselect_b32 s76, s78, s76
    s_cselect_b32 s77, s79, s77
L_GU_sp15_w:
    s_waitcnt vmcnt(0)
    s_branch L_GU_sp15
L_GU_ck15:
    s_waitcnt vmcnt(8) lgkmcnt(0)
    s_barrier
    buffer_load_dwordx4 v[224:227], v39, s[12:15], 0 offen offset:0 sc1
    buffer_load_dwordx4 v[228:231], v39, s[12:15], 0 offen offset:1536 sc1
    buffer_load_dwordx4 v[232:235], v39, s[12:15], 0 offen offset:3072 sc1
    buffer_load_dwordx4 v[236:239], v39, s[12:15], s67 offen sc1
    s_cmp_ge_u32 s40, 6
    s_cbranch_scc0 L_GU_s16
    buffer_load_dwordx2 v[240:241], v29, s[12:15], 0 offen sc1
L_GU_s16:
    v_mfma_f32_16x16x32_bf16 v[128:131], v[104:107], v[88:91], v[128:131]
    ds_read_b128 v[48:51], v14 offset:32768
    v_mfma_f32_16x16x32_bf16 v[152:155], v[104:107], v[92:95], v[152:155]
    ds_read_b128 v[52:55], v14 offset:34816
    v_mfma_f32_16x16x32_bf16 v[176:179], v[104:107], v[96:99], v[176:179]
    ds_read_b128 v[56:59], v14 offset:36864
    v_mfma_f32_16x16x32_bf16 v[200:203], v[104:107], v[100:103], v[200:203]
    ds_read_b128 v[60:63], v14 offset:38912
    v_mfma_f32_16x16x32_bf16 v[132:135], v[108:111], v[88:91], v[132:135]
    ds_read_b64_tr_b16 v[64:65], v16 offset:0
    v_mfma_f32_16x16x32_bf16 v[156:159], v[108:111], v[92:95], v[156:159]
    ds_read_b64_tr_b16 v[66:67], v16 offset:1536
    v_mfma_f32_16x16x32_bf16 v[180:183], v[108:111], v[96:99], v[180:183]
    ds_read_b64_tr_b16 v[68:69], v17 offset:0
    v_mfma_f32_16x16x32_bf16 v[204:207], v[108:111], v[100:103], v[204:207]
    ds_read_b64_tr_b16 v[70:71], v17 offset:1536
    v_mfma_f32_16x16x32_bf16 v[136:139], v[112:115], v[88:91], v[136:139]
    ds_read_b64_tr_b16 v[72:73], v18 offset:0
    v_mfma_f32_16x16x32_bf16 v[160:163], v[112:115], v[92:95], v[160:163]
    ds_read_b64_tr_b16 v[74:75], v18 offset:1536
    v_mfma_f32_16x16x32_bf16 v[184:187], v[112:115], v[96:99], v[184:187]
    ds_read_b64_tr_b16 v[76:77], v16 offset:12288
    v_mfma_f32_16x16x32_bf16 v[208:211], v[112:115], v[100:103], v[208:211]
    ds_read_b64_tr_b16 v[78:79], v16 offset:13824
    v_mfma_f32_16x16x32_bf16 v[140:143], v[116:119], v[88:91], v[140:143]
    ds_read_b64_tr_b16 v[80:81], v17 offset:12288
    v_mfma_f32_16x16x32_bf16 v[164:167], v[116:119], v[92:95], v[164:167]
    ds_read_b64_tr_b16 v[82:83], v17 offset:13824
    v_mfma_f32_16x16x32_bf16 v[188:191], v[116:119], v[96:99], v[188:191]
    ds_read_b64_tr_b16 v[84:85], v18 offset:12288
    v_mfma_f32_16x16x32_bf16 v[212:215], v[116:119], v[100:103], v[212:215]
    ds_read_b64_tr_b16 v[86:87], v18 offset:13824
    v_mfma_f32_16x16x32_bf16 v[144:147], v[120:123], v[88:91], v[144:147]
    v_mfma_f32_16x16x32_bf16 v[168:171], v[120:123], v[92:95], v[168:171]
    s_add_u32 m0, s58, 73728
    v_mfma_f32_16x16x32_bf16 v[192:195], v[120:123], v[96:99], v[192:195]
    buffer_load_dwordx4 v11, s[8:11], s50 offen lds
    v_mfma_f32_16x16x32_bf16 v[216:219], v[120:123], v[100:103], v[216:219]
    s_add_u32 m0, s58, 74752
    v_mfma_f32_16x16x32_bf16 v[148:151], v[124:127], v[88:91], v[148:151]
    buffer_load_dwordx4 v12, s[8:11], s50 offen lds
    v_mfma_f32_16x16x32_bf16 v[172:175], v[124:127], v[92:95], v[172:175]
    s_add_u32 m0, s58, 75776
    v_mfma_f32_16x16x32_bf16 v[196:199], v[124:127], v[96:99], v[196:199]
    buffer_load_dwordx4 v13, s[8:11], s50 offen lds
    s_add_u32 s50, s50, s55
    v_mfma_f32_16x16x32_bf16 v[220:223], v[124:127], v[100:103], v[220:223]
    s_add_u32 m0, s16, 20480
    s_add_u32 s52, s3, 0
    s_cmp_eq_u32 s19, 0
    buffer_load_dwordx4 v21, s[12:15], s52 offen sc1 lds
    s_cbranch_scc1 L_p2_x1
    s_add_u32 m0, s17, 20480
    s_add_u32 s52, s52, s18
    buffer_load_dwordx4 v21, s[12:15], s52 offen sc1 lds
L_p2_x1:
    s_waitcnt vmcnt(13) lgkmcnt(0)
    s_barrier
    v_mfma_f32_16x16x32_bf16 v[128:131], v[64:67], v[48:51], v[128:131]
    ds_read_b128 v[88:91], v15 offset:32768
    v_mfma_f32_16x16x32_bf16 v[152:155], v[64:67], v[52:55], v[152:155]
    ds_read_b128 v[92:95], v15 offset:34816
    v_mfma_f32_16x16x32_bf16 v[176:179], v[64:67], v[56:59], v[176:179]
    ds_read_b128 v[96:99], v15 offset:36864
    v_mfma_f32_16x16x32_bf16 v[200:203], v[64:67], v[60:63], v[200:203]
    ds_read_b128 v[100:103], v15 offset:38912
    v_mfma_f32_16x16x32_bf16 v[132:135], v[68:71], v[48:51], v[132:135]
    ds_read_b64_tr_b16 v[104:105], v16 offset:24576
    v_mfma_f32_16x16x32_bf16 v[156:159], v[68:71], v[52:55], v[156:159]
    ds_read_b64_tr_b16 v[106:107], v16 offset:26112
    v_mfma_f32_16x16x32_bf16 v[180:183], v[68:71], v[56:59], v[180:183]
    ds_read_b64_tr_b16 v[108:109], v17 offset:24576
    v_mfma_f32_16x16x32_bf16 v[204:207], v[68:71], v[60:63], v[204:207]
    ds_read_b64_tr_b16 v[110:111], v17 offset:26112
    v_mfma_f32_16x16x32_bf16 v[136:139], v[72:75], v[48:51], v[136:139]
    ds_read_b64_tr_b16 v[112:113], v18 offset:24576
    v_mfma_f32_16x16x32_bf16 v[160:163], v[72:75], v[52:55], v[160:163]
    ds_read_b64_tr_b16 v[114:115], v18 offset:26112
    v_mfma_f32_16x16x32_bf16 v[184:187], v[72:75], v[56:59], v[184:187]
    ds_read_b64_tr_b16 v[116:117], v16 offset:36864
    v_mfma_f32_16x16x32_bf16 v[208:211], v[72:75], v[60:63], v[208:211]
    ds_read_b64_tr_b16 v[118:119], v16 offset:38400
    v_mfma_f32_16x16x32_bf16 v[140:143], v[76:79], v[48:51], v[140:143]
    ds_read_b64_tr_b16 v[120:121], v17 offset:36864
    v_mfma_f32_16x16x32_bf16 v[164:167], v[76:79], v[52:55], v[164:167]
    ds_read_b64_tr_b16 v[122:123], v17 offset:38400
    v_mfma_f32_16x16x32_bf16 v[188:191], v[76:79], v[56:59], v[188:191]
    ds_read_b64_tr_b16 v[124:125], v18 offset:36864
    v_mfma_f32_16x16x32_bf16 v[212:215], v[76:79], v[60:63], v[212:215]
    ds_read_b64_tr_b16 v[126:127], v18 offset:38400
    v_mfma_f32_16x16x32_bf16 v[144:147], v[80:83], v[48:51], v[144:147]
    v_mfma_f32_16x16x32_bf16 v[168:171], v[80:83], v[52:55], v[168:171]
    v_mfma_f32_16x16x32_bf16 v[192:195], v[80:83], v[56:59], v[192:195]
    v_mfma_f32_16x16x32_bf16 v[216:219], v[80:83], v[60:63], v[216:219]
    v_mfma_f32_16x16x32_bf16 v[148:151], v[84:87], v[48:51], v[148:151]
    s_add_u32 m0, s16, 51200
    s_add_u32 s52, s3, 10240
    s_cmp_eq_u32 s19, 0
    buffer_load_dwordx4 v21, s[12:15], s52 offen sc1 lds
    s_cbranch_scc1 L_p2_x2
    s_add_u32 m0, s17, 51200
    s_add_u32 s52, s52, s18
    buffer_load_dwordx4 v21, s[12:15], s52 offen sc1 lds
L_p2_x2:
    v_mfma_f32_16x16x32_bf16 v[172:175], v[84:87], v[52:55], v[172:175]
    v_mfma_f32_16x16x32_bf16 v[196:199], v[84:87], v[56:59], v[196:199]
    s_add_u32 m0, s16, 61440
    s_add_u32 s52, s3, 20480
    s_cmp_eq_u32 s19, 0
    buffer_load_dwordx4 v21, s[12:15], s52 offen sc1 lds
    s_cbranch_scc1 L_p2_x3
    s_add_u32 m0, s17, 61440
    s_add_u32 s52, s52, s18
    buffer_load_dwordx4 v21, s[12:15], s52 offen sc1 lds
L_p2_x3:
    v_mfma_f32_16x16x32_bf16 v[220:223], v[84:87], v[60:63], v[220:223]
    s_waitcnt vmcnt(6) lgkmcnt(0)
    s_barrier
    s_cmp_lt_u32 s40, 6
    s_cbranch_scc0 L_GU_s17
    v_add_f32 v224, v224, v228
    v_add_f32 v225, v225, v229
    v_add_f32 v226, v226, v230
    v_add_f32 v227, v227, v231
    v_add_f32 v224, v224, v232
    v_add_f32 v225, v225, v233
    v_add_f32 v226, v226, v234
    v_add_f32 v227, v227, v235
    v_add_f32 v224, v224, v236
    v_add_f32 v225, v225, v237
    v_add_f32 v226, v226, v238
    v_add_f32 v227, v227, v239
    ds_write_b128 v30, v[224:227]
L_GU_s17:
    v_mfma_f32_16x16x32_bf16 v[128:131], v[104:107], v[88:91], v[128:131]
    ds_read_b128 v[48:51], v14 offset:0
    v_mfma_f32_16x16x32_bf16 v[152:155], v[104:107], v[92:95], v[152:155]
    ds_read_b128 v[52:55], v14 offset:2048
    v_mfma_f32_16x16x32_bf16 v[176:179], v[104:107], v[96:99], v[176:179]
    ds_read_b128 v[56:59], v14 offset:4096
    v_mfma_f32_16x16x32_bf16 v[200:203], v[104:107], v[100:103], v[200:203]
    ds_read_b128 v[60:63], v14 offset:6144
    v_mfma_f32_16x16x32_bf16 v[132:135], v[108:111], v[88:91], v[132:135]
    ds_read_b64_tr_b16 v[64:65], v22 offset:0
    v_mfma_f32_16x16x32_bf16 v[156:159], v[108:111], v[92:95], v[156:159]
    ds_read_b64_tr_b16 v[66:67], v22 offset:1536
    v_mfma_f32_16x16x32_bf16 v[180:183], v[108:111], v[96:99], v[180:183]
    ds_read_b64_tr_b16 v[68:69], v23 offset:0
    v_mfma_f32_16x16x32_bf16 v[204:207], v[108:111], v[100:103], v[204:207]
    ds_read_b64_tr_b16 v[70:71], v23 offset:1536
    v_mfma_f32_16x16x32_bf16 v[136:139], v[112:115], v[88:91], v[136:139]
    ds_read_b64_tr_b16 v[72:73], v24 offset:0
    v_mfma_f32_16x16x32_bf16 v[160:163], v[112:115], v[92:95], v[160:163]
    ds_read_b64_tr_b16 v[74:75], v24 offset:1536
    v_mfma_f32_16x16x32_bf16 v[184:187], v[112:115], v[96:99], v[184:187]
    ds_read_b64_tr_b16 v[76:77], v22 offset:12288
    v_mfma_f32_16x16x32_bf16 v[208:211], v[112:115], v[100:103], v[208:211]
    ds_read_b64_tr_b16 v[78:79], v22 offset:13824
    v_mfma_f32_16x16x32_bf16 v[140:143], v[116:119], v[88:91], v[140:143]
    ds_read_b64_tr_b16 v[80:81], v23 offset:12288
    v_mfma_f32_16x16x32_bf16 v[164:167], v[116:119], v[92:95], v[164:167]
    ds_read_b64_tr_b16 v[82:83], v23 offset:13824
    v_mfma_f32_16x16x32_bf16 v[188:191], v[116:119], v[96:99], v[188:191]
    ds_read_b64_tr_b16 v[84:85], v24 offset:12288
    v_mfma_f32_16x16x32_bf16 v[212:215], v[116:119], v[100:103], v[212:215]
    ds_read_b64_tr_b16 v[86:87], v24 offset:13824
    v_mfma_f32_16x16x32_bf16 v[144:147], v[120:123], v[88:91], v[144:147]
    s_add_u32 m0, s16, 30720
    s_add_u32 s52, s3, 30720
    s_cmp_eq_u32 s19, 0
    buffer_load_dwordx4 v21, s[12:15], s52 offen sc1 lds
    s_cbranch_scc1 L_p2_x4
    s_add_u32 m0, s17, 30720
    s_add_u32 s52, s52, s18
    buffer_load_dwordx4 v21, s[12:15], s52 offen sc1 lds
L_p2_x4:
    v_mfma_f32_16x16x32_bf16 v[168:171], v[120:123], v[92:95], v[168:171]
    v_mfma_f32_16x16x32_bf16 v[192:195], v[120:123], v[96:99], v[192:195]
    s_add_u32 m0, s16, 40960
    s_add_u32 s52, s3, 40960
    s_cmp_eq_u32 s19, 0
    buffer_load_dwordx4 v21, s[12:15], s52 offen sc1 lds
    s_cbranch_scc1 L_p2_x5
    s_add_u32 m0, s17, 40960
    s_add_u32 s52, s52, s18
    buffer_load_dwordx4 v21, s[12:15], s52 offen sc1 lds
L_p2_x5:
    v_mfma_f32_16x16x32_bf16 v[216:219], v[120:123], v[100:103], v[216:219]
    v_mfma_f32_16x16x32_bf16 v[148:151], v[124:127], v[88:91], v[148:151]
    s_add_u32 m0, s16, 71680
    s_add_u32 s52, s3, 51200
    s_cmp_eq_u32 s19, 0
    buffer_load_dwordx4 v21, s[12:15], s52 offen sc1 lds
    s_cbranch_scc1 L_p2_x6
    s_add_u32 m0, s17, 71680
    s_add_u32 s52, s52, s18
    buffer_load_dwordx4 v21, s[12:15], s52 offen sc1 lds
L_p2_x6:
    v_mfma_f32_16x16x32_bf16 v[172:175], v[124:127], v[92:95], v[172:175]
    v_mfma_f32_16x16x32_bf16 v[196:199], v[124:127], v[96:99], v[196:199]
    s_add_u32 m0, s16, 81920
    s_add_u32 s52, s3, 61440
    s_cmp_eq_u32 s19, 0
    buffer_load_dwordx4 v21, s[12:15], s52 offen sc1 lds
    s_cbranch_scc1 L_p2_x7
    s_add_u32 m0, s17, 81920
    s_add_u32 s52, s52, s18
    buffer_load_dwordx4 v21, s[12:15], s52 offen sc1 lds
L_p2_x7:
    v_mfma_f32_16x16x32_bf16 v[220:223], v[124:127], v[100:103], v[220:223]
    s_waitcnt vmcnt(7) lgkmcnt(0)
    s_barrier
    s_cmp_lt_u32 s40, 2
    s_cbranch_scc0 L_GU_s18
    v_cmp_gt_u32 vcc, 96, v0
    s_nop 0
    s_and_saveexec_b64 s[60:61], vcc
    v_lshlrev_b32 v2, 4, v0
    v_add_u32 v3, 147456, v2
    ds_read_b128 v[224:227], v3 offset:0
    ds_read_b128 v[228:231], v3 offset:1536
    ds_read_b128 v[232:235], v3 offset:3072
    ds_read_b128 v[236:239], v3 offset:4608
    s_mov_b64 exec, s[60:61]
L_GU_s18:
    v_mfma_f32_16x16x32_bf16 v[128:131], v[64:67], v[48:51], v[128:131]
    ds_read_b128 v[88:91], v15 offset:0
    v_mfma_f32_16x16x32_bf16 v[152:155], v[64:67], v[52:55], v[152:155]
    ds_read_b128 v[92:95], v15 offset:2048
    v_mfma_f32_16x16x32_bf16 v[176:179], v[64:67], v[56:59], v[176:179]
    ds_read_b128 v[96:99], v15 offset:4096
    v_mfma_f32_16x16x32_bf16 v[200:203], v[64:67], v[60:63], v[200:203]
    ds_read_b128 v[100:103], v15 offset:6144
    v_mfma_f32_16x16x32_bf16 v[132:135], v[68:71], v[48:51], v[132:135]
    ds_read_b64_tr_b16 v[104:105], v22 offset:24576
    v_mfma_f32_16x16x32_bf16 v[156:159], v[68:71], v[52:55], v[156:159]
    ds_read_b64_tr_b16 v[106:107], v22 offset:26112
    v_mfma_f32_16x16x32_bf16 v[180:183], v[68:71], v[56:59], v[180:183]
    ds_read_b64_tr_b16 v[108:109], v23 offset:24576
    v_mfma_f32_16x16x32_bf16 v[204:207], v[68:71], v[60:63], v[204:207]
    ds_read_b64_tr_b16 v[110:111], v23 offset:26112
    v_mfma_f32_16x16x32_bf16 v[136:139], v[72:75], v[48:51], v[136:139]
    ds_read_b64_tr_b16 v[112:113], v24 offset:24576
    v_mfma_f32_16x16x32_bf16 v[160:163], v[72:75], v[52:55], v[160:163]
    ds_read_b64_tr_b16 v[114:115], v24 offset:26112
    v_mfma_f32_16x16x32_bf16 v[184:187], v[72:75], v[56:59], v[184:187]
    ds_read_b64_tr_b16 v[116:117], v22 offset:36864
    v_mfma_f32_16x16x32_bf16 v[208:211], v[72:75], v[60:63], v[208:211]
    ds_read_b64_tr_b16 v[118:119], v22 offset:38400
    v_mfma_f32_16x16x32_bf16 v[140:143], v[76:79], v[48:51], v[140:143]
    ds_read_b64_tr_b16 v[120:121], v23 offset:36864
    v_mfma_f32_16x16x32_bf16 v[164:167], v[76:79], v[52:55], v[164:167]
    ds_read_b64_tr_b16 v[122:123], v23 offset:38400
    v_mfma_f32_16x16x32_bf16 v[188:191], v[76:79], v[56:59], v[188:191]
    ds_read_b64_tr_b16 v[124:125], v24 offset:36864
    v_mfma_f32_16x16x32_bf16 v[212:215], v[76:79], v[60:63], v[212:215]
    ds_read_b64_tr_b16 v[126:127], v24 offset:38400
    v_mfma_f32_16x16x32_bf16 v[144:147], v[80:83], v[48:51], v[144:147]
    v_mfma_f32_16x16x32_bf16 v[168:171], v[80:83], v[52:55], v[168:171]
    v_mfma_f32_16x16x32_bf16 v[192:195], v[80:83], v[56:59], v[192:195]
    s_add_u32 m0, s16, 92160
    s_add_u32 s52, s3, 71680
    s_cmp_eq_u32 s19, 0
    buffer_load_dwordx4 v21, s[12:15], s52 offen sc1 lds
    s_cbranch_scc1 L_p2_x8
    s_add_u32 m0, s17, 92160
    s_add_u32 s52, s52, s18
    buffer_load_dwordx4 v21, s[12:15], s52 offen sc1 lds
L_p2_x8:
    v_mfma_f32_16x16x32_bf16 v[216:219], v[80:83], v[60:63], v[216:219]
    v_mfma_f32_16x16x32_bf16 v[148:151], v[84:87], v[48:51], v[148:151]
    s_add_u32 m0, s16, 102400
    s_add_u32 s52, s3, 81920
    s_cmp_eq_u32 s19, 0
    buffer_load_dwordx4 v21, s[12:15], s52 offen sc1 lds
    s_cbranch_scc1 L_p2_x9
    s_add_u32 m0, s17, 102400
    s_add_u32 s52, s52, s18
    buffer_load_dwordx4 v21, s[12:15], s52 offen sc1 lds
L_p2_x9:
    v_mfma_f32_16x16x32_bf16 v[172:175], v[84:87], v[52:55], v[172:175]
    v_mfma_f32_16x16x32_bf16 v[196:199], v[84:87], v[56:59], v[196:199]
    s_add_u32 m0, s16, 112640
    s_add_u32 s52, s3, 92160
    s_cmp_eq_u32 s19, 0
    buffer_load_dwordx4 v21, s[12:15], s52 offen sc1 lds
    s_cbranch_scc1 L_p2_x10
    s_add_u32 m0, s17, 112640
    s_add_u32 s52, s52, s18
    buffer_load_dwordx4 v21, s[12:15], s52 offen sc1 lds
L_p2_x10:
    v_mfma_f32_16x16x32_bf16 v[220:223], v[84:87], v[60:63], v[220:223]
    s_cmp_lt_u32 s40, 2
    s_cbranch_scc0 L_GU_e18a
    s_and_saveexec_b64 s[60:61], vcc
    s_waitcnt lgkmcnt(0)
    v_add_f32 v224, v224, v228
    v_add_f32 v225, v225, v229
    v_add_f32 v226, v226, v230
    v_add_f32 v227, v227, v231
    v_add_f32 v224, v224, v232
    v_add_f32 v225, v225, v233
    v_add_f32 v226, v226, v234
    v_add_f32 v227, v227, v235
    v_add_f32 v224, v224, v236
    v_add_f32 v225, v225, v237
    v_add_f32 v226, v226, v238
    v_add_f32 v227, v227, v239
    ds_write_b128 v3, v[224:227] offset:12288
    s_mov_b64 exec, s[60:61]
L_GU_e18a:
    s_cmp_ge_u32 s40, 6
    s_cbranch_scc0 L_GU_e18b
    s_waitcnt vmcnt(10)
    ds_write_b32 v30, v240
    ds_write_b32 v30, v241 offset:512
L_GU_e18b:
    s_waitcnt lgkmcnt(0)
    s_barrier
    v_and_b32 v2, 15, v1
    s_lshl_b32 s60, s45, 8
    s_add_u32 s60, s60, 161280
    v_lshl_add_u32 v2, v2, 2, s60
    v_mfma_f32_16x16x32_bf16 v[128:131], v[104:107], v[88:91], v[128:131]
    ds_read_b128 v[48:51], v31
    ds_read_b128 v[60:63], v31 offset:768
    ds_read_b128 v[52:55], v32
    v_mfma_f32_16x16x32_bf16 v[152:155], v[104:107], v[92:95], v[152:155]
    ds_read_b128 v[64:67], v32 offset:768
    ds_read_b128 v[56:59], v33
    ds_read_b128 v[68:71], v33 offset:768
    v_mfma_f32_16x16x32_bf16 v[176:179], v[104:107], v[96:99], v[176:179]
    ds_read_b32 v72, v2 offset:0
    ds_read_b32 v80, v2 offset:512
    ds_read_b32 v74, v2 offset:64
    s_add_u32 m0, s16, 0
    s_add_u32 s52, s3, 102400
    s_cmp_eq_u32 s19, 0
    buffer_load_dwordx4 v21, s[12:15], s52 offen sc1 lds
    s_cbranch_scc1 L_p2_x11
    s_add_u32 m0, s17, 0
    s_add_u32 s52, s52, s18
    buffer_load_dwordx4 v21, s[12:15], s52 offen sc1 lds
L_p2_x11:
    v_mfma_f32_16x16x32_bf16 v[200:203], v[104:107], v[100:103], v[200:203]
    ds_read_b32 v82, v2 offset:576
    ds_read_b32 v76, v2 offset:128
    ds_read_b32 v84, v2 offset:640
    v_mfma_f32_16x16x32_bf16 v[132:135], v[108:111], v[88:91], v[132:135]
    ds_read_b32 v78, v2 offset:192
    ds_read_b32 v86, v2 offset:704
    s_lshl_b32 s60, s41, 1
    v_mfma_f32_16x16x32_bf16 v[156:159], v[108:111], v[92:95], v[156:159]
    s_add_u32 s60, s60, s45
    s_mul_i32 s60, s60, 303104
    v_mfma_f32_16x16x32_bf16 v[180:183], v[108:111], v[96:99], v[180:183]
    s_lshl_b32 s61, s42, 14
    s_lshl_b32 s62, s46, 12
    s_add_u32 m0, s16, 10240
    s_add_u32 s52, s3, 112640
    s_cmp_eq_u32 s19, 0
    buffer_load_dwordx4 v21, s[12:15], s52 offen sc1 lds
    s_cbranch_scc1 L_p2_x12
    s_add_u32 m0, s17, 10240
    s_add_u32 s52, s52, s18
    buffer_load_dwordx4 v21, s[12:15], s52 offen sc1 lds
L_p2_x12:
    v_mfma_f32_16x16x32_bf16 v[204:207], v[108:111], v[100:103], v[204:207]
    s_add_u32 s65, s60, s61
    s_add_u32 s65, s65, s62
    v_mfma_f32_16x16x32_bf16 v[136:139], v[112:115], v[88:91], v[136:139]
    s_lshl_b32 s61, s42, 13
    s_add_u32 s66, s60, s61
    v_mfma_f32_16x16x32_bf16 v[160:163], v[112:115], v[92:95], v[160:163]
    s_add_u32 s66, s66, 147456
    s_lshr_b32 s61, s46, 1
    v_mfma_f32_16x16x32_bf16 v[184:187], v[112:115], v[96:99], v[184:187]
    s_lshl_b32 s61, s61, 12
    s_add_u32 s66, s66, s61
    v_mfma_f32_16x16x32_bf16 v[208:211], v[112:115], v[100:103], v[208:211]
    s_and_b32 s61, s46, 1
    s_lshl_b32 s61, s61, 11
    v_mfma_f32_16x16x32_bf16 v[140:143], v[116:119], v[88:91], v[140:143]
    s_add_u32 s66, s66, s61
    v_lshlrev_b32 v3, 4, v1
    v_mfma_f32_16x16x32_bf16 v[164:167], v[116:119], v[92:95], v[164:167]
    s_lshr_b32 s61, s40, 1
    s_lshl_b32 s61, s61, 12
    v_mfma_f32_16x16x32_bf16 v[188:191], v[116:119], v[96:99], v[188:191]
    s_add_u32 s61, s61, 122880
    s_and_b32 s62, s40, 1
    v_mfma_f32_16x16x32_bf16 v[212:215], v[116:119], v[100:103], v[212:215]
    s_lshl_b32 s63, s62, 3
    s_lshl_b32 s62, s62, 11
    v_mfma_f32_16x16x32_bf16 v[144:147], v[120:123], v[88:91], v[144:147]
    s_add_u32 s63, s63, s61
    s_add_u32 s61, s61, s62
    v_mfma_f32_16x16x32_bf16 v[168:171], v[120:123], v[92:95], v[168:171]
    v_add_u32 v4, s63, v3
    v_add_u32 v5, s61, v3
    v_mfma_f32_16x16x32_bf16 v[192:195], v[120:123], v[96:99], v[192:195]
    s_lshl_b32 s82, s41, 7
    s_lshl_b32 s61, s42, 3
    v_mfma_f32_16x16x32_bf16 v[216:219], v[120:123], v[100:103], v[216:219]
    s_add_u32 s82, s82, s61
    s_add_u32 s82, s82, 16916480
    v_mfma_f32_16x16x32_bf16 v[148:151], v[124:127], v[88:91], v[148:151]
    v_mfma_f32_16x16x32_bf16 v[172:175], v[124:127], v[92:95], v[172:175]
    v_mfma_f32_16x16x32_bf16 v[196:199], v[124:127], v[96:99], v[196:199]
    v_mfma_f32_16x16x32_bf16 v[220:223], v[124:127], v[100:103], v[220:223]
L_GU_ch0:
    s_waitcnt lgkmcnt(0)
    v_mul_f32 v80, v80, v80
    v_mul_f32 v82, v82, v82
    v_mul_f32 v84, v84, v84
    v_mul_f32 v86, v86, v86
    v_fmac_f32 v136, v72, v56
    v_fmac_f32 v148, v72, v68
    v_fmac_f32 v137, v72, v57
    v_fmac_f32 v149, v72, v69
    v_fmac_f32 v138, v72, v58
    v_fmac_f32 v150, v72, v70
    v_fmac_f32 v139, v72, v59
    v_fmac_f32 v151, v72, v71
    v_max_f32 v136, 0, v136
    v_mul_f32 v148, v148, v80
    v_max_f32 v137, 0, v137
    v_mul_f32 v149, v149, v80
    v_max_f32 v138, 0, v138
    v_mul_f32 v150, v150, v80
    v_max_f32 v139, 0, v139
    v_mul_f32 v151, v151, v80
    v_mul_f32 v136, v136, v148
    v_mul_f32 v137, v137, v149
    v_mul_f32 v138, v138, v150
    v_mul_f32 v139, v139, v151
    v_cvt_pk_bf16_f32 v228, v136, v137
    v_cvt_pk_bf16_f32 v229, v138, v139
    ds_write_b64 v4, v[228:229] offset:0
    v_fmac_f32 v160, v74, v56
    v_fmac_f32 v172, v74, v68
    v_fmac_f32 v161, v74, v57
    v_fmac_f32 v173, v74, v69
    v_fmac_f32 v162, v74, v58
    v_fmac_f32 v174, v74, v70
    v_fmac_f32 v163, v74, v59
    v_fmac_f32 v175, v74, v71
    v_max_f32 v160, 0, v160
    v_mul_f32 v172, v172, v82
    v_max_f32 v161, 0, v161
    v_mul_f32 v173, v173, v82
    v_max_f32 v162, 0, v162
    v_mul_f32 v174, v174, v82
    v_max_f32 v163, 0, v163
    v_mul_f32 v175, v175, v82
    v_mul_f32 v160, v160, v172
    v_mul_f32 v161, v161, v173
    v_mul_f32 v162, v162, v174
    v_mul_f32 v163, v163, v175
    v_cvt_pk_bf16_f32 v236, v160, v161
    v_cvt_pk_bf16_f32 v237, v162, v163
    ds_write_b64 v4, v[236:237] offset:1024
    v_fmac_f32 v184, v76, v56
    v_fmac_f32 v196, v76, v68
    v_fmac_f32 v185, v76, v57
    v_fmac_f32 v197, v76, v69
    v_fmac_f32 v186, v76, v58
    v_fmac_f32 v198, v76, v70
    v_fmac_f32 v187, v76, v59
    v_fmac_f32 v199, v76, v71
    v_max_f32 v184, 0, v184
    v_mul_f32 v196, v196, v84
    v_max_f32 v185, 0, v185
    v_mul_f32 v197, v197, v84
    v_max_f32 v186, 0, v186
    v_mul_f32 v198, v198, v84
    v_max_f32 v187, 0, v187
    v_mul_f32 v199, v199, v84
    v_mul_f32 v184, v184, v196
    v_mul_f32 v185, v185, v197
    v_mul_f32 v186, v186, v198
    v_mul_f32 v187, v187, v199
    v_cvt_pk_bf16_f32 v228, v184, v185
    v_cvt_pk_bf16_f32 v229, v186, v187
    ds_write_b64 v4, v[228:229] offset:2048
    v_fmac_f32 v208, v78, v56
    v_fmac_f32 v220, v78, v68
    v_fmac_f32 v209, v78, v57
    v_fmac_f32 v221, v78, v69
    v_fmac_f32 v210, v78, v58
    v_fmac_f32 v222, v78, v70
    v_fmac_f32 v211, v78, v59
    v_fmac_f32 v223, v78, v71
    v_max_f32 v208, 0, v208
    v_mul_f32 v220, v220, v86
    v_max_f32 v209, 0, v209
    v_mul_f32 v221, v221, v86
    v_max_f32 v210, 0, v210
    v_mul_f32 v222, v222, v86
    v_max_f32 v211, 0, v211
    v_mul_f32 v223, v223, v86
    v_mul_f32 v208, v208, v220
    v_mul_f32 v209, v209, v221
    v_mul_f32 v210, v210, v222
    v_mul_f32 v211, v211, v223
    v_cvt_pk_bf16_f32 v236, v208, v209
    v_cvt_pk_bf16_f32 v237, v210, v211
    ds_write_b64 v4, v[236:237] offset:3072
    v_fmac_f32 v128, v72, v48
    v_fmac_f32 v140, v72, v60
    v_fmac_f32 v129, v72, v49
    v_fmac_f32 v141, v72, v61
    v_fmac_f32 v130, v72, v50
    v_fmac_f32 v142, v72, v62
    v_fmac_f32 v131, v72, v51
    v_fmac_f32 v143, v72, v63
    v_max_f32 v128, 0, v128
    v_mul_f32 v140, v140, v80
    v_max_f32 v129, 0, v129
    v_mul_f32 v141, v141, v80
    v_max_f32 v130, 0, v130
    v_mul_f32 v142, v142, v80
    v_max_f32 v131, 0, v131
    v_mul_f32 v143, v143, v80
    v_mul_f32 v128, v128, v140
    v_mul_f32 v129, v129, v141
    v_mul_f32 v130, v130, v142
    v_mul_f32 v131, v131, v143
    v_cvt_pk_bf16_f32 v224, v128, v129
    v_cvt_pk_bf16_f32 v225, v130, v131
    v_fmac_f32 v132, v72, v52
    v_fmac_f32 v144, v72, v64
    v_fmac_f32 v133, v72, v53
    v_fmac_f32 v145, v72, v65
    v_fmac_f32 v134, v72, v54
    v_fmac_f32 v146, v72, v66
    v_fmac_f32 v135, v72, v55
    v_fmac_f32 v147, v72, v67
    v_max_f32 v132, 0, v132
    v_mul_f32 v144, v144, v80
    v_max_f32 v133, 0, v133
    v_mul_f32 v145, v145, v80
    v_max_f32 v134, 0, v134
    v_mul_f32 v146, v146, v80
    v_max_f32 v135, 0, v135
    v_mul_f32 v147, v147, v80
    v_mul_f32 v132, v132, v144
    v_mul_f32 v133, v133, v145
    v_mul_f32 v134, v134, v146
    v_mul_f32 v135, v135, v147
    v_cvt_pk_bf16_f32 v226, v132, v133
    v_cvt_pk_bf16_f32 v227, v134, v135
    buffer_store_dwordx4 v[224:227], v3, s[12:15], s65 offen offset:0 sc1
    v_fmac_f32 v152, v74, v48
    v_fmac_f32 v164, v74, v60
    v_fmac_f32 v153, v74, v49
    v_fmac_f32 v165, v74, v61
    v_fmac_f32 v154, v74, v50
    v_fmac_f32 v166, v74, v62
    v_fmac_f32 v155, v74, v51
    v_fmac_f32 v167, v74, v63
    v_max_f32 v152, 0, v152
    v_mul_f32 v164, v164, v82
    v_max_f32 v153, 0, v153
    v_mul_f32 v165, v165, v82
    v_max_f32 v154, 0, v154
    v_mul_f32 v166, v166, v82
    v_max_f32 v155, 0, v155
    v_mul_f32 v167, v167, v82
    v_mul_f32 v152, v152, v164
    v_mul_f32 v153, v153, v165
    v_mul_f32 v154, v154, v166
    v_mul_f32 v155, v155, v167
    v_cvt_pk_bf16_f32 v232, v152, v153
    v_cvt_pk_bf16_f32 v233, v154, v155
    v_fmac_f32 v156, v74, v52
    v_fmac_f32 v168, v74, v64
    v_fmac_f32 v157, v74, v53
    v_fmac_f32 v169, v74, v65
    v_fmac_f32 v158, v74, v54
    v_fmac_f32 v170, v74, v66
    v_fmac_f32 v159, v74, v55
    v_fmac_f32 v171, v74, v67
    v_max_f32 v156, 0, v156
    v_mul_f32 v168, v168, v82
    v_max_f32 v157, 0, v157
    v_mul_f32 v169, v169, v82
    v_max_f32 v158, 0, v158
    v_mul_f32 v170, v170, v82
    v_max_f32 v159, 0, v159
    v_mul_f32 v171, v171, v82
    v_mul_f32 v156, v156, v168
    v_mul_f32 v157, v157, v169
    v_mul_f32 v158, v158, v170
    v_mul_f32 v159, v159, v171
    v_cvt_pk_bf16_f32 v234, v156, v157
    v_cvt_pk_bf16_f32 v235, v158, v159
    buffer_store_dwordx4 v[232:235], v3, s[12:15], s65 offen offset:1024 sc1
    v_fmac_f32 v176, v76, v48
    v_fmac_f32 v188, v76, v60
    v_fmac_f32 v177, v76, v49
    v_fmac_f32 v189, v76, v61
    v_fmac_f32 v178, v76, v50
    v_fmac_f32 v190, v76, v62
    v_fmac_f32 v179, v76, v51
    v_fmac_f32 v191, v76, v63
    v_max_f32 v176, 0, v176
    v_mul_f32 v188, v188, v84
    v_max_f32 v177, 0, v177
    v_mul_f32 v189, v189, v84
    v_max_f32 v178, 0, v178
    v_mul_f32 v190, v190, v84
    v_max_f32 v179, 0, v179
    v_mul_f32 v191, v191, v84
    v_mul_f32 v176, v176, v188
    v_mul_f32 v177, v177, v189
    v_mul_f32 v178, v178, v190
    v_mul_f32 v179, v179, v191
    v_cvt_pk_bf16_f32 v224, v176, v177
    v_cvt_pk_bf16_f32 v225, v178, v179
    v_fmac_f32 v180, v76, v52
    v_fmac_f32 v192, v76, v64
    v_fmac_f32 v181, v76, v53
    v_fmac_f32 v193, v76, v65
    v_fmac_f32 v182, v76, v54
    v_fmac_f32 v194, v76, v66
    v_fmac_f32 v183, v76, v55
    v_fmac_f32 v195, v76, v67
    v_max_f32 v180, 0, v180
    v_mul_f32 v192, v192, v84
    v_max_f32 v181, 0, v181
    v_mul_f32 v193, v193, v84
    v_max_f32 v182, 0, v182
    v_mul_f32 v194, v194, v84
    v_max_f32 v183, 0, v183
    v_mul_f32 v195, v195, v84
    v_mul_f32 v180, v180, v192
    v_mul_f32 v181, v181, v193
    v_mul_f32 v182, v182, v194
    v_mul_f32 v183, v183, v195
    v_cvt_pk_bf16_f32 v226, v180, v181
    v_cvt_pk_bf16_f32 v227, v182, v183
    s_waitcnt lgkmcnt(0)
    s_barrier
    ds_read_b128 v[240:243], v5
    ds_read_b128 v[244:247], v5 offset:1024
    buffer_store_dwordx4 v[224:227], v3, s[12:15], s65 offen offset:2048 sc1
    v_fmac_f32 v200, v78, v48
    v_fmac_f32 v212, v78, v60
    v_fmac_f32 v201, v78, v49
    v_fmac_f32 v213, v78, v61
    v_fmac_f32 v202, v78, v50
    v_fmac_f32 v214, v78, v62
    v_fmac_f32 v203, v78, v51
    v_fmac_f32 v215, v78, v63
    v_max_f32 v200, 0, v200
    v_mul_f32 v212, v212, v86
    v_max_f32 v201, 0, v201
    v_mul_f32 v213, v213, v86
    v_max_f32 v202, 0, v202
    v_mul_f32 v214, v214, v86
    v_max_f32 v203, 0, v203
    v_mul_f32 v215, v215, v86
    v_mul_f32 v200, v200, v212
    v_mul_f32 v201, v201, v213
    v_mul_f32 v202, v202, v214
    v_mul_f32 v203, v203, v215
    v_cvt_pk_bf16_f32 v232, v200, v201
    v_cvt_pk_bf16_f32 v233, v202, v203
    v_fmac_f32 v204, v78, v52
    v_fmac_f32 v216, v78, v64
    v_fmac_f32 v205, v78, v53
    v_fmac_f32 v217, v78, v65
    v_fmac_f32 v206, v78, v54
    v_fmac_f32 v218, v78, v66
    v_fmac_f32 v207, v78, v55
    v_fmac_f32 v219, v78, v67
    v_max_f32 v204, 0, v204
    v_mul_f32 v216, v216, v86
    v_max_f32 v205, 0, v205
    v_mul_f32 v217, v217, v86
    v_max_f32 v206, 0, v206
    v_mul_f32 v218, v218, v86
    v_max_f32 v207, 0, v207
    v_mul_f32 v219, v219, v86
    v_mul_f32 v204, v204, v216
    v_mul_f32 v205, v205, v217
    v_mul_f32 v206, v206, v218
    v_mul_f32 v207, v207, v219
    v_cvt_pk_bf16_f32 v234, v204, v205
    v_cvt_pk_bf16_f32 v235, v206, v207
    buffer_store_dwordx4 v[232:235], v3, s[12:15], s65 offen offset:3072 sc1
    s_waitcnt lgkmcnt(0)
    buffer_store_dwordx4 v[240:243], v3, s[12:15], s66 offen sc1
    buffer_store_dwordx4 v[244:247], v3, s[12:15], s66 offen offset:1024 sc1
    s_branch L_pub
L_Q:
    s_mul_i32 s61, s46, 160
    s_add_u32 s62, s61, 0
    v_lshl_add_u32 v2, v8, 3, s62
    v_cmp_le_u32 vcc, 384, v2
    v_subrev_u32 v3, 384, v2
    s_nop 0
    v_cndmask_b32 v3, v2, v3, vcc
    v_cndmask_b32 v4, 0, v7, vcc
    v_lshrrev_b32 v16, 5, v3
    v_xor_b32 v16, v16, v6
    v_lshlrev_b32 v16, 5, v16
    v_and_b32 v3, 31, v3
    v_add3_u32 v16, v16, v3, v5
    v_add_u32 v16, v16, v4
    s_add_u32 s62, s61, 0
    v_lshl_add_u32 v2, v9, 3, s62
    v_lshlrev_b32 v2, 1, v2
    v_add_u32 v31, 159744, v2
    s_add_u32 s62, s61, 40
    v_lshl_add_u32 v2, v8, 3, s62
    v_cmp_le_u32 vcc, 384, v2
    v_subrev_u32 v3, 384, v2
    s_nop 0
    v_cndmask_b32 v3, v2, v3, vcc
    v_cndmask_b32 v4, 0, v7, vcc
    v_lshrrev_b32 v17, 5, v3
    v_xor_b32 v17, v17, v6
    v_lshlrev_b32 v17, 5, v17
    v_and_b32 v3, 31, v3
    v_add3_u32 v17, v17, v3, v5
    v_add_u32 v17, v17, v4
    s_add_u32 s62, s61, 40
    v_lshl_add_u32 v2, v9, 3, s62
    v_lshlrev_b32 v2, 1, v2
    v_add_u32 v32, 159744, v2
    s_add_u32 s62, s61, 80
    v_lshl_add_u32 v2, v8, 3, s62
    v_cmp_le_u32 vcc, 384, v2
    v_subrev_u32 v3, 384, v2
    s_nop 0
    v_cndmask_b32 v3, v2, v3, vcc
    v_cndmask_b32 v4, 0, v7, vcc
    v_lshrrev_b32 v18, 5, v3
    v_xor_b32 v18, v18, v6
    v_lshlrev_b32 v18, 5, v18
    v_and_b32 v3, 31, v3
    v_add3_u32 v18, v18, v3, v5
    v_add_u32 v18, v18, v4
    s_add_u32 s62, s61, 80
    v_lshl_add_u32 v2, v9, 3, s62
    v_lshlrev_b32 v2, 1, v2
    v_add_u32 v33, 159744, v2
    s_add_u32 s62, s61, 120
    v_lshl_add_u32 v2, v8, 3, s62
    v_cmp_le_u32 vcc, 384, v2
    v_subrev_u32 v3, 384, v2
    s_nop 0
    v_cndmask_b32 v3, v2, v3, vcc
    v_cndmask_b32 v4, 0, v7, vcc
    v_lshrrev_b32 v19, 5, v3
    v_xor_b32 v19, v19, v6
    v_lshlrev_b32 v19, 5, v19
    v_and_b32 v3, 31, v3
    v_add3_u32 v19, v19, v3, v5
    v_add_u32 v19, v19, v4
    s_add_u32 s62, s61, 120
    v_lshl_add_u32 v2, v9, 3, s62
    v_lshlrev_b32 v2, 1, v2
    v_add_u32 v34, 159744, v2
    s_add_u32 s62, s61, 32
    v_mul_u32_u24 v2, 40, v8
    v_add_u32 v2, s62, v2
    v_cmp_le_u32 vcc, 384, v2
    v_subrev_u32 v3, 384, v2
    s_nop 0
    v_cndmask_b32 v3, v2, v3, vcc
    v_cndmask_b32 v4, 0, v7, vcc
    v_lshrrev_b32 v20, 5, v3
    v_xor_b32 v20, v20, v6
    v_lshlrev_b32 v20, 5, v20
    v_and_b32 v3, 31, v3
    v_add3_u32 v20, v20, v3, v5
    v_add_u32 v20, v20, v4
    s_add_u32 s62, s61, 32
    v_mul_u32_u24 v2, 40, v9
    v_add_u32 v2, s62, v2
    v_lshlrev_b32 v2, 1, v2
    v_add_u32 v35, 159744, v2
    v_add_u32 v22, 49152, v16
    v_add_u32 v23, 49152, v17
    v_add_u32 v24, 49152, v18
    v_add_u32 v25, 49152, v19
    v_add_u32 v26, 49152, v20
    s_waitcnt vmcnt(8)
    s_barrier
    ds_read_b128 v[48:51], v14 offset:0
    ds_read_b128 v[52:55], v14 offset:2048
    ds_read_b128 v[56:59], v14 offset:4096
    ds_read_b128 v[60:63], v14 offset:6144
    ds_read_b64_tr_b16 v[64:65], v16 offset:0
    ds_read_b64_tr_b16 v[66:67], v16 offset:1536
    ds_read_b64_tr_b16 v[68:69], v17 offset:0
    ds_read_b64_tr_b16 v[70:71], v17 offset:1536
    ds_read_b64_tr_b16 v[72:73], v18 offset:0
    ds_read_b64_tr_b16 v[74:75], v18 offset:1536
    ds_read_b64_tr_b16 v[76:77], v19 offset:0
    ds_read_b64_tr_b16 v[78:79], v19 offset:1536
    ds_read_b64_tr_b16 v[80:81], v20 offset:0
    ds_read_b64_tr_b16 v[82:83], v20 offset:1536
    s_add_u32 m0, s58, 73728
    s_nop 0
    buffer_load_dwordx4 v11, s[8:11], s50 offen lds
    s_add_u32 m0, s58, 74752
    s_nop 0
    buffer_load_dwordx4 v12, s[8:11], s50 offen lds
    s_add_u32 m0, s58, 75776
    s_nop 0
    buffer_load_dwordx4 v13, s[8:11], s50 offen lds
    s_add_u32 s50, s50, s55
    s_lshl_b32 s71, s43, 7
    s_mov_b32 s70, s71
    s_mov_b32 exec_hi, 0xffff
    buffer_load_dwordx4 v[228:231], v27, s[8:11], s70 offen
    s_mov_b64 exec, -1
    s_waitcnt vmcnt(9) lgkmcnt(0)
    s_barrier
    v_mfma_f32_16x16x32_bf16 v[128:131], v[64:67], v[48:51], 0
    ds_read_b128 v[88:91], v15 offset:0
    s_add_u32 m0, s57, 32768
    s_movk_i32 s53, 256
    v_mfma_f32_16x16x32_bf16 v[152:155], v[64:67], v[52:55], 0
    ds_read_b128 v[92:95], v15 offset:2048
    buffer_load_dwordx4 v10, s[4:7], s53 offen lds
    v_mfma_f32_16x16x32_bf16 v[176:179], v[64:67], v[56:59], 0
    ds_read_b128 v[96:99], v15 offset:4096
    s_add_u32 m0, s57, 33792
    s_movk_i32 s56, 10496
    v_mfma_f32_16x16x32_bf16 v[200:203], v[64:67], v[60:63], 0
    ds_read_b128 v[100:103], v15 offset:6144
    buffer_load_dwordx4 v10, s[4:7], s56 offen lds
    v_mfma_f32_16x16x32_bf16 v[132:135], v[68:71], v[48:51], 0
    ds_read_b64_tr_b16 v[104:105], v16 offset:24576
    s_add_u32 m0, s58, 0
    v_mfma_f32_16x16x32_bf16 v[156:159], v[68:71], v[52:55], 0
    ds_read_b64_tr_b16 v[106:107], v16 offset:26112
    buffer_load_dwordx4 v11, s[8:11], s50 offen lds
    v_mfma_f32_16x16x32_bf16 v[180:183], v[68:71], v[56:59], 0
    ds_read_b64_tr_b16 v[108:109], v17 offset:24576
    s_add_u32 m0, s58, 1024
    v_mfma_f32_16x16x32_bf16 v[204:207], v[68:71], v[60:63], 0
    ds_read_b64_tr_b16 v[110:111], v17 offset:26112
    buffer_load_dwordx4 v12, s[8:11], s50 offen lds
    v_mfma_f32_16x16x32_bf16 v[136:139], v[72:75], v[48:51], 0
    ds_read_b64_tr_b16 v[112:113], v18 offset:24576
    s_add_u32 m0, s58, 2048
    v_mfma_f32_16x16x32_bf16 v[160:163], v[72:75], v[52:55], 0
    ds_read_b64_tr_b16 v[114:115], v18 offset:26112
    buffer_load_dwordx4 v13, s[8:11], s50 offen lds
    s_add_u32 s50, s50, s55
    v_mfma_f32_16x16x32_bf16 v[184:187], v[72:75], v[56:59], 0
    ds_read_b64_tr_b16 v[116:117], v19 offset:24576
    v_mfma_f32_16x16x32_bf16 v[208:211], v[72:75], v[60:63], 0
    ds_read_b64_tr_b16 v[118:119], v19 offset:26112
    v_mfma_f32_16x16x32_bf16 v[140:143], v[76:79], v[48:51], 0
    ds_read_b64_tr_b16 v[120:121], v20 offset:24576
    v_mfma_f32_16x16x32_bf16 v[164:167], v[76:79], v[52:55], 0
    ds_read_b64_tr_b16 v[122:123], v20 offset:26112
    v_mfma_f32_16x16x32_bf16 v[188:191], v[76:79], v[56:59], 0
    v_mfma_f32_16x16x32_bf16 v[212:215], v[76:79], v[60:63], 0
    v_mfma_f32_16x16x32_bf16 v[144:147], v[80:83], v[48:51], 0
    v_mfma_f32_16x16x32_bf16 v[168:171], v[80:83], v[52:55], 0
    v_mfma_f32_16x16x32_bf16 v[192:195], v[80:83], v[56:59], 0
    v_mfma_f32_16x16x32_bf16 v[216:219], v[80:83], v[60:63], 0
    s_add_u32 s70, s70, s71
    s_mov_b32 exec_hi, 0xffff
    buffer_load_dwordx4 v[232:235], v27, s[8:11], s70 offen
    s_mov_b64 exec, -1
    s_waitcnt vmcnt(10) lgkmcnt(0)
    s_barrier
    v_mfma_f32_16x16x32_bf16 v[128:131], v[104:107], v[88:91], v[128:131]
    ds_read_b128 v[48:51], v14 offset:16384
    v_mfma_f32_16x16x32_bf16 v[152:155], v[104:107], v[92:95], v[152:155]
    ds_read_b128 v[52:55], v14 offset:18432
    v_mfma_f32_16x16x32_bf16 v[176:179], v[104:107], v[96:99], v[176:179]
    ds_read_b128 v[56:59], v14 offset:20480
    v_mfma_f32_16x16x32_bf16 v[200:203], v[104:107], v[100:103], v[200:203]
    ds_read_b128 v[60:63], v14 offset:22528
    v_mfma_f32_16x16x32_bf16 v[132:135], v[108:111], v[88:91], v[132:135]
    ds_read_b64_tr_b16 v[64:65], v22 offset:0
    v_mfma_f32_16x16x32_bf16 v[156:159], v[108:111], v[92:95], v[156:159]
    ds_read_b64_tr_b16 v[66:67], v22 offset:1536
    v_mfma_f32_16x16x32_bf16 v[180:183], v[108:111], v[96:99], v[180:183]
    ds_read_b64_tr_b16 v[68:69], v23 offset:0
    v_mfma_f32_16x16x32_bf16 v[204:207], v[108:111], v[100:103], v[204:207]
    ds_read_b64_tr_b16 v[70:71], v23 offset:1536
    v_mfma_f32_16x16x32_bf16 v[136:139], v[112:115], v[88:91], v[136:139]
    ds_read_b64_tr_b16 v[72:73], v24 offset:0
    v_mfma_f32_16x16x32_bf16 v[160:163], v[112:115], v[92:95], v[160:163]
    ds_read_b64_tr_b16 v[74:75], v24 offset:1536
    s_add_u32 m0, s58, 24576
    v_mfma_f32_16x16x32_bf16 v[184:187], v[112:115], v[96:99], v[184:187]
    ds_read_b64_tr_b16 v[76:77], v25 offset:0
    buffer_load_dwordx4 v11, s[8:11], s50 offen lds
    v_mfma_f32_16x16x32_bf16 v[208:211], v[112:115], v[100:103], v[208:211]
    ds_read_b64_tr_b16 v[78:79], v25 offset:1536
    s_add_u32 m0, s58, 25600
    v_mfma_f32_16x16x32_bf16 v[140:143], v[116:119], v[88:91], v[140:143]
    ds_read_b64_tr_b16 v[80:81], v26 offset:0
    buffer_load_dwordx4 v12, s[8:11], s50 offen lds
    v_mfma_f32_16x16x32_bf16 v[164:167], v[116:119], v[92:95], v[164:167]
    ds_read_b64_tr_b16 v[82:83], v26 offset:1536
    s_add_u32 m0, s58, 26624
    v_mfma_f32_16x16x32_bf16 v[188:191], v[116:119], v[96:99], v[188:191]
    buffer_load_dwordx4 v13, s[8:11], s50 offen lds
    s_add_u32 s50, s50, s55
    v_mfma_f32_16x16x32_bf16 v[212:215], v[116:119], v[100:103], v[212:215]
    s_add_u32 m0, s57, 0
    s_movk_i32 s53, 384
    v_mfma_f32_16x16x32_bf16 v[144:147], v[120:123], v[88:91], v[144:147]
    buffer_load_dwordx4 v10, s[4:7], s53 offen lds
    v_mfma_f32_16x16x32_bf16 v[168:171], v[120:123], v[92:95], v[168:171]
    s_add_u32 m0, s57, 1024
    s_movk_i32 s56, 10624
    v_mfma_f32_16x16x32_bf16 v[192:195], v[120:123], v[96:99], v[192:195]
    buffer_load_dwordx4 v10, s[4:7], s56 offen lds
    v_mfma_f32_16x16x32_bf16 v[216:219], v[120:123], v[100:103], v[216:219]
    s_add_u32 s70, s70, s71
    s_mov_b32 exec_hi, 0xffff
    buffer_load_dwordx4 v[236:239], v27, s[8:11], s70 offen
    s_mov_b64 exec, -1
    s_waitcnt vmcnt(13) lgkmcnt(0)
    s_barrier
    v_mfma_f32_16x16x32_bf16 v[128:131], v[64:67], v[48:51], v[128:131]
    ds_read_b128 v[88:91], v15 offset:16384
    v_mfma_f32_16x16x32_bf16 v[152:155], v[64:67], v[52:55], v[152:155]
    ds_read_b128 v[92:95], v15 offset:18432
    v_mfma_f32_16x16x32_bf16 v[176:179], v[64:67], v[56:59], v[176:179]
    ds_read_b128 v[96:99], v15 offset:20480
    v_mfma_f32_16x16x32_bf16 v[200:203], v[64:67], v[60:63], v[200:203]
    ds_read_b128 v[100:103], v15 offset:22528
    v_mfma_f32_16x16x32_bf16 v[132:135], v[68:71], v[48:51], v[132:135]
    ds_read_b64_tr_b16 v[104:105], v22 offset:24576
    v_mfma_f32_16x16x32_bf16 v[156:159], v[68:71], v[52:55], v[156:159]
    ds_read_b64_tr_b16 v[106:107], v22 offset:26112
    v_mfma_f32_16x16x32_bf16 v[180:183], v[68:71], v[56:59], v[180:183]
    ds_read_b64_tr_b16 v[108:109], v23 offset:24576
    v_mfma_f32_16x16x32_bf16 v[204:207], v[68:71], v[60:63], v[204:207]
    ds_read_b64_tr_b16 v[110:111], v23 offset:26112
    v_mfma_f32_16x16x32_bf16 v[136:139], v[72:75], v[48:51], v[136:139]
    ds_read_b64_tr_b16 v[112:113], v24 offset:24576
    v_mfma_f32_16x16x32_bf16 v[160:163], v[72:75], v[52:55], v[160:163]
    ds_read_b64_tr_b16 v[114:115], v24 offset:26112
    v_mfma_f32_16x16x32_bf16 v[184:187], v[72:75], v[56:59], v[184:187]
    ds_read_b64_tr_b16 v[116:117], v25 offset:24576
    v_mfma_f32_16x16x32_bf16 v[208:211], v[72:75], v[60:63], v[208:211]
    ds_read_b64_tr_b16 v[118:119], v25 offset:26112
    v_mfma_f32_16x16x32_bf16 v[140:143], v[76:79], v[48:51], v[140:143]
    ds_read_b64_tr_b16 v[120:121], v26 offset:24576
    v_mfma_f32_16x16x32_bf16 v[164:167], v[76:79], v[52:55], v[164:167]
    ds_read_b64_tr_b16 v[122:123], v26 offset:26112
    s_add_u32 m0, s58, 49152
    v_mfma_f32_16x16x32_bf16 v[188:191], v[76:79], v[56:59], v[188:191]
    buffer_load_dwordx4 v11, s[8:11], s50 offen lds
    v_mfma_f32_16x16x32_bf16 v[212:215], v[76:79], v[60:63], v[212:215]
    s_add_u32 m0, s58, 50176
    v_mfma_f32_16x16x32_bf16 v[144:147], v[80:83], v[48:51], v[144:147]
    buffer_load_dwordx4 v12, s[8:11], s50 offen lds
    v_mfma_f32_16x16x32_bf16 v[168:171], v[80:83], v[52:55], v[168:171]
    s_add_u32 m0, s58, 51200
    v_mfma_f32_16x16x32_bf16 v[192:195], v[80:83], v[56:59], v[192:195]
    buffer_load_dwordx4 v13, s[8:11], s50 offen lds
    s_add_u32 s50, s50, s55
    v_mfma_f32_16x16x32_bf16 v[216:219], v[80:83], v[60:63], v[216:219]
    s_cmp_eq_u32 s64, 2
    s_cbranch_scc0 L_Q_ep2
    s_not_b64 s[78:79], s[76:77]
    s_sub_u32 s78, s78, 200
    s_subb_u32 s79, s79, 0
    s_mov_b64 exec, 1
    v_mov_b32 v42, s78
    v_mov_b32 v43, s79
    v_mov_b32 v44, 0
    global_atomic_umax_x2 v44, v[42:43], s[36:37] sc1
    s_mov_b64 exec, -1
L_Q_ep2:
    s_add_u32 s70, s70, s71
    s_mov_b32 exec_hi, 0xffff
    buffer_load_dwordx4 v[240:243], v27, s[8:11], s70 offen
    s_mov_b64 exec, -1
    s_waitcnt vmcnt(11) lgkmcnt(0)
    s_barrier
    v_mfma_f32_16x16x32_bf16 v[128:131], v[104:107], v[88:91], v[128:131]
    ds_read_b128 v[48:51], v14 offset:32768
    v_mfma_f32_16x16x32_bf16 v[152:155], v[104:107], v[92:95], v[152:155]
    ds_read_b128 v[52:55], v14 offset:34816
    v_mfma_f32_16x16x32_bf16 v[176:179], v[104:107], v[96:99], v[176:179]
    ds_read_b128 v[56:59], v14 offset:36864
    v_mfma_f32_16x16x32_bf16 v[200:203], v[104:107], v[100:103], v[200:203]
    ds_read_b128 v[60:63], v14 offset:38912
    v_mfma_f32_16x16x32_bf16 v[132:135], v[108:111], v[88:91], v[132:135]
    ds_read_b64_tr_b16 v[64:65], v16 offset:0
    v_mfma_f32_16x16x32_bf16 v[156:159], v[108:111], v[92:95], v[156:159]
    ds_read_b64_tr_b16 v[66:67], v16 offset:1536
    v_mfma_f32_16x16x32_bf16 v[180:183], v[108:111], v[96:99], v[180:183]
    ds_read_b64_tr_b16 v[68:69], v17 offset:0
    v_mfma_f32_16x16x32_bf16 v[204:207], v[108:111], v[100:103], v[204:207]
    ds_read_b64_tr_b16 v[70:71], v17 offset:1536
    v_mfma_f32_16x16x32_bf16 v[136:139], v[112:115], v[88:91], v[136:139]
    ds_read_b64_tr_b16 v[72:73], v18 offset:0
    v_mfma_f32_16x16x32_bf16 v[160:163], v[112:115], v[92:95], v[160:163]
    ds_read_b64_tr_b16 v[74:75], v18 offset:1536
    s_add_u32 m0, s58, 73728
    v_mfma_f32_16x16x32_bf16 v[184:187], v[112:115], v[96:99], v[184:187]
    ds_read_b64_tr_b16 v[76:77], v19 offset:0
    buffer_load_dwordx4 v11, s[8:11], s50 offen lds
    v_mfma_f32_16x16x32_bf16 v[208:211], v[112:115], v[100:103], v[208:211]
    ds_read_b64_tr_b16 v[78:79], v19 offset:1536
    s_add_u32 m0, s58, 74752
    v_mfma_f32_16x16x32_bf16 v[140:143], v[116:119], v[88:91], v[140:143]
    ds_read_b64_tr_b16 v[80:81], v20 offset:0
    buffer_load_dwordx4 v12, s[8:11], s50 offen lds
    v_mfma_f32_16x16x32_bf16 v[164:167], v[116:119], v[92:95], v[164:167]
    ds_read_b64_tr_b16 v[82:83], v20 offset:1536
    s_add_u32 m0, s58, 75776
    v_mfma_f32_16x16x32_bf16 v[188:191], v[116:119], v[96:99], v[188:191]
    buffer_load_dwordx4 v13, s[8:11], s50 offen lds
    s_add_u32 s50, s50, s55
    v_mfma_f32_16x16x32_bf16 v[212:215], v[116:119], v[100:103], v[212:215]
    s_add_u32 m0, s57, 16384
    s_movk_i32 s53, 512
    v_mfma_f32_16x16x32_bf16 v[144:147], v[120:123], v[88:91], v[144:147]
    buffer_load_dwordx4 v10, s[4:7], s53 offen lds
    v_mfma_f32_16x16x32_bf16 v[168:171], v[120:123], v[92:95], v[168:171]
    s_add_u32 m0, s57, 17408
    s_movk_i32 s56, 10752
    v_mfma_f32_16x16x32_bf16 v[192:195], v[120:123], v[96:99], v[192:195]
    buffer_load_dwordx4 v10, s[4:7], s56 offen lds
    v_mfma_f32_16x16x32_bf16 v[216:219], v[120:123], v[100:103], v[216:219]
    s_cmp_eq_u32 s64, 3
    s_cbranch_scc0 L_Q_ep3
    s_not_b64 s[78:79], s[76:77]
    s_sub_u32 s78, s78, 200
    s_subb_u32 s79, s79, 0
    s_mov_b64 exec, 1
    v_mov_b32 v42, s78
    v_mov_b32 v43, s79
    v_mov_b32 v44, 0
    global_atomic_umax_x2 v44, v[42:43], s[36:37] sc1
    s_mov_b64 exec, -1
L_Q_ep3:
    s_mov_b32 s70, 0
    s_mov_b32 exec_hi, 0xffff
    buffer_load_dwordx4 v[224:227], v27, s[8:11], s70 offen
    s_mov_b64 exec, -1
    s_waitcnt vmcnt(13) lgkmcnt(0)
    s_barrier
    v_mfma_f32_16x16x32_bf16 v[128:131], v[64:67], v[48:51], v[128:131]
    ds_read_b128 v[88:91], v15 offset:32768
    v_mfma_f32_16x16x32_bf16 v[152:155], v[64:67], v[52:55], v[152:155]
    ds_read_b128 v[92:95], v15 offset:34816
    v_mfma_f32_16x16x32_bf16 v[176:179], v[64:67], v[56:59], v[176:179]
    ds_read_b128 v[96:99], v15 offset:36864
    v_mfma_f32_16x16x32_bf16 v[200:203], v[64:67], v[60:63], v[200:203]
    ds_read_b128 v[100:103], v15 offset:38912
    v_mfma_f32_16x16x32_bf16 v[132:135], v[68:71], v[48:51], v[132:135]
    ds_read_b64_tr_b16 v[104:105], v16 offset:24576
    v_mfma_f32_16x16x32_bf16 v[156:159], v[68:71], v[52:55], v[156:159]
    ds_read_b64_tr_b16 v[106:107], v16 offset:26112
    v_mfma_f32_16x16x32_bf16 v[180:183], v[68:71], v[56:59], v[180:183]
    ds_read_b64_tr_b16 v[108:109], v17 offset:24576
    v_mfma_f32_16x16x32_bf16 v[204:207], v[68:71], v[60:63], v[204:207]
    ds_read_b64_tr_b16 v[110:111], v17 offset:26112
    v_mfma_f32_16x16x32_bf16 v[136:139], v[72:75], v[48:51], v[136:139]
    ds_read_b64_tr_b16 v[112:113], v18 offset:24576
    v_mfma_f32_16x16x32_bf16 v[160:163], v[72:75], v[52:55], v[160:163]
    ds_read_b64_tr_b16 v[114:115], v18 offset:26112
    v_mfma_f32_16x16x32_bf16 v[184:187], v[72:75], v[56:59], v[184:187]
    ds_read_b64_tr_b16 v[116:117], v19 offset:24576
    v_mfma_f32_16x16x32_bf16 v[208:211], v[72:75], v[60:63], v[208:211]
    ds_read_b64_tr_b16 v[118:119], v19 offset:26112
    v_mfma_f32_16x16x32_bf16 v[140:143], v[76:79], v[48:51], v[140:143]
    ds_read_b64_tr_b16 v[120:121], v20 offset:24576
    v_mfma_f32_16x16x32_bf16 v[164:167], v[76:79], v[52:55], v[164:167]
    ds_read_b64_tr_b16 v[122:123], v20 offset:26112
    s_add_u32 m0, s58, 0
    v_mfma_f32_16x16x32_bf16 v[188:191], v[76:79], v[56:59], v[188:191]
    buffer_load_dwordx4 v11, s[8:11], s50 offen lds
    v_mfma_f32_16x16x32_bf16 v[212:215], v[76:79], v[60:63], v[212:215]
    s_add_u32 m0, s58, 1024
    v_mfma_f32_16x16x32_bf16 v[144:147], v[80:83], v[48:51], v[144:147]
    buffer_load_dwordx4 v12, s[8:11], s50 offen lds
    v_mfma_f32_16x16x32_bf16 v[168:171], v[80:83], v[52:55], v[168:171]
    s_add_u32 m0, s58, 2048
    v_mfma_f32_16x16x32_bf16 v[192:195], v[80:83], v[56:59], v[192:195]
    buffer_load_dwordx4 v13, s[8:11], s50 offen lds
    s_add_u32 s50, s50, s55
    v_mfma_f32_16x16x32_bf16 v[216:219], v[80:83], v[60:63], v[216:219]
    s_cmp_eq_u32 s64, 4
    s_cbranch_scc0 L_Q_ep4
    s_not_b64 s[78:79], s[76:77]
    s_sub_u32 s78, s78, 200
    s_subb_u32 s79, s79, 0
    s_mov_b64 exec, 1
    v_mov_b32 v42, s78
    v_mov_b32 v43, s79
    v_mov_b32 v44, 0
    global_atomic_umax_x2 v44, v[42:43], s[36:37] sc1
    s_mov_b64 exec, -1
L_Q_ep4:
    s_waitcnt vmcnt(10) lgkmcnt(0)
    s_barrier
    v_mfma_f32_16x16x32_bf16 v[128:131], v[104:107], v[88:91], v[128:131]
    ds_read_b128 v[48:51], v14 offset:0
    v_lshlrev_b32 v244, 16, v228
    v_and_b32 v245, s73, v228
    v_lshlrev_b32 v246, 16, v229
    v_mfma_f32_16x16x32_bf16 v[152:155], v[104:107], v[92:95], v[152:155]
    ds_read_b128 v[52:55], v14 offset:2048
    v_and_b32 v247, s73, v229
    v_lshlrev_b32 v248, 16, v230
    v_and_b32 v249, s73, v230
    v_mfma_f32_16x16x32_bf16 v[176:179], v[104:107], v[96:99], v[176:179]
    ds_read_b128 v[56:59], v14 offset:4096
    v_lshlrev_b32 v250, 16, v231
    v_and_b32 v251, s73, v231
    v_lshlrev_b32 v2, 16, v232
    v_mfma_f32_16x16x32_bf16 v[200:203], v[104:107], v[100:103], v[200:203]
    ds_read_b128 v[60:63], v14 offset:6144
    v_and_b32 v3, s73, v232
    v_add_f32 v244, v244, v2
    v_add_f32 v245, v245, v3
    v_mfma_f32_16x16x32_bf16 v[132:135], v[108:111], v[88:91], v[132:135]
    ds_read_b64_tr_b16 v[64:65], v22 offset:0
    v_lshlrev_b32 v4, 16, v233
    v_and_b32 v5, s73, v233
    v_add_f32 v246, v246, v4
    v_mfma_f32_16x16x32_bf16 v[156:159], v[108:111], v[92:95], v[156:159]
    ds_read_b64_tr_b16 v[66:67], v22 offset:1536
    v_add_f32 v247, v247, v5
    v_lshlrev_b32 v2, 16, v234
    v_and_b32 v3, s73, v234
    v_mfma_f32_16x16x32_bf16 v[180:183], v[108:111], v[96:99], v[180:183]
    ds_read_b64_tr_b16 v[68:69], v23 offset:0
    v_add_f32 v248, v248, v2
    v_add_f32 v249, v249, v3
    v_lshlrev_b32 v4, 16, v235
    v_mfma_f32_16x16x32_bf16 v[204:207], v[108:111], v[100:103], v[204:207]
    ds_read_b64_tr_b16 v[70:71], v23 offset:1536
    v_and_b32 v5, s73, v235
    v_add_f32 v250, v250, v4
    v_add_f32 v251, v251, v5
    v_mfma_f32_16x16x32_bf16 v[136:139], v[112:115], v[88:91], v[136:139]
    ds_read_b64_tr_b16 v[72:73], v24 offset:0
    v_lshlrev_b32 v2, 16, v236
    v_and_b32 v3, s73, v236
    v_mfma_f32_16x16x32_bf16 v[160:163], v[112:115], v[92:95], v[160:163]
    ds_read_b64_tr_b16 v[74:75], v24 offset:1536
    s_add_u32 m0, s58, 24576
    v_add_f32 v244, v244, v2
    v_add_f32 v245, v245, v3
    v_mfma_f32_16x16x32_bf16 v[184:187], v[112:115], v[96:99], v[184:187]
    ds_read_b64_tr_b16 v[76:77], v25 offset:0
    buffer_load_dwordx4 v11, s[8:11], s50 offen lds
    v_lshlrev_b32 v4, 16, v237
    v_and_b32 v5, s73, v237
    v_mfma_f32_16x16x32_bf16 v[208:211], v[112:115], v[100:103], v[208:211]
    ds_read_b64_tr_b16 v[78:79], v25 offset:1536
    s_add_u32 m0, s58, 25600
    v_add_f32 v246, v246, v4
    v_add_f32 v247, v247, v5
    v_mfma_f32_16x16x32_bf16 v[140:143], v[116:119], v[88:91], v[140:143]
    ds_read_b64_tr_b16 v[80:81], v26 offset:0
    buffer_load_dwordx4 v12, s[8:11], s50 offen lds
    v_lshlrev_b32 v2, 16, v238
    v_and_b32 v3, s73, v238
    v_mfma_f32_16x16x32_bf16 v[164:167], v[116:119], v[92:95], v[164:167]
    ds_read_b64_tr_b16 v[82:83], v26 offset:1536
    s_add_u32 m0, s58, 26624
    v_add_f32 v248, v248, v2
    v_add_f32 v249, v249, v3
    v_mfma_f32_16x16x32_bf16 v[188:191], v[116:119], v[96:99], v[188:191]
    buffer_load_dwordx4 v13, s[8:11], s50 offen lds
    s_add_u32 s50, s50, s55
    v_lshlrev_b32 v4, 16, v239
    v_and_b32 v5, s73, v239
    v_mfma_f32_16x16x32_bf16 v[212:215], v[116:119], v[100:103], v[212:215]
    s_add_u32 m0, s57, 32768
    s_movk_i32 s53, 640
    v_add_f32 v250, v250, v4
    v_add_f32 v251, v251, v5
    v_mfma_f32_16x16x32_bf16 v[144:147], v[120:123], v[88:91], v[144:147]
    buffer_load_dwordx4 v10, s[4:7], s53 offen lds
    v_mfma_f32_16x16x32_bf16 v[168:171], v[120:123], v[92:95], v[168:171]
    s_add_u32 m0, s57, 33792
    s_movk_i32 s56, 10880
    v_mfma_f32_16x16x32_bf16 v[192:195], v[120:123], v[96:99], v[192:195]
    buffer_load_dwordx4 v10, s[4:7], s56 offen lds
    v_mfma_f32_16x16x32_bf16 v[216:219], v[120:123], v[100:103], v[216:219]
    s_cmp_eq_u32 s64, 5
    s_cbranch_scc0 L_Q_ep5
    s_not_b64 s[78:79], s[76:77]
    s_sub_u32 s78, s78, 200
    s_subb_u32 s79, s79, 0
    s_mov_b64 exec, 1
    v_mov_b32 v42, s78
    v_mov_b32 v43, s79
    v_mov_b32 v44, 0
    global_atomic_umax_x2 v44, v[42:43], s[36:37] sc1
    s_mov_b64 exec, -1
L_Q_ep5:
    s_waitcnt vmcnt(8) lgkmcnt(0)
    s_barrier
    v_mfma_f32_16x16x32_bf16 v[128:131], v[64:67], v[48:51], v[128:131]
    ds_read_b128 v[88:91], v15 offset:0
    v_lshlrev_b32 v2, 16, v240
    v_and_b32 v3, s73, v240
    v_mfma_f32_16x16x32_bf16 v[152:155], v[64:67], v[52:55], v[152:155]
    ds_read_b128 v[92:95], v15 offset:2048
    v_add_f32 v244, v244, v2
    v_add_f32 v245, v245, v3
    v_mfma_f32_16x16x32_bf16 v[176:179], v[64:67], v[56:59], v[176:179]
    ds_read_b128 v[96:99], v15 offset:4096
    v_lshlrev_b32 v4, 16, v241
    v_and_b32 v5, s73, v241
    v_mfma_f32_16x16x32_bf16 v[200:203], v[64:67], v[60:63], v[200:203]
    ds_read_b128 v[100:103], v15 offset:6144
    v_add_f32 v246, v246, v4
    v_add_f32 v247, v247, v5
    v_mfma_f32_16x16x32_bf16 v[132:135], v[68:71], v[48:51], v[132:135]
    ds_read_b64_tr_b16 v[104:105], v22 offset:24576
    v_lshlrev_b32 v2, 16, v242
    v_and_b32 v3, s73, v242
    v_mfma_f32_16x16x32_bf16 v[156:159], v[68:71], v[52:55], v[156:159]
    ds_read_b64_tr_b16 v[106:107], v22 offset:26112
    v_add_f32 v248, v248, v2
    v_add_f32 v249, v249, v3
    v_mfma_f32_16x16x32_bf16 v[180:183], v[68:71], v[56:59], v[180:183]
    ds_read_b64_tr_b16 v[108:109], v23 offset:24576
    v_lshlrev_b32 v4, 16, v243
    v_and_b32 v5, s73, v243
    v_mfma_f32_16x16x32_bf16 v[204:207], v[68:71], v[60:63], v[204:207]
    ds_read_b64_tr_b16 v[110:111], v23 offset:26112
    v_add_f32 v250, v250, v4
    v_add_f32 v251, v251, v5
    v_mfma_f32_16x16x32_bf16 v[136:139], v[72:75], v[48:51], v[136:139]
    ds_read_b64_tr_b16 v[112:113], v24 offset:24576
    v_lshlrev_b32 v2, 16, v224
    v_and_b32 v3, s73, v224
    v_mfma_f32_16x16x32_bf16 v[160:163], v[72:75], v[52:55], v[160:163]
    ds_read_b64_tr_b16 v[114:115], v24 offset:26112
    v_add_f32 v244, v244, v2
    v_add_f32 v245, v245, v3
    v_mfma_f32_16x16x32_bf16 v[184:187], v[72:75], v[56:59], v[184:187]
    ds_read_b64_tr_b16 v[116:117], v25 offset:24576
    v_lshlrev_b32 v4, 16, v225
    v_and_b32 v5, s73, v225
    v_mfma_f32_16x16x32_bf16 v[208:211], v[72:75], v[60:63], v[208:211]
    ds_read_b64_tr_b16 v[118:119], v25 offset:26112
    v_add_f32 v246, v246, v4
    v_add_f32 v247, v247, v5
    v_mfma_f32_16x16x32_bf16 v[140:143], v[76:79], v[48:51], v[140:143]
    ds_read_b64_tr_b16 v[120:121], v26 offset:24576
    v_lshlrev_b32 v2, 16, v226
    v_and_b32 v3, s73, v226
    v_mfma_f32_16x16x32_bf16 v[164:167], v[76:79], v[52:55], v[164:167]
    ds_read_b64_tr_b16 v[122:123], v26 offset:26112
    s_add_u32 m0, s58, 49152
    v_add_f32 v248, v248, v2
    v_add_f32 v249, v249, v3
    v_mfma_f32_16x16x32_bf16 v[188:191], v[76:79], v[56:59], v[188:191]
    buffer_load_dwordx4 v11, s[8:11], s50 offen lds
    v_lshlrev_b32 v4, 16, v227
    v_and_b32 v5, s73, v227
    v_mfma_f32_16x16x32_bf16 v[212:215], v[76:79], v[60:63], v[212:215]
    s_add_u32 m0, s58, 50176
    v_add_f32 v250, v250, v4
    v_add_f32 v251, v251, v5
    v_mfma_f32_16x16x32_bf16 v[144:147], v[80:83], v[48:51], v[144:147]
    buffer_load_dwordx4 v12, s[8:11], s50 offen lds
    v_mfma_f32_16x16x32_bf16 v[168:171], v[80:83], v[52:55], v[168:171]
    s_add_u32 m0, s58, 51200
    v_mfma_f32_16x16x32_bf16 v[192:195], v[80:83], v[56:59], v[192:195]
    buffer_load_dwordx4 v13, s[8:11], s50 offen lds
    s_add_u32 s50, s50, s55
    v_mfma_f32_16x16x32_bf16 v[216:219], v[80:83], v[60:63], v[216:219]
    s_cmp_eq_u32 s64, 6
    s_cbranch_scc0 L_Q_ep6
    s_not_b64 s[78:79], s[76:77]
    s_sub_u32 s78, s78, 200
    s_subb_u32 s79, s79, 0
    s_mov_b64 exec, 1
    v_mov_b32 v42, s78
    v_mov_b32 v43, s79
    v_mov_b32 v44, 0
    global_atomic_umax_x2 v44, v[42:43], s[36:37] sc1
    s_mov_b64 exec, -1
L_Q_ep6:
    s_mov_b32 exec_hi, 0xffff
    ds_write_b128 v28, v[244:247]
    ds_write_b128 v28, v[248:251] offset:16
    s_mov_b64 exec, -1
    s_waitcnt vmcnt(8) lgkmcnt(0)
    s_barrier
    v_mfma_f32_16x16x32_bf16 v[128:131], v[104:107], v[88:91], v[128:131]
    ds_read_b128 v[48:51], v14 offset:16384
    v_mfma_f32_16x16x32_bf16 v[152:155], v[104:107], v[92:95], v[152:155]
    ds_read_b128 v[52:55], v14 offset:18432
    v_mfma_f32_16x16x32_bf16 v[176:179], v[104:107], v[96:99], v[176:179]
    ds_read_b128 v[56:59], v14 offset:20480
    v_mfma_f32_16x16x32_bf16 v[200:203], v[104:107], v[100:103], v[200:203]
    ds_read_b128 v[60:63], v14 offset:22528
    v_mfma_f32_16x16x32_bf16 v[132:135], v[108:111], v[88:91], v[132:135]
    ds_read_b64_tr_b16 v[64:65], v16 offset:0
    v_mfma_f32_16x16x32_bf16 v[156:159], v[108:111], v[92:95], v[156:159]
    ds_read_b64_tr_b16 v[66:67], v16 offset:1536
    v_mfma_f32_16x16x32_bf16 v[180:183], v[108:111], v[96:99], v[180:183]
    ds_read_b64_tr_b16 v[68:69], v17 offset:0
    v_mfma_f32_16x16x32_bf16 v[204:207], v[108:111], v[100:103], v[204:207]
    ds_read_b64_tr_b16 v[70:71], v17 offset:1536
    v_mfma_f32_16x16x32_bf16 v[136:139], v[112:115], v[88:91], v[136:139]
    ds_read_b64_tr_b16 v[72:73], v18 offset:0
    v_mfma_f32_16x16x32_bf16 v[160:163], v[112:115], v[92:95], v[160:163]
    ds_read_b64_tr_b16 v[74:75], v18 offset:1536
    s_add_u32 m0, s58, 73728
    v_mfma_f32_16x16x32_bf16 v[184:187], v[112:115], v[96:99], v[184:187]
    ds_read_b64_tr_b16 v[76:77], v19 offset:0
    buffer_load_dwordx4 v11, s[8:11], s50 offen lds
    v_mfma_f32_16x16x32_bf16 v[208:211], v[112:115], v[100:103], v[208:211]
    ds_read_b64_tr_b16 v[78:79], v19 offset:1536
    s_add_u32 m0, s58, 74752
    v_mfma_f32_16x16x32_bf16 v[140:143], v[116:119], v[88:91], v[140:143]
    ds_read_b64_tr_b16 v[80:81], v20 offset:0
    buffer_load_dwordx4 v12, s[8:11], s50 offen lds
    v_mfma_f32_16x16x32_bf16 v[164:167], v[116:119], v[92:95], v[164:167]
    ds_read_b64_tr_b16 v[82:83], v20 offset:1536
    s_add_u32 m0, s58, 75776
    v_mfma_f32_16x16x32_bf16 v[188:191], v[116:119], v[96:99], v[188:191]
    buffer_load_dwordx4 v13, s[8:11], s50 offen lds
    s_add_u32 s50, s50, s55
    v_mfma_f32_16x16x32_bf16 v[212:215], v[116:119], v[100:103], v[212:215]
    s_add_u32 m0, s57, 0
    s_movk_i32 s53, 768
    v_mfma_f32_16x16x32_bf16 v[144:147], v[120:123], v[88:91], v[144:147]
    buffer_load_dwordx4 v10, s[4:7], s53 offen lds
    v_mfma_f32_16x16x32_bf16 v[168:171], v[120:123], v[92:95], v[168:171]
    s_add_u32 m0, s57, 1024
    s_movk_i32 s56, 11008
    v_mfma_f32_16x16x32_bf16 v[192:195], v[120:123], v[96:99], v[192:195]
    buffer_load_dwordx4 v10, s[4:7], s56 offen lds
    v_mfma_f32_16x16x32_bf16 v[216:219], v[120:123], v[100:103], v[216:219]
    s_cmp_eq_u32 s64, 7
    s_cbranch_scc0 L_Q_ep7
    s_not_b64 s[78:79], s[76:77]
    s_sub_u32 s78, s78, 200
    s_subb_u32 s79, s79, 0
    s_mov_b64 exec, 1
    v_mov_b32 v42, s78
    v_mov_b32 v43, s79
    v_mov_b32 v44, 0
    global_atomic_umax_x2 v44, v[42:43], s[36:37] sc1
    s_mov_b64 exec, -1
L_Q_ep7:
    s_cmp_lt_u32 s40, 2
    s_cbranch_scc0 L_Q_e6
    v_cmp_gt_u32 vcc, 96, v0
    s_nop 0
    s_and_saveexec_b64 s[60:61], vcc
    v_lshlrev_b32 v2, 4, v0
    v_add_u32 v3, 147456, v2
    ds_read_b128 v[224:227], v3 offset:0
    ds_read_b128 v[228:231], v3 offset:1536
    ds_read_b128 v[232:235], v3 offset:3072
    ds_read_b128 v[236:239], v3 offset:4608
    ds_read_b128 v[240:243], v3 offset:6144
    ds_read_b128 v[244:247], v3 offset:7680
    ds_read_b128 v[248:251], v3 offset:9216
    ds_read_b128 v[252:255], v3 offset:10752
    s_lshl_b32 s62, s42, 4
    s_add_u32 s62, s62, s41
    s_mul_i32 s62, s62, 1536
    s_add_u32 s62, s62, 14680064
    s_waitcnt lgkmcnt(6)
    v_add_f32 v224, v224, v228
    v_add_f32 v225, v225, v229
    v_add_f32 v226, v226, v230
    v_add_f32 v227, v227, v231
    s_waitcnt lgkmcnt(5)
    v_add_f32 v224, v224, v232
    v_add_f32 v225, v225, v233
    v_add_f32 v226, v226, v234
    v_add_f32 v227, v227, v235
    s_waitcnt lgkmcnt(4)
    v_add_f32 v224, v224, v236
    v_add_f32 v225, v225, v237
    v_add_f32 v226, v226, v238
    v_add_f32 v227, v227, v239
    s_waitcnt lgkmcnt(3)
    v_add_f32 v224, v224, v240
    v_add_f32 v225, v225, v241
    v_add_f32 v226, v226, v242
    v_add_f32 v227, v227, v243
    s_waitcnt lgkmcnt(2)
    v_add_f32 v224, v224, v244
    v_add_f32 v225, v225, v245
    v_add_f32 v226, v226, v246
    v_add_f32 v227, v227, v247
    s_waitcnt lgkmcnt(1)
    v_add_f32 v224, v224, v248
    v_add_f32 v225, v225, v249
    v_add_f32 v226, v226, v250
    v_add_f32 v227, v227, v251
    s_waitcnt lgkmcnt(0)
    v_add_f32 v224, v224, v252
    v_add_f32 v225, v225, v253
    v_add_f32 v226, v226, v254
    v_add_f32 v227, v227, v255
    buffer_store_dwordx4 v[224:227], v2, s[12:15], s62 offen sc1
    s_mov_b64 exec, s[60:61]
L_Q_e6:
    s_waitcnt vmcnt(10) lgkmcnt(0)
    s_barrier
    v_mfma_f32_16x16x32_bf16 v[128:131], v[64:67], v[48:51], v[128:131]
    ds_read_b128 v[88:91], v15 offset:16384
    v_mfma_f32_16x16x32_bf16 v[152:155], v[64:67], v[52:55], v[152:155]
    ds_read_b128 v[92:95], v15 offset:18432
    v_mfma_f32_16x16x32_bf16 v[176:179], v[64:67], v[56:59], v[176:179]
    ds_read_b128 v[96:99], v15 offset:20480
    v_mfma_f32_16x16x32_bf16 v[200:203], v[64:67], v[60:63], v[200:203]
    ds_read_b128 v[100:103], v15 offset:22528
    v_mfma_f32_16x16x32_bf16 v[132:135], v[68:71], v[48:51], v[132:135]
    ds_read_b64_tr_b16 v[104:105], v16 offset:24576
    v_mfma_f32_16x16x32_bf16 v[156:159], v[68:71], v[52:55], v[156:159]
    ds_read_b64_tr_b16 v[106:107], v16 offset:26112
    v_mfma_f32_16x16x32_bf16 v[180:183], v[68:71], v[56:59], v[180:183]
    ds_read_b64_tr_b16 v[108:109], v17 offset:24576
    v_mfma_f32_16x16x32_bf16 v[204:207], v[68:71], v[60:63], v[204:207]
    ds_read_b64_tr_b16 v[110:111], v17 offset:26112
    v_mfma_f32_16x16x32_bf16 v[136:139], v[72:75], v[48:51], v[136:139]
    ds_read_b64_tr_b16 v[112:113], v18 offset:24576
    v_mfma_f32_16x16x32_bf16 v[160:163], v[72:75], v[52:55], v[160:163]
    ds_read_b64_tr_b16 v[114:115], v18 offset:26112
    v_mfma_f32_16x16x32_bf16 v[184:187], v[72:75], v[56:59], v[184:187]
    ds_read_b64_tr_b16 v[116:117], v19 offset:24576
    v_mfma_f32_16x16x32_bf16 v[208:211], v[72:75], v[60:63], v[208:211]
    ds_read_b64_tr_b16 v[118:119], v19 offset:26112
    v_mfma_f32_16x16x32_bf16 v[140:143], v[76:79], v[48:51], v[140:143]
    ds_read_b64_tr_b16 v[120:121], v20 offset:24576
    v_mfma_f32_16x16x32_bf16 v[164:167], v[76:79], v[52:55], v[164:167]
    ds_read_b64_tr_b16 v[122:123], v20 offset:26112
    s_add_u32 m0, s58, 0
    v_mfma_f32_16x16x32_bf16 v[188:191], v[76:79], v[56:59], v[188:191]
    buffer_load_dwordx4 v11, s[8:11], s50 offen lds
    v_mfma_f32_16x16x32_bf16 v[212:215], v[76:79], v[60:63], v[212:215]
    s_add_u32 m0, s58, 1024
    v_mfma_f32_16x16x32_bf16 v[144:147], v[80:83], v[48:51], v[144:147]
    buffer_load_dwordx4 v12, s[8:11], s50 offen lds
    v_mfma_f32_16x16x32_bf16 v[168:171], v[80:83], v[52:55], v[168:171]
    s_add_u32 m0, s58, 2048
    v_mfma_f32_16x16x32_bf16 v[192:195], v[80:83], v[56:59], v[192:195]
    buffer_load_dwordx4 v13, s[8:11], s50 offen lds
    s_add_u32 s50, s50, s55
    v_mfma_f32_16x16x32_bf16 v[216:219], v[80:83], v[60:63], v[216:219]
    s_cmp_eq_u32 s64, 8
    s_cbranch_scc0 L_Q_ep8
    s_not_b64 s[78:79], s[76:77]
    s_sub_u32 s78, s78, 200
    s_subb_u32 s79, s79, 0
    s_mov_b64 exec, 1
    v_mov_b32 v42, s78
    v_mov_b32 v43, s79
    v_mov_b32 v44, 0
    global_atomic_umax_x2 v44, v[42:43], s[36:37] sc1
    s_mov_b64 exec, -1
L_Q_ep8:
    s_cmp_ge_u32 s40, 5
    s_cbranch_scc0 L_Q_cpf
    s_getpc_b64 s[60:61]
L_Q_pc:
    s_cmp_eq_u32 s40, 5
    s_cselect_b32 s62, L_Q_ch0-L_Q_pc-2048, 0
    s_cmp_eq_u32 s40, 6
    s_cselect_b32 s62, L_pub-L_Q_pc+0, s62
    s_cmp_eq_u32 s40, 7
    s_cselect_b32 s62, L_pub-L_Q_pc+8192, s62
    v_lshl_add_u32 v44, v1, 7, s62
    v_min_u32 v44, L_code_end-L_Q_pc-4, v44
    v_mov_b32 v45, s61
    v_add_co_u32 v44, vcc, s60, v44
    s_nop 1
    v_addc_co_u32 v45, vcc, 0, v45, vcc
    global_load_dword v46, v[44:45], off
L_Q_cpf:
    s_waitcnt vmcnt(8) lgkmcnt(0)
    s_barrier
    v_mfma_f32_16x16x32_bf16 v[128:131], v[104:107], v[88:91], v[128:131]
    ds_read_b128 v[48:51], v14 offset:32768
    s_add_u32 m0, s58, 24576
    v_mfma_f32_16x16x32_bf16 v[152:155], v[104:107], v[92:95], v[152:155]
    ds_read_b128 v[52:55], v14 offset:34816
    buffer_load_dwordx4 v11, s[8:11], s50 offen lds
    v_mfma_f32_16x16x32_bf16 v[176:179], v[104:107], v[96:99], v[176:179]
    ds_read_b128 v[56:59], v14 offset:36864
    s_add_u32 m0, s58, 25600
    v_mfma_f32_16x16x32_bf16 v[200:203], v[104:107], v[100:103], v[200:203]
    ds_read_b128 v[60:63], v14 offset:38912
    buffer_load_dwordx4 v12, s[8:11], s50 offen lds
    v_mfma_f32_16x16x32_bf16 v[132:135], v[108:111], v[88:91], v[132:135]
    ds_read_b64_tr_b16 v[64:65], v22 offset:0
    s_add_u32 m0, s58, 26624
    v_mfma_f32_16x16x32_bf16 v[156:159], v[108:111], v[92:95], v[156:159]
    ds_read_b64_tr_b16 v[66:67], v22 offset:1536
    buffer_load_dwordx4 v13, s[8:11], s50 offen lds
    s_add_u32 s50, s50, s55
    v_mfma_f32_16x16x32_bf16 v[180:183], v[108:111], v[96:99], v[180:183]
    ds_read_b64_tr_b16 v[68:69], v23 offset:0
    s_add_u32 m0, s57, 16384
    s_movk_i32 s53, 896
    v_mfma_f32_16x16x32_bf16 v[204:207], v[108:111], v[100:103], v[204:207]
    ds_read_b64_tr_b16 v[70:71], v23 offset:1536
    buffer_load_dwordx4 v10, s[4:7], s53 offen lds
    v_mfma_f32_16x16x32_bf16 v[136:139], v[112:115], v[88:91], v[136:139]
    ds_read_b64_tr_b16 v[72:73], v24 offset:0
    s_add_u32 m0, s57, 17408
    s_movk_i32 s56, 11136
    v_mfma_f32_16x16x32_bf16 v[160:163], v[112:115], v[92:95], v[160:163]
    ds_read_b64_tr_b16 v[74:75], v24 offset:1536
    buffer_load_dwordx4 v10, s[4:7], s56 offen lds
    v_mfma_f32_16x16x32_bf16 v[184:187], v[112:115], v[96:99], v[184:187]
    ds_read_b64_tr_b16 v[76:77], v25 offset:0
    v_mfma_f32_16x16x32_bf16 v[208:211], v[112:115], v[100:103], v[208:211]
    ds_read_b64_tr_b16 v[78:79], v25 offset:1536
    v_mfma_f32_16x16x32_bf16 v[140:143], v[116:119], v[88:91], v[140:143]
    ds_read_b64_tr_b16 v[80:81], v26 offset:0
    v_mfma_f32_16x16x32_bf16 v[164:167], v[116:119], v[92:95], v[164:167]
    ds_read_b64_tr_b16 v[82:83], v26 offset:1536
    v_mfma_f32_16x16x32_bf16 v[188:191], v[116:119], v[96:99], v[188:191]
    v_mfma_f32_16x16x32_bf16 v[212:215], v[116:119], v[100:103], v[212:215]
    v_mfma_f32_16x16x32_bf16 v[144:147], v[120:123], v[88:91], v[144:147]
    v_mfma_f32_16x16x32_bf16 v[168:171], v[120:123], v[92:95], v[168:171]
    v_mfma_f32_16x16x32_bf16 v[192:195], v[120:123], v[96:99], v[192:195]
    v_mfma_f32_16x16x32_bf16 v[216:219], v[120:123], v[100:103], v[216:219]
    s_cmp_eq_u32 s64, 9
    s_cbranch_scc0 L_Q_ep9
    s_not_b64 s[78:79], s[76:77]
    s_sub_u32 s78, s78, 200
    s_subb_u32 s79, s79, 0
    s_mov_b64 exec, 1
    v_mov_b32 v42, s78
    v_mov_b32 v43, s79
    v_mov_b32 v44, 0
    global_atomic_umax_x2 v44, v[42:43], s[36:37] sc1
    s_mov_b64 exec, -1
L_Q_ep9:
    s_cmp_lt_u32 s40, 2
    s_cbranch_scc0 L_Q_t10
    s_waitcnt vmcnt(0)
L_Q_t10:
    s_waitcnt vmcnt(10) lgkmcnt(0)
    s_barrier
    v_mfma_f32_16x16x32_bf16 v[128:131], v[64:67], v[48:51], v[128:131]
    ds_read_b128 v[88:91], v15 offset:32768
    v_mfma_f32_16x16x32_bf16 v[152:155], v[64:67], v[52:55], v[152:155]
    ds_read_b128 v[92:95], v15 offset:34816
    v_mfma_f32_16x16x32_bf16 v[176:179], v[64:67], v[56:59], v[176:179]
    ds_read_b128 v[96:99], v15 offset:36864
    v_mfma_f32_16x16x32_bf16 v[200:203], v[64:67], v[60:63], v[200:203]
    ds_read_b128 v[100:103], v15 offset:38912
    v_mfma_f32_16x16x32_bf16 v[132:135], v[68:71], v[48:51], v[132:135]
    ds_read_b64_tr_b16 v[104:105], v22 offset:24576
    v_mfma_f32_16x16x32_bf16 v[156:159], v[68:71], v[52:55], v[156:159]
    ds_read_b64_tr_b16 v[106:107], v22 offset:26112
    v_mfma_f32_16x16x32_bf16 v[180:183], v[68:71], v[56:59], v[180:183]
    ds_read_b64_tr_b16 v[108:109], v23 offset:24576
    v_mfma_f32_16x16x32_bf16 v[204:207], v[68:71], v[60:63], v[204:207]
    ds_read_b64_tr_b16 v[110:111], v23 offset:26112
    v_mfma_f32_16x16x32_bf16 v[136:139], v[72:75], v[48:51], v[136:139]
    ds_read_b64_tr_b16 v[112:113], v24 offset:24576
    v_mfma_f32_16x16x32_bf16 v[160:163], v[72:75], v[52:55], v[160:163]
    ds_read_b64_tr_b16 v[114:115], v24 offset:26112
    v_mfma_f32_16x16x32_bf16 v[184:187], v[72:75], v[56:59], v[184:187]
    ds_read_b64_tr_b16 v[116:117], v25 offset:24576
    v_mfma_f32_16x16x32_bf16 v[208:211], v[72:75], v[60:63], v[208:211]
    ds_read_b64_tr_b16 v[118:119], v25 offset:26112
    v_mfma_f32_16x16x32_bf16 v[140:143], v[76:79], v[48:51], v[140:143]
    ds_read_b64_tr_b16 v[120:121], v26 offset:24576
    v_mfma_f32_16x16x32_bf16 v[164:167], v[76:79], v[52:55], v[164:167]
    ds_read_b64_tr_b16 v[122:123], v26 offset:26112
    s_add_u32 m0, s58, 49152
    v_mfma_f32_16x16x32_bf16 v[188:191], v[76:79], v[56:59], v[188:191]
    buffer_load_dwordx4 v11, s[8:11], s50 offen lds
    v_mfma_f32_16x16x32_bf16 v[212:215], v[76:79], v[60:63], v[212:215]
    s_add_u32 m0, s58, 50176
    v_mfma_f32_16x16x32_bf16 v[144:147], v[80:83], v[48:51], v[144:147]
    buffer_load_dwordx4 v12, s[8:11], s50 offen lds
    v_mfma_f32_16x16x32_bf16 v[168:171], v[80:83], v[52:55], v[168:171]
    s_add_u32 m0, s58, 51200
    v_mfma_f32_16x16x32_bf16 v[192:195], v[80:83], v[56:59], v[192:195]
    buffer_load_dwordx4 v13, s[8:11], s50 offen lds
    s_add_u32 s50, s50, s55
    v_mfma_f32_16x16x32_bf16 v[216:219], v[80:83], v[60:63], v[216:219]
    s_cmp_eq_u32 s40, 0
    s_cbranch_scc0 L_Q_e9
    s_lshl_b32 s60, s41, 3
    s_memrealtime s[78:79]
    s_mov_b64 exec, 1
    s_waitcnt lgkmcnt(0)
    v_mov_b32 v40, s78
    v_mov_b32 v41, s79
    buffer_store_dwordx2 v[40:41], v37, s[12:15], s60 offen offset:0 sc1
    s_mov_b64 exec, -1
L_Q_e9:
    s_waitcnt vmcnt(8) lgkmcnt(0)
    s_barrier
    v_mfma_f32_16x16x32_bf16 v[128:131], v[104:107], v[88:91], v[128:131]
    ds_read_b128 v[48:51], v14 offset:0
    v_mfma_f32_16x16x32_bf16 v[152:155], v[104:107], v[92:95], v[152:155]
    ds_read_b128 v[52:55], v14 offset:2048
    v_mfma_f32_16x16x32_bf16 v[176:179], v[104:107], v[96:99], v[176:179]
    ds_read_b128 v[56:59], v14 offset:4096
    v_mfma_f32_16x16x32_bf16 v[200:203], v[104:107], v[100:103], v[200:203]
    ds_read_b128 v[60:63], v14 offset:6144
    v_mfma_f32_16x16x32_bf16 v[132:135], v[108:111], v[88:91], v[132:135]
    ds_read_b64_tr_b16 v[64:65], v16 offset:0
    v_mfma_f32_16x16x32_bf16 v[156:159], v[108:111], v[92:95], v[156:159]
    ds_read_b64_tr_b16 v[66:67], v16 offset:1536
    v_mfma_f32_16x16x32_bf16 v[180:183], v[108:111], v[96:99], v[180:183]
    ds_read_b64_tr_b16 v[68:69], v17 offset:0
    v_mfma_f32_16x16x32_bf16 v[204:207], v[108:111], v[100:103], v[204:207]
    ds_read_b64_tr_b16 v[70:71], v17 offset:1536
    v_mfma_f32_16x16x32_bf16 v[136:139], v[112:115], v[88:91], v[136:139]
    ds_read_b64_tr_b16 v[72:73], v18 offset:0
    v_mfma_f32_16x16x32_bf16 v[160:163], v[112:115], v[92:95], v[160:163]
    ds_read_b64_tr_b16 v[74:75], v18 offset:1536
    s_add_u32 m0, s58, 73728
    v_mfma_f32_16x16x32_bf16 v[184:187], v[112:115], v[96:99], v[184:187]
    ds_read_b64_tr_b16 v[76:77], v19 offset:0
    buffer_load_dwordx4 v11, s[8:11], s50 offen lds
    v_mfma_f32_16x16x32_bf16 v[208:211], v[112:115], v[100:103], v[208:211]
    ds_read_b64_tr_b16 v[78:79], v19 offset:1536
    s_add_u32 m0, s58, 74752
    v_mfma_f32_16x16x32_bf16 v[140:143], v[116:119], v[88:91], v[140:143]
    ds_read_b64_tr_b16 v[80:81], v20 offset:0
    buffer_load_dwordx4 v12, s[8:11], s50 offen lds
    v_mfma_f32_16x16x32_bf16 v[164:167], v[116:119], v[92:95], v[164:167]
    ds_read_b64_tr_b16 v[82:83], v20 offset:1536
    s_add_u32 m0, s58, 75776
    v_mfma_f32_16x16x32_bf16 v[188:191], v[116:119], v[96:99], v[188:191]
    buffer_load_dwordx4 v13, s[8:11], s50 offen lds
    s_add_u32 s50, s50, s55
    v_mfma_f32_16x16x32_bf16 v[212:215], v[116:119], v[100:103], v[212:215]
    s_add_u32 m0, s57, 32768
    s_movk_i32 s53, 1024
    v_mfma_f32_16x16x32_bf16 v[144:147], v[120:123], v[88:91], v[144:147]
    buffer_load_dwordx4 v10, s[4:7], s53 offen lds
    v_mfma_f32_16x16x32_bf16 v[168:171], v[120:123], v[92:95], v[168:171]
    s_add_u32 m0, s57, 33792
    s_movk_i32 s56, 11264
    v_mfma_f32_16x16x32_bf16 v[192:195], v[120:123], v[96:99], v[192:195]
    buffer_load_dwordx4 v10, s[4:7], s56 offen lds
    v_mfma_f32_16x16x32_bf16 v[216:219], v[120:123], v[100:103], v[216:219]
    s_waitcnt vmcnt(10) lgkmcnt(0)
    s_barrier
    v_mfma_f32_16x16x32_bf16 v[128:131], v[64:67], v[48:51], v[128:131]
    ds_read_b128 v[88:91], v15 offset:0
    v_mfma_f32_16x16x32_bf16 v[152:155], v[64:67], v[52:55], v[152:155]
    ds_read_b128 v[92:95], v15 offset:2048
    v_mfma_f32_16x16x32_bf16 v[176:179], v[64:67], v[56:59], v[176:179]
    ds_read_b128 v[96:99], v15 offset:4096
    v_mfma_f32_16x16x32_bf16 v[200:203], v[64:67], v[60:63], v[200:203]
    ds_read_b128 v[100:103], v15 offset:6144
    v_mfma_f32_16x16x32_bf16 v[132:135], v[68:71], v[48:51], v[132:135]
    ds_read_b64_tr_b16 v[104:105], v16 offset:24576
    v_mfma_f32_16x16x32_bf16 v[156:159], v[68:71], v[52:55], v[156:159]
    ds_read_b64_tr_b16 v[106:107], v16 offset:26112
    v_mfma_f32_16x16x32_bf16 v[180:183], v[68:71], v[56:59], v[180:183]
    ds_read_b64_tr_b16 v[108:109], v17 offset:24576
    v_mfma_f32_16x16x32_bf16 v[204:207], v[68:71], v[60:63], v[204:207]
    ds_read_b64_tr_b16 v[110:111], v17 offset:26112
    v_mfma_f32_16x16x32_bf16 v[136:139], v[72:75], v[48:51], v[136:139]
    ds_read_b64_tr_b16 v[112:113], v18 offset:24576
    v_mfma_f32_16x16x32_bf16 v[160:163], v[72:75], v[52:55], v[160:163]
    ds_read_b64_tr_b16 v[114:115], v18 offset:26112
    v_mfma_f32_16x16x32_bf16 v[184:187], v[72:75], v[56:59], v[184:187]
    ds_read_b64_tr_b16 v[116:117], v19 offset:24576
    v_mfma_f32_16x16x32_bf16 v[208:211], v[72:75], v[60:63], v[208:211]
    ds_read_b64_tr_b16 v[118:119], v19 offset:26112
    v_mfma_f32_16x16x32_bf16 v[140:143], v[76:79], v[48:51], v[140:143]
    ds_read_b64_tr_b16 v[120:121], v20 offset:24576
    v_mfma_f32_16x16x32_bf16 v[164:167], v[76:79], v[52:55], v[164:167]
    ds_read_b64_tr_b16 v[122:123], v20 offset:26112
    s_add_u32 m0, s58, 0
    v_mfma_f32_16x16x32_bf16 v[188:191], v[76:79], v[56:59], v[188:191]
    buffer_load_dwordx4 v11, s[8:11], s50 offen lds
    v_mfma_f32_16x16x32_bf16 v[212:215], v[76:79], v[60:63], v[212:215]
    s_add_u32 m0, s58, 1024
    v_mfma_f32_16x16x32_bf16 v[144:147], v[80:83], v[48:51], v[144:147]
    buffer_load_dwordx4 v12, s[8:11], s50 offen lds
    v_mfma_f32_16x16x32_bf16 v[168:171], v[80:83], v[52:55], v[168:171]
    s_add_u32 m0, s58, 2048
    v_mfma_f32_16x16x32_bf16 v[192:195], v[80:83], v[56:59], v[192:195]
    buffer_load_dwordx4 v13, s[8:11], s50 offen lds
    s_add_u32 s50, s50, s55
    v_mfma_f32_16x16x32_bf16 v[216:219], v[80:83], v[60:63], v[216:219]
    s_waitcnt vmcnt(8) lgkmcnt(0)
    s_barrier
    v_mfma_f32_16x16x32_bf16 v[128:131], v[104:107], v[88:91], v[128:131]
    ds_read_b128 v[48:51], v14 offset:16384
    v_mfma_f32_16x16x32_bf16 v[152:155], v[104:107], v[92:95], v[152:155]
    ds_read_b128 v[52:55], v14 offset:18432
    v_mfma_f32_16x16x32_bf16 v[176:179], v[104:107], v[96:99], v[176:179]
    ds_read_b128 v[56:59], v14 offset:20480
    v_mfma_f32_16x16x32_bf16 v[200:203], v[104:107], v[100:103], v[200:203]
    ds_read_b128 v[60:63], v14 offset:22528
    v_mfma_f32_16x16x32_bf16 v[132:135], v[108:111], v[88:91], v[132:135]
    ds_read_b64_tr_b16 v[64:65], v22 offset:0
    v_mfma_f32_16x16x32_bf16 v[156:159], v[108:111], v[92:95], v[156:159]
    ds_read_b64_tr_b16 v[66:67], v22 offset:1536
    v_mfma_f32_16x16x32_bf16 v[180:183], v[108:111], v[96:99], v[180:183]
    ds_read_b64_tr_b16 v[68:69], v23 offset:0
    v_mfma_f32_16x16x32_bf16 v[204:207], v[108:111], v[100:103], v[204:207]
    ds_read_b64_tr_b16 v[70:71], v23 offset:1536
    v_mfma_f32_16x16x32_bf16 v[136:139], v[112:115], v[88:91], v[136:139]
    ds_read_b64_tr_b16 v[72:73], v24 offset:0
    v_mfma_f32_16x16x32_bf16 v[160:163], v[112:115], v[92:95], v[160:163]
    ds_read_b64_tr_b16 v[74:75], v24 offset:1536
    s_add_u32 m0, s58, 24576
    v_mfma_f32_16x16x32_bf16 v[184:187], v[112:115], v[96:99], v[184:187]
    ds_read_b64_tr_b16 v[76:77], v25 offset:0
    buffer_load_dwordx4 v11, s[8:11], s50 offen lds
    v_mfma_f32_16x16x32_bf16 v[208:211], v[112:115], v[100:103], v[208:211]
    ds_read_b64_tr_b16 v[78:79], v25 offset:1536
    s_add_u32 m0, s58, 25600
    v_mfma_f32_16x16x32_bf16 v[140:143], v[116:119], v[88:91], v[140:143]
    ds_read_b64_tr_b16 v[80:81], v26 offset:0
    buffer_load_dwordx4 v12, s[8:11], s50 offen lds
    v_mfma_f32_16x16x32_bf16 v[164:167], v[116:119], v[92:95], v[164:167]
    ds_read_b64_tr_b16 v[82:83], v26 offset:1536
    s_add_u32 m0, s58, 26624
    v_mfma_f32_16x16x32_bf16 v[188:191], v[116:119], v[96:99], v[188:191]
    buffer_load_dwordx4 v13, s[8:11], s50 offen lds
    s_add_u32 s50, s50, s55
    v_mfma_f32_16x16x32_bf16 v[212:215], v[116:119], v[100:103], v[212:215]
    s_add_u32 m0, s57, 0
    s_movk_i32 s53, 1152
    v_mfma_f32_16x16x32_bf16 v[144:147], v[120:123], v[88:91], v[144:147]
    buffer_load_dwordx4 v10, s[4:7], s53 offen lds
    v_mfma_f32_16x16x32_bf16 v[168:171], v[120:123], v[92:95], v[168:171]
    s_add_u32 m0, s57, 1024
    s_movk_i32 s56, 11392
    v_mfma_f32_16x16x32_bf16 v[192:195], v[120:123], v[96:99], v[192:195]
    buffer_load_dwordx4 v10, s[4:7], s56 offen lds
    v_mfma_f32_16x16x32_bf16 v[216:219], v[120:123], v[100:103], v[216:219]
    s_cmp_eq_u32 s40, 0
    s_cbranch_scc0 L_Q_e12
    s_mov_b64 exec, 0xffffffff
    buffer_load_dwordx2 v[40:41], v37, s[12:15], 0 offen offset:0 sc1
    s_mov_b64 exec, -1
L_Q_e12:
    s_waitcnt vmcnt(10) lgkmcnt(0)
    s_barrier
    v_mfma_f32_16x16x32_bf16 v[128:131], v[64:67], v[48:51], v[128:131]
    ds_read_b128 v[88:91], v15 offset:16384
    v_mfma_f32_16x16x32_bf16 v[152:155], v[64:67], v[52:55], v[152:155]
    ds_read_b128 v[92:95], v15 offset:18432
    v_mfma_f32_16x16x32_bf16 v[176:179], v[64:67], v[56:59], v[176:179]
    ds_read_b128 v[96:99], v15 offset:20480
    v_mfma_f32_16x16x32_bf16 v[200:203], v[64:67], v[60:63], v[200:203]
    ds_read_b128 v[100:103], v15 offset:22528
    v_mfma_f32_16x16x32_bf16 v[132:135], v[68:71], v[48:51], v[132:135]
    ds_read_b64_tr_b16 v[104:105], v22 offset:24576
    v_mfma_f32_16x16x32_bf16 v[156:159], v[68:71], v[52:55], v[156:159]
    ds_read_b64_tr_b16 v[106:107], v22 offset:26112
    v_mfma_f32_16x16x32_bf16 v[180:183], v[68:71], v[56:59], v[180:183]
    ds_read_b64_tr_b16 v[108:109], v23 offset:24576
    v_mfma_f32_16x16x32_bf16 v[204:207], v[68:71], v[60:63], v[204:207]
    ds_read_b64_tr_b16 v[110:111], v23 offset:26112
    v_mfma_f32_16x16x32_bf16 v[136:139], v[72:75], v[48:51], v[136:139]
    ds_read_b64_tr_b16 v[112:113], v24 offset:24576
    v_mfma_f32_16x16x32_bf16 v[160:163], v[72:75], v[52:55], v[160:163]
    ds_read_b64_tr_b16 v[114:115], v24 offset:26112
    v_mfma_f32_16x16x32_bf16 v[184:187], v[72:75], v[56:59], v[184:187]
    ds_read_b64_tr_b16 v[116:117], v25 offset:24576
    v_mfma_f32_16x16x32_bf16 v[208:211], v[72:75], v[60:63], v[208:211]
    ds_read_b64_tr_b16 v[118:119], v25 offset:26112
    v_mfma_f32_16x16x32_bf16 v[140:143], v[76:79], v[48:51], v[140:143]
    ds_read_b64_tr_b16 v[120:121], v26 offset:24576
    v_mfma_f32_16x16x32_bf16 v[164:167], v[76:79], v[52:55], v[164:167]
    ds_read_b64_tr_b16 v[122:123], v26 offset:26112
    s_add_u32 m0, s58, 49152
    v_mfma_f32_16x16x32_bf16 v[188:191], v[76:79], v[56:59], v[188:191]
    buffer_load_dwordx4 v11, s[8:11], s50 offen lds
    v_mfma_f32_16x16x32_bf16 v[212:215], v[76:79], v[60:63], v[212:215]
    s_add_u32 m0, s58, 50176
    v_mfma_f32_16x16x32_bf16 v[144:147], v[80:83], v[48:51], v[144:147]
    buffer_load_dwordx4 v12, s[8:11], s50 offen lds
    v_mfma_f32_16x16x32_bf16 v[168:171], v[80:83], v[52:55], v[168:171]
    s_add_u32 m0, s58, 51200
    v_mfma_f32_16x16x32_bf16 v[192:195], v[80:83], v[56:59], v[192:195]
    buffer_load_dwordx4 v13, s[8:11], s50 offen lds
    s_add_u32 s50, s50, s55
    v_mfma_f32_16x16x32_bf16 v[216:219], v[80:83], v[60:63], v[216:219]
    s_cmp_eq_u32 s40, 0
    s_cbranch_scc0 L_Q_ck15
    s_waitcnt vmcnt(3)
    s_mov_b32 s65, 0
L_Q_sp15:
    s_mov_b64 exec, 0xffffffff
    v_mov_b32 v43, s77
    v_subrev_co_u32 v42, vcc, s76, v40
    s_nop 1
    v_subb_co_u32 v43, vcc, v41, v43, vcc
    v_lshrrev_b32 v42, 30, v42
    v_or_b32 v42, v42, v43
    v_cmp_ne_u32 vcc, 0, v42
    s_mov_b64 exec, -1
    s_cmp_eq_u64 vcc, 0
    s_cbranch_scc1 L_Q_ck15
    s_add_u32 s65, s65, 1
    s_cmp_ge_u32 s65, 0x400000
    s_cbranch_scc1 L_Q_ck15
    s_sleep 4
    s_mov_b64 exec, 0xffffffff
    buffer_load_dwordx2 v[40:41], v37, s[12:15], 0 offen offset:0 sc1
    s_mov_b64 exec, -1
    s_and_b32 s66, s65, 15
    s_cmp_lg_u32 s66, 0
    s_cbranch_scc1 L_Q_sp15_w
    v_mov_b32 v42, 0
    global_load_dwordx2 v[42:43], v42, s[36:37] sc1
    s_waitcnt vmcnt(0)
    v_readfirstlane_b32 s78, v42
    v_readfirstlane_b32 s79, v43
    s_nop 0
    s_cmp_eq_u64 s[78:79], 0
    s_cbranch_scc1 L_Q_sp15_w
    s_not_b64 s[78:79], s[78:79]
    s_sub_u32 s78, s78, 200
    s_subb_u32 s79, s79, 0
    s_sub_u32 s66, s78, s76
    s_subb_u32 s66, s79, s77
    s_cselect_b32 s76, s78, s76
    s_cselect_b32 s77, s79, s77
L_Q_sp15_w:
    s_waitcnt vmcnt(0)
    s_branch L_Q_sp15
L_Q_ck15:
    s_waitcnt vmcnt(8) lgkmcnt(0)
    s_barrier
    buffer_load_dwordx4 v[224:227], v39, s[12:15], 0 offen offset:0 sc1
    buffer_load_dwordx4 v[228:231], v39, s[12:15], 0 offen offset:1536 sc1
    buffer_load_dwordx4 v[232:235], v39, s[12:15], 0 offen offset:3072 sc1
    buffer_load_dwordx4 v[236:239], v39, s[12:15], s67 offen sc1
    s_cmp_ge_u32 s40, 6
    s_cbranch_scc0 L_Q_s16
    buffer_load_dwordx2 v[240:241], v29, s[12:15], 0 offen sc1
L_Q_s16:
    v_mfma_f32_16x16x32_bf16 v[128:131], v[104:107], v[88:91], v[128:131]
    ds_read_b128 v[48:51], v14 offset:32768
    v_mfma_f32_16x16x32_bf16 v[152:155], v[104:107], v[92:95], v[152:155]
    ds_read_b128 v[52:55], v14 offset:34816
    v_mfma_f32_16x16x32_bf16 v[176:179], v[104:107], v[96:99], v[176:179]
    ds_read_b128 v[56:59], v14 offset:36864
    v_mfma_f32_16x16x32_bf16 v[200:203], v[104:107], v[100:103], v[200:203]
    ds_read_b128 v[60:63], v14 offset:38912
    v_mfma_f32_16x16x32_bf16 v[132:135], v[108:111], v[88:91], v[132:135]
    ds_read_b64_tr_b16 v[64:65], v16 offset:0
    v_mfma_f32_16x16x32_bf16 v[156:159], v[108:111], v[92:95], v[156:159]
    ds_read_b64_tr_b16 v[66:67], v16 offset:1536
    v_mfma_f32_16x16x32_bf16 v[180:183], v[108:111], v[96:99], v[180:183]
    ds_read_b64_tr_b16 v[68:69], v17 offset:0
    v_mfma_f32_16x16x32_bf16 v[204:207], v[108:111], v[100:103], v[204:207]
    ds_read_b64_tr_b16 v[70:71], v17 offset:1536
    v_mfma_f32_16x16x32_bf16 v[136:139], v[112:115], v[88:91], v[136:139]
    ds_read_b64_tr_b16 v[72:73], v18 offset:0
    v_mfma_f32_16x16x32_bf16 v[160:163], v[112:115], v[92:95], v[160:163]
    ds_read_b64_tr_b16 v[74:75], v18 offset:1536
    v_mfma_f32_16x16x32_bf16 v[184:187], v[112:115], v[96:99], v[184:187]
    ds_read_b64_tr_b16 v[76:77], v19 offset:0
    v_mfma_f32_16x16x32_bf16 v[208:211], v[112:115], v[100:103], v[208:211]
    ds_read_b64_tr_b16 v[78:79], v19 offset:1536
    v_mfma_f32_16x16x32_bf16 v[140:143], v[116:119], v[88:91], v[140:143]
    ds_read_b64_tr_b16 v[80:81], v20 offset:0
    v_mfma_f32_16x16x32_bf16 v[164:167], v[116:119], v[92:95], v[164:167]
    ds_read_b64_tr_b16 v[82:83], v20 offset:1536
    s_add_u32 m0, s58, 73728
    v_mfma_f32_16x16x32_bf16 v[188:191], v[116:119], v[96:99], v[188:191]
    buffer_load_dwordx4 v11, s[8:11], s50 offen lds
    v_mfma_f32_16x16x32_bf16 v[212:215], v[116:119], v[100:103], v[212:215]
    s_add_u32 m0, s58, 74752
    v_mfma_f32_16x16x32_bf16 v[144:147], v[120:123], v[88:91], v[144:147]
    buffer_load_dwordx4 v12, s[8:11], s50 offen lds
    v_mfma_f32_16x16x32_bf16 v[168:171], v[120:123], v[92:95], v[168:171]
    s_add_u32 m0, s58, 75776
    v_mfma_f32_16x16x32_bf16 v[192:195], v[120:123], v[96:99], v[192:195]
    buffer_load_dwordx4 v13, s[8:11], s50 offen lds
    s_add_u32 s50, s50, s55
    v_mfma_f32_16x16x32_bf16 v[216:219], v[120:123], v[100:103], v[216:219]
    s_add_u32 m0, s16, 20480
    s_add_u32 s52, s3, 0
    s_cmp_eq_u32 s19, 0
    buffer_load_dwordx4 v21, s[12:15], s52 offen sc1 lds
    s_cbranch_scc1 L_p2_x13
    s_add_u32 m0, s17, 20480
    s_add_u32 s52, s52, s18
    buffer_load_dwordx4 v21, s[12:15], s52 offen sc1 lds
L_p2_x13:
    s_waitcnt vmcnt(13) lgkmcnt(0)
    s_barrier
    v_mfma_f32_16x16x32_bf16 v[128:131], v[64:67], v[48:51], v[128:131]
    ds_read_b128 v[88:91], v15 offset:32768
    v_mfma_f32_16x16x32_bf16 v[152:155], v[64:67], v[52:55], v[152:155]
    ds_read_b128 v[92:95], v15 offset:34816
    v_mfma_f32_16x16x32_bf16 v[176:179], v[64:67], v[56:59], v[176:179]
    ds_read_b128 v[96:99], v15 offset:36864
    v_mfma_f32_16x16x32_bf16 v[200:203], v[64:67], v[60:63], v[200:203]
    ds_read_b128 v[100:103], v15 offset:38912
    v_mfma_f32_16x16x32_bf16 v[132:135], v[68:71], v[48:51], v[132:135]
    ds_read_b64_tr_b16 v[104:105], v16 offset:24576
    v_mfma_f32_16x16x32_bf16 v[156:159], v[68:71], v[52:55], v[156:159]
    ds_read_b64_tr_b16 v[106:107], v16 offset:26112
    v_mfma_f32_16x16x32_bf16 v[180:183], v[68:71], v[56:59], v[180:183]
    ds_read_b64_tr_b16 v[108:109], v17 offset:24576
    v_mfma_f32_16x16x32_bf16 v[204:207], v[68:71], v[60:63], v[204:207]
    ds_read_b64_tr_b16 v[110:111], v17 offset:26112
    v_mfma_f32_16x16x32_bf16 v[136:139], v[72:75], v[48:51], v[136:139]
    ds_read_b64_tr_b16 v[112:113], v18 offset:24576
    v_mfma_f32_16x16x32_bf16 v[160:163], v[72:75], v[52:55], v[160:163]
    ds_read_b64_tr_b16 v[114:115], v18 offset:26112
    v_mfma_f32_16x16x32_bf16 v[184:187], v[72:75], v[56:59], v[184:187]
    ds_read_b64_tr_b16 v[116:117], v19 offset:24576
    v_mfma_f32_16x16x32_bf16 v[208:211], v[72:75], v[60:63], v[208:211]
    ds_read_b64_tr_b16 v[118:119], v19 offset:26112
    v_mfma_f32_16x16x32_bf16 v[140:143], v[76:79], v[48:51], v[140:143]
    ds_read_b64_tr_b16 v[120:121], v20 offset:24576
    v_mfma_f32_16x16x32_bf16 v[164:167], v[76:79], v[52:55], v[164:167]
    ds_read_b64_tr_b16 v[122:123], v20 offset:26112
    v_mfma_f32_16x16x32_bf16 v[188:191], v[76:79], v[56:59], v[188:191]
    v_mfma_f32_16x16x32_bf16 v[212:215], v[76:79], v[60:63], v[212:215]
    v_mfma_f32_16x16x32_bf16 v[144:147], v[80:83], v[48:51], v[144:147]
    s_add_u32 m0, s16, 51200
    s_add_u32 s52, s3, 10240
    s_cmp_eq_u32 s19, 0
    buffer_load_dwordx4 v21, s[12:15], s52 offen sc1 lds
    s_cbranch_scc1 L_p2_x14
    s_add_u32 m0, s17, 51200
    s_add_u32 s52, s52, s18
    buffer_load_dwordx4 v21, s[12:15], s52 offen sc1 lds
L_p2_x14:
    v_mfma_f32_16x16x32_bf16 v[168:171], v[80:83], v[52:55], v[168:171]
    v_mfma_f32_16x16x32_bf16 v[192:195], v[80:83], v[56:59], v[192:195]
    s_add_u32 m0, s16, 61440
    s_add_u32 s52, s3, 20480
    s_cmp_eq_u32 s19, 0
    buffer_load_dwordx4 v21, s[12:15], s52 offen sc1 lds
    s_cbranch_scc1 L_p2_x15
    s_add_u32 m0, s17, 61440
    s_add_u32 s52, s52, s18
    buffer_load_dwordx4 v21, s[12:15], s52 offen sc1 lds
L_p2_x15:
    v_mfma_f32_16x16x32_bf16 v[216:219], v[80:83], v[60:63], v[216:219]
    s_waitcnt vmcnt(6) lgkmcnt(0)
    s_barrier
    s_cmp_lt_u32 s40, 6
    s_cbranch_scc0 L_Q_s17
    v_add_f32 v224, v224, v228
    v_add_f32 v225, v225, v229
    v_add_f32 v226, v226, v230
    v_add_f32 v227, v227, v231
    v_add_f32 v224, v224, v232
    v_add_f32 v225, v225, v233
    v_add_f32 v226, v226, v234
    v_add_f32 v227, v227, v235
    v_add_f32 v224, v224, v236
    v_add_f32 v225, v225, v237
    v_add_f32 v226, v226, v238
    v_add_f32 v227, v227, v239
    ds_write_b128 v30, v[224:227]
L_Q_s17:
    v_mfma_f32_16x16x32_bf16 v[128:131], v[104:107], v[88:91], v[128:131]
    ds_read_b128 v[48:51], v14 offset:0
    v_mfma_f32_16x16x32_bf16 v[152:155], v[104:107], v[92:95], v[152:155]
    ds_read_b128 v[52:55], v14 offset:2048
    v_mfma_f32_16x16x32_bf16 v[176:179], v[104:107], v[96:99], v[176:179]
    ds_read_b128 v[56:59], v14 offset:4096
    v_mfma_f32_16x16x32_bf16 v[200:203], v[104:107], v[100:103], v[200:203]
    ds_read_b128 v[60:63], v14 offset:6144
    v_mfma_f32_16x16x32_bf16 v[132:135], v[108:111], v[88:91], v[132:135]
    ds_read_b64_tr_b16 v[64:65], v22 offset:0
    v_mfma_f32_16x16x32_bf16 v[156:159], v[108:111], v[92:95], v[156:159]
    ds_read_b64_tr_b16 v[66:67], v22 offset:1536
    v_mfma_f32_16x16x32_bf16 v[180:183], v[108:111], v[96:99], v[180:183]
    ds_read_b64_tr_b16 v[68:69], v23 offset:0
    v_mfma_f32_16x16x32_bf16 v[204:207], v[108:111], v[100:103], v[204:207]
    ds_read_b64_tr_b16 v[70:71], v23 offset:1536
    v_mfma_f32_16x16x32_bf16 v[136:139], v[112:115], v[88:91], v[136:139]
    ds_read_b64_tr_b16 v[72:73], v24 offset:0
    v_mfma_f32_16x16x32_bf16 v[160:163], v[112:115], v[92:95], v[160:163]
    ds_read_b64_tr_b16 v[74:75], v24 offset:1536
    v_mfma_f32_16x16x32_bf16 v[184:187], v[112:115], v[96:99], v[184:187]
    ds_read_b64_tr_b16 v[76:77], v25 offset:0
    v_mfma_f32_16x16x32_bf16 v[208:211], v[112:115], v[100:103], v[208:211]
    ds_read_b64_tr_b16 v[78:79], v25 offset:1536
    v_mfma_f32_16x16x32_bf16 v[140:143], v[116:119], v[88:91], v[140:143]
    ds_read_b64_tr_b16 v[80:81], v26 offset:0
    s_add_u32 m0, s16, 30720
    s_add_u32 s52, s3, 30720
    s_cmp_eq_u32 s19, 0
    buffer_load_dwordx4 v21, s[12:15], s52 offen sc1 lds
    s_cbranch_scc1 L_p2_x16
    s_add_u32 m0, s17, 30720
    s_add_u32 s52, s52, s18
    buffer_load_dwordx4 v21, s[12:15], s52 offen sc1 lds
L_p2_x16:
    v_mfma_f32_16x16x32_bf16 v[164:167], v[116:119], v[92:95], v[164:167]
    ds_read_b64_tr_b16 v[82:83], v26 offset:1536
    v_mfma_f32_16x16x32_bf16 v[188:191], v[116:119], v[96:99], v[188:191]
    s_add_u32 m0, s16, 40960
    s_add_u32 s52, s3, 40960
    s_cmp_eq_u32 s19, 0
    buffer_load_dwordx4 v21, s[12:15], s52 offen sc1 lds
    s_cbranch_scc1 L_p2_x17
    s_add_u32 m0, s17, 40960
    s_add_u32 s52, s52, s18
    buffer_load_dwordx4 v21, s[12:15], s52 offen sc1 lds
L_p2_x17:
    v_mfma_f32_16x16x32_bf16 v[212:215], v[116:119], v[100:103], v[212:215]
    v_mfma_f32_16x16x32_bf16 v[144:147], v[120:123], v[88:91], v[144:147]
    s_add_u32 m0, s16, 71680
    s_add_u32 s52, s3, 51200
    s_cmp_eq_u32 s19, 0
    buffer_load_dwordx4 v21, s[12:15], s52 offen sc1 lds
    s_cbranch_scc1 L_p2_x18
    s_add_u32 m0, s17, 71680
    s_add_u32 s52, s52, s18
    buffer_load_dwordx4 v21, s[12:15], s52 offen sc1 lds
L_p2_x18:
    v_mfma_f32_16x16x32_bf16 v[168:171], v[120:123], v[92:95], v[168:171]
    v_mfma_f32_16x16x32_bf16 v[192:195], v[120:123], v[96:99], v[192:195]
    s_add_u32 m0, s16, 81920
    s_add_u32 s52, s3, 61440
    s_cmp_eq_u32 s19, 0
    buffer_load_dwordx4 v21, s[12:15], s52 offen sc1 lds
    s_cbranch_scc1 L_p2_x19
    s_add_u32 m0, s17, 81920
    s_add_u32 s52, s52, s18
    buffer_load_dwordx4 v21, s[12:15], s52 offen sc1 lds
L_p2_x19:
    v_mfma_f32_16x16x32_bf16 v[216:219], v[120:123], v[100:103], v[216:219]
    s_waitcnt vmcnt(7) lgkmcnt(0)
    s_barrier
    s_cmp_lt_u32 s40, 2
    s_cbranch_scc0 L_Q_s18
    v_cmp_gt_u32 vcc, 96, v0
    s_nop 0
    s_and_saveexec_b64 s[60:61], vcc
    v_lshlrev_b32 v2, 4, v0
    v_add_u32 v3, 147456, v2
    ds_read_b128 v[224:227], v3 offset:0
    ds_read_b128 v[228:231], v3 offset:1536
    ds_read_b128 v[232:235], v3 offset:3072
    ds_read_b128 v[236:239], v3 offset:4608
    s_mov_b64 exec, s[60:61]
L_Q_s18:
    v_mfma_f32_16x16x32_bf16 v[128:131], v[64:67], v[48:51], v[128:131]
    ds_read_b128 v[88:91], v15 offset:0
    v_mfma_f32_16x16x32_bf16 v[152:155], v[64:67], v[52:55], v[152:155]
    ds_read_b128 v[92:95], v15 offset:2048
    v_mfma_f32_16x16x32_bf16 v[176:179], v[64:67], v[56:59], v[176:179]
    ds_read_b128 v[96:99], v15 offset:4096
    v_mfma_f32_16x16x32_bf16 v[200:203], v[64:67], v[60:63], v[200:203]
    ds_read_b128 v[100:103], v15 offset:6144
    v_mfma_f32_16x16x32_bf16 v[132:135], v[68:71], v[48:51], v[132:135]
    ds_read_b64_tr_b16 v[104:105], v22 offset:24576
    v_mfma_f32_16x16x32_bf16 v[156:159], v[68:71], v[52:55], v[156:159]
    ds_read_b64_tr_b16 v[106:107], v22 offset:26112
    v_mfma_f32_16x16x32_bf16 v[180:183], v[68:71], v[56:59], v[180:183]
    ds_read_b64_tr_b16 v[108:109], v23 offset:24576
    v_mfma_f32_16x16x32_bf16 v[204:207], v[68:71], v[60:63], v[204:207]
    ds_read_b64_tr_b16 v[110:111], v23 offset:26112
    v_mfma_f32_16x16x32_bf16 v[136:139], v[72:75], v[48:51], v[136:139]
    ds_read_b64_tr_b16 v[112:113], v24 offset:24576
    v_mfma_f32_16x16x32_bf16 v[160:163], v[72:75], v[52:55], v[160:163]
    ds_read_b64_tr_b16 v[114:115], v24 offset:26112
    v_mfma_f32_16x16x32_bf16 v[184:187], v[72:75], v[56:59], v[184:187]
    ds_read_b64_tr_b16 v[116:117], v25 offset:24576
    v_mfma_f32_16x16x32_bf16 v[208:211], v[72:75], v[60:63], v[208:211]
    ds_read_b64_tr_b16 v[118:119], v25 offset:26112
    v_mfma_f32_16x16x32_bf16 v[140:143], v[76:79], v[48:51], v[140:143]
    ds_read_b64_tr_b16 v[120:121], v26 offset:24576
    v_mfma_f32_16x16x32_bf16 v[164:167], v[76:79], v[52:55], v[164:167]
    ds_read_b64_tr_b16 v[122:123], v26 offset:26112
    v_mfma_f32_16x16x32_bf16 v[188:191], v[76:79], v[56:59], v[188:191]
    s_add_u32 m0, s16, 92160
    s_add_u32 s52, s3, 71680
    s_cmp_eq_u32 s19, 0
    buffer_load_dwordx4 v21, s[12:15], s52 offen sc1 lds
    s_cbranch_scc1 L_p2_x20
    s_add_u32 m0, s17, 92160
    s_add_u32 s52, s52, s18
    buffer_load_dwordx4 v21, s[12:15], s52 offen sc1 lds
L_p2_x20:
    v_mfma_f32_16x16x32_bf16 v[212:215], v[76:79], v[60:63], v[212:215]
    v_mfma_f32_16x16x32_bf16 v[144:147], v[80:83], v[48:51], v[144:147]
    s_add_u32 m0, s16, 102400
    s_add_u32 s52, s3, 81920
    s_cmp_eq_u32 s19, 0
    buffer_load_dwordx4 v21, s[12:15], s52 offen sc1 lds
    s_cbranch_scc1 L_p2_x21
    s_add_u32 m0, s17, 102400
    s_add_u32 s52, s52, s18
    buffer_load_dwordx4 v21, s[12:15], s52 offen sc1 lds
L_p2_x21:
    v_mfma_f32_16x16x32_bf16 v[168:171], v[80:83], v[52:55], v[168:171]
    v_mfma_f32_16x16x32_bf16 v[192:195], v[80:83], v[56:59], v[192:195]
    s_add_u32 m0, s16, 112640
    s_add_u32 s52, s3, 92160
    s_cmp_eq_u32 s19, 0
    buffer_load_dwordx4 v21, s[12:15], s52 offen sc1 lds
    s_cbranch_scc1 L_p2_x22
    s_add_u32 m0, s17, 112640
    s_add_u32 s52, s52, s18
    buffer_load_dwordx4 v21, s[12:15], s52 offen sc1 lds
L_p2_x22:
    v_mfma_f32_16x16x32_bf16 v[216:219], v[80:83], v[60:63], v[216:219]
    s_cmp_lt_u32 s40, 2
    s_cbranch_scc0 L_Q_e18a
    s_and_saveexec_b64 s[60:61], vcc
    s_waitcnt lgkmcnt(0)
    v_add_f32 v224, v224, v228
    v_add_f32 v225, v225, v229
    v_add_f32 v226, v226, v230
    v_add_f32 v227, v227, v231
    v_add_f32 v224, v224, v232
    v_add_f32 v225, v225, v233
    v_add_f32 v226, v226, v234
    v_add_f32 v227, v227, v235
    v_add_f32 v224, v224, v236
    v_add_f32 v225, v225, v237
    v_add_f32 v226, v226, v238
    v_add_f32 v227, v227, v239
    ds_write_b128 v3, v[224:227] offset:12288
    s_mov_b64 exec, s[60:61]
L_Q_e18a:
    s_cmp_ge_u32 s40, 6
    s_cbranch_scc0 L_Q_e18b
    s_waitcnt vmcnt(10)
    ds_write_b32 v30, v240
    ds_write_b32 v30, v241 offset:512
L_Q_e18b:
    s_waitcnt lgkmcnt(0)
    s_barrier
    v_and_b32 v2, 15, v1
    s_lshl_b32 s60, s45, 8
    s_add_u32 s60, s60, 161280
    v_lshl_add_u32 v2, v2, 2, s60
    v_mfma_f32_16x16x32_bf16 v[128:131], v[104:107], v[88:91], v[128:131]
    ds_read_b128 v[48:51], v31
    ds_read_b128 v[52:55], v32
    ds_read_b128 v[56:59], v33
    v_mfma_f32_16x16x32_bf16 v[152:155], v[104:107], v[92:95], v[152:155]
    ds_read_b128 v[60:63], v34
    ds_read_b128 v[64:67], v35
    ds_read_b32 v72, v2 offset:0
    v_mfma_f32_16x16x32_bf16 v[176:179], v[104:107], v[96:99], v[176:179]
    ds_read_b32 v80, v2 offset:512
    ds_read_b32 v74, v2 offset:64
    ds_read_b32 v82, v2 offset:576
    s_add_u32 m0, s16, 0
    s_add_u32 s52, s3, 102400
    s_cmp_eq_u32 s19, 0
    buffer_load_dwordx4 v21, s[12:15], s52 offen sc1 lds
    s_cbranch_scc1 L_p2_x23
    s_add_u32 m0, s17, 0
    s_add_u32 s52, s52, s18
    buffer_load_dwordx4 v21, s[12:15], s52 offen sc1 lds
L_p2_x23:
    v_mfma_f32_16x16x32_bf16 v[200:203], v[104:107], v[100:103], v[200:203]
    ds_read_b32 v76, v2 offset:128
    ds_read_b32 v84, v2 offset:640
    ds_read_b32 v78, v2 offset:192
    v_mfma_f32_16x16x32_bf16 v[132:135], v[108:111], v[88:91], v[132:135]
    ds_read_b32 v86, v2 offset:704
    s_lshl_b32 s60, s41, 1
    s_add_u32 s60, s60, s45
    v_mfma_f32_16x16x32_bf16 v[156:159], v[108:111], v[92:95], v[156:159]
    s_mul_i32 s60, s60, 303104
    s_lshl_b32 s61, s47, 12
    s_add_u32 s60, s60, s61
    v_mfma_f32_16x16x32_bf16 v[180:183], v[108:111], v[96:99], v[180:183]
    s_lshr_b32 s61, s46, 1
    s_mul_i32 s61, s61, 40960
    s_add_u32 s60, s60, s61
    s_add_u32 m0, s16, 10240
    s_add_u32 s52, s3, 112640
    s_cmp_eq_u32 s19, 0
    buffer_load_dwordx4 v21, s[12:15], s52 offen sc1 lds
    s_cbranch_scc1 L_p2_x24
    s_add_u32 m0, s17, 10240
    s_add_u32 s52, s52, s18
    buffer_load_dwordx4 v21, s[12:15], s52 offen sc1 lds
L_p2_x24:
    v_mfma_f32_16x16x32_bf16 v[204:207], v[108:111], v[100:103], v[204:207]
    s_add_u32 s65, s60, 221184
    s_and_b32 s62, s46, 1
    s_lshl_b32 s61, s62, 14
    v_mfma_f32_16x16x32_bf16 v[136:139], v[112:115], v[88:91], v[136:139]
    s_add_u32 s66, s65, s61
    s_add_u32 s66, s66, 8192
    s_add_u32 s67, s66, 8192
    v_mfma_f32_16x16x32_bf16 v[160:163], v[112:115], v[92:95], v[160:163]
    s_lshl_b32 s62, s62, 11
    s_add_u32 s65, s65, s62
    v_lshlrev_b32 v3, 4, v1
    v_mfma_f32_16x16x32_bf16 v[184:187], v[112:115], v[96:99], v[184:187]
    s_mov_b32 s60, 0x3fb8aa3b
    s_lshr_b32 s61, s40, 1
    s_lshl_b32 s61, s61, 12
    v_mfma_f32_16x16x32_bf16 v[208:211], v[112:115], v[100:103], v[208:211]
    s_add_u32 s61, s61, 122880
    s_and_b32 s62, s40, 1
    s_lshl_b32 s63, s62, 3
    v_mfma_f32_16x16x32_bf16 v[140:143], v[116:119], v[88:91], v[140:143]
    s_lshl_b32 s62, s62, 11
    s_add_u32 s63, s63, s61
    s_add_u32 s61, s61, s62
    v_mfma_f32_16x16x32_bf16 v[164:167], v[116:119], v[92:95], v[164:167]
    v_add_u32 v4, s63, v3
    v_add_u32 v5, s61, v3
    v_mfma_f32_16x16x32_bf16 v[188:191], v[116:119], v[96:99], v[188:191]
    s_lshl_b32 s82, s41, 7
    s_lshl_b32 s61, s47, 3
    v_mfma_f32_16x16x32_bf16 v[212:215], v[116:119], v[100:103], v[212:215]
    s_add_u32 s82, s82, s61
    s_add_u32 s82, s82, 16916552
    v_mfma_f32_16x16x32_bf16 v[144:147], v[120:123], v[88:91], v[144:147]
    v_mfma_f32_16x16x32_bf16 v[168:171], v[120:123], v[92:95], v[168:171]
    v_mfma_f32_16x16x32_bf16 v[192:195], v[120:123], v[96:99], v[192:195]
    v_mfma_f32_16x16x32_bf16 v[216:219], v[120:123], v[100:103], v[216:219]
L_Q_ch0:
    s_waitcnt lgkmcnt(0)
    s_mov_b32 s69, s68
    v_mul_f32 v73, s60, v80
    v_mul_f32 v75, s60, v82
    v_mul_f32 v77, s60, v84
    v_mul_f32 v79, s60, v86
    v_fmac_f32 v144, v72, v64
    v_fmac_f32 v145, v72, v65
    v_fmac_f32 v146, v72, v66
    v_fmac_f32 v147, v72, v67
    v_mul_f32 v240, v144, v73
    v_mul_f32 v241, v145, v73
    v_mul_f32 v242, v146, v73
    v_mul_f32 v243, v147, v73
    v_exp_f32 v240, v240 clamp
    v_max_f32 v144, 0, v144
    v_exp_f32 v241, v241 clamp
    v_max_f32 v145, 0, v145
    v_exp_f32 v242, v242 clamp
    v_max_f32 v146, 0, v146
    v_exp_f32 v243, v243 clamp
    v_max_f32 v147, 0, v147
    v_fmac_f32 v240, v144, v80
    v_fmac_f32 v241, v145, v80
    v_fmac_f32 v242, v146, v80
    v_fmac_f32 v243, v147, v80
    v_add_f32 v240, s68, v240
    v_add_f32 v241, s68, v241
    v_add_f32 v242, s68, v242
    v_add_f32 v243, s68, v243
    v_cvt_pk_bf16_f32 v96, v240, v241
    v_cvt_pk_bf16_f32 v97, v242, v243
    ds_write_b64 v4, v[96:97] offset:0
    v_fmac_f32 v168, v74, v64
    v_fmac_f32 v169, v74, v65
    v_fmac_f32 v170, v74, v66
    v_fmac_f32 v171, v74, v67
    v_mul_f32 v240, v168, v75
    v_mul_f32 v241, v169, v75
    v_mul_f32 v242, v170, v75
    v_mul_f32 v243, v171, v75
    v_exp_f32 v240, v240 clamp
    v_max_f32 v168, 0, v168
    v_exp_f32 v241, v241 clamp
    v_max_f32 v169, 0, v169
    v_exp_f32 v242, v242 clamp
    v_max_f32 v170, 0, v170
    v_exp_f32 v243, v243 clamp
    v_max_f32 v171, 0, v171
    v_fmac_f32 v240, v168, v82
    v_fmac_f32 v241, v169, v82
    v_fmac_f32 v242, v170, v82
    v_fmac_f32 v243, v171, v82
    v_add_f32 v240, s68, v240
    v_add_f32 v241, s68, v241
    v_add_f32 v242, s68, v242
    v_add_f32 v243, s68, v243
    v_cvt_pk_bf16_f32 v108, v240, v241
    v_cvt_pk_bf16_f32 v109, v242, v243
    ds_write_b64 v4, v[108:109] offset:1024
    v_fmac_f32 v192, v76, v64
    v_fmac_f32 v193, v76, v65
    v_fmac_f32 v194, v76, v66
    v_fmac_f32 v195, v76, v67
    v_mul_f32 v240, v192, v77
    v_mul_f32 v241, v193, v77
    v_mul_f32 v242, v194, v77
    v_mul_f32 v243, v195, v77
    v_exp_f32 v240, v240 clamp
    v_max_f32 v192, 0, v192
    v_exp_f32 v241, v241 clamp
    v_max_f32 v193, 0, v193
    v_exp_f32 v242, v242 clamp
    v_max_f32 v194, 0, v194
    v_exp_f32 v243, v243 clamp
    v_max_f32 v195, 0, v195
    v_fmac_f32 v240, v192, v84
    v_fmac_f32 v241, v193, v84
    v_fmac_f32 v242, v194, v84
    v_fmac_f32 v243, v195, v84
    v_add_f32 v240, s68, v240
    v_add_f32 v241, s68, v241
    v_add_f32 v242, s68, v242
    v_add_f32 v243, s68, v243
    v_cvt_pk_bf16_f32 v96, v240, v241
    v_cvt_pk_bf16_f32 v97, v242, v243
    ds_write_b64 v4, v[96:97] offset:2048
    v_fmac_f32 v216, v78, v64
    v_fmac_f32 v217, v78, v65
    v_fmac_f32 v218, v78, v66
    v_fmac_f32 v219, v78, v67
    v_mul_f32 v240, v216, v79
    v_mul_f32 v241, v217, v79
    v_mul_f32 v242, v218, v79
    v_mul_f32 v243, v219, v79
    v_exp_f32 v240, v240 clamp
    v_max_f32 v216, 0, v216
    v_exp_f32 v241, v241 clamp
    v_max_f32 v217, 0, v217
    v_exp_f32 v242, v242 clamp
    v_max_f32 v218, 0, v218
    v_exp_f32 v243, v243 clamp
    v_max_f32 v219, 0, v219
    v_fmac_f32 v240, v216, v86
    v_fmac_f32 v241, v217, v86
    v_fmac_f32 v242, v218, v86
    v_fmac_f32 v243, v219, v86
    v_add_f32 v240, s68, v240
    v_add_f32 v241, s68, v241
    v_add_f32 v242, s68, v242
    v_add_f32 v243, s68, v243
    v_cvt_pk_bf16_f32 v108, v240, v241
    v_cvt_pk_bf16_f32 v109, v242, v243
    ds_write_b64 v4, v[108:109] offset:3072
    v_fmac_f32 v128, v72, v48
    v_fmac_f32 v129, v72, v49
    v_fmac_f32 v130, v72, v50
    v_fmac_f32 v131, v72, v51
    v_mul_f32 v240, v128, v73
    v_mul_f32 v241, v129, v73
    v_mul_f32 v242, v130, v73
    v_mul_f32 v243, v131, v73
    v_exp_f32 v240, v240 clamp
    v_max_f32 v128, 0, v128
    v_exp_f32 v241, v241 clamp
    v_max_f32 v129, 0, v129
    v_exp_f32 v242, v242 clamp
    v_max_f32 v130, 0, v130
    v_exp_f32 v243, v243 clamp
    v_max_f32 v131, 0, v131
    v_fmac_f32 v240, v128, v80
    v_fmac_f32 v241, v129, v80
    v_fmac_f32 v242, v130, v80
    v_fmac_f32 v243, v131, v80
    v_add_f32 v240, s68, v240
    v_add_f32 v241, s68, v241
    v_add_f32 v242, s68, v242
    v_add_f32 v243, s68, v243
    v_cvt_pk_bf16_f32 v88, v240, v241
    v_cvt_pk_bf16_f32 v89, v242, v243
    v_fmac_f32 v132, v72, v52
    v_fmac_f32 v133, v72, v53
    v_fmac_f32 v134, v72, v54
    v_fmac_f32 v135, v72, v55
    v_mul_f32 v244, v132, v73
    v_mul_f32 v245, v133, v73
    v_mul_f32 v246, v134, v73
    v_mul_f32 v247, v135, v73
    v_exp_f32 v244, v244 clamp
    v_max_f32 v132, 0, v132
    v_exp_f32 v245, v245 clamp
    v_max_f32 v133, 0, v133
    v_exp_f32 v246, v246 clamp
    v_max_f32 v134, 0, v134
    v_exp_f32 v247, v247 clamp
    v_max_f32 v135, 0, v135
    v_fmac_f32 v244, v132, v80
    v_fmac_f32 v245, v133, v80
    v_fmac_f32 v246, v134, v80
    v_fmac_f32 v247, v135, v80
    v_add_f32 v244, s68, v244
    v_add_f32 v245, s68, v245
    v_add_f32 v246, s68, v246
    v_add_f32 v247, s68, v247
    v_cvt_pk_bf16_f32 v90, v244, v245
    v_cvt_pk_bf16_f32 v91, v246, v247
    buffer_store_dwordx4 v[88:91], v3, s[12:15], s66 offen offset:0 sc1
    v_fmac_f32 v136, v72, v56
    v_fmac_f32 v137, v72, v57
    v_fmac_f32 v138, v72, v58
    v_fmac_f32 v139, v72, v59
    v_mul_f32 v240, v136, v73
    v_mul_f32 v241, v137, v73
    v_mul_f32 v242, v138, v73
    v_mul_f32 v243, v139, v73
    v_exp_f32 v240, v240 clamp
    v_max_f32 v136, 0, v136
    v_exp_f32 v241, v241 clamp
    v_max_f32 v137, 0, v137
    v_exp_f32 v242, v242 clamp
    v_max_f32 v138, 0, v138
    v_exp_f32 v243, v243 clamp
    v_max_f32 v139, 0, v139
    v_fmac_f32 v240, v136, v80
    v_fmac_f32 v241, v137, v80
    v_fmac_f32 v242, v138, v80
    v_fmac_f32 v243, v139, v80
    v_add_f32 v240, s68, v240
    v_add_f32 v241, s68, v241
    v_add_f32 v242, s68, v242
    v_add_f32 v243, s68, v243
    v_cvt_pk_bf16_f32 v92, v240, v241
    v_cvt_pk_bf16_f32 v93, v242, v243
    v_fmac_f32 v140, v72, v60
    v_fmac_f32 v141, v72, v61
    v_fmac_f32 v142, v72, v62
    v_fmac_f32 v143, v72, v63
    v_mul_f32 v244, v140, v73
    v_mul_f32 v245, v141, v73
    v_mul_f32 v246, v142, v73
    v_mul_f32 v247, v143, v73
    v_exp_f32 v244, v244 clamp
    v_max_f32 v140, 0, v140
    v_exp_f32 v245, v245 clamp
    v_max_f32 v141, 0, v141
    v_exp_f32 v246, v246 clamp
    v_max_f32 v142, 0, v142
    v_exp_f32 v247, v247 clamp
    v_max_f32 v143, 0, v143
    v_fmac_f32 v244, v140, v80
    v_fmac_f32 v245, v141, v80
    v_fmac_f32 v246, v142, v80
    v_fmac_f32 v247, v143, v80
    v_add_f32 v244, s68, v244
    v_add_f32 v245, s68, v245
    v_add_f32 v246, s68, v246
    v_add_f32 v247, s68, v247
    v_cvt_pk_bf16_f32 v94, v244, v245
    v_cvt_pk_bf16_f32 v95, v246, v247
    buffer_store_dwordx4 v[92:95], v3, s[12:15], s67 offen offset:0 sc1
    v_fmac_f32 v152, v74, v48
    v_fmac_f32 v153, v74, v49
    v_fmac_f32 v154, v74, v50
    v_fmac_f32 v155, v74, v51
    v_mul_f32 v240, v152, v75
    v_mul_f32 v241, v153, v75
    v_mul_f32 v242, v154, v75
    v_mul_f32 v243, v155, v75
    v_exp_f32 v240, v240 clamp
    v_max_f32 v152, 0, v152
    v_exp_f32 v241, v241 clamp
    v_max_f32 v153, 0, v153
    v_exp_f32 v242, v242 clamp
    v_max_f32 v154, 0, v154
    v_exp_f32 v243, v243 clamp
    v_max_f32 v155, 0, v155
    v_fmac_f32 v240, v152, v82
    v_fmac_f32 v241, v153, v82
    v_fmac_f32 v242, v154, v82
    v_fmac_f32 v243, v155, v82
    v_add_f32 v240, s68, v240
    v_add_f32 v241, s68, v241
    v_add_f32 v242, s68, v242
    v_add_f32 v243, s68, v243
    v_cvt_pk_bf16_f32 v100, v240, v241
    v_cvt_pk_bf16_f32 v101, v242, v243
    v_fmac_f32 v156, v74, v52
    v_fmac_f32 v157, v74, v53
    v_fmac_f32 v158, v74, v54
    v_fmac_f32 v159, v74, v55
    v_mul_f32 v244, v156, v75
    v_mul_f32 v245, v157, v75
    v_mul_f32 v246, v158, v75
    v_mul_f32 v247, v159, v75
    v_exp_f32 v244, v244 clamp
    v_max_f32 v156, 0, v156
    v_exp_f32 v245, v245 clamp
    v_max_f32 v157, 0, v157
    v_exp_f32 v246, v246 clamp
    v_max_f32 v158, 0, v158
    v_exp_f32 v247, v247 clamp
    v_max_f32 v159, 0, v159
    v_fmac_f32 v244, v156, v82
    v_fmac_f32 v245, v157, v82
    v_fmac_f32 v246, v158, v82
    v_fmac_f32 v247, v159, v82
    v_add_f32 v244, s68, v244
    v_add_f32 v245, s68, v245
    v_add_f32 v246, s68, v246
    v_add_f32 v247, s68, v247
    v_cvt_pk_bf16_f32 v102, v244, v245
    v_cvt_pk_bf16_f32 v103, v246, v247
    buffer_store_dwordx4 v[100:103], v3, s[12:15], s66 offen offset:1024 sc1
    v_fmac_f32 v160, v74, v56
    v_fmac_f32 v161, v74, v57
    v_fmac_f32 v162, v74, v58
    v_fmac_f32 v163, v74, v59
    v_mul_f32 v240, v160, v75
    v_mul_f32 v241, v161, v75
    v_mul_f32 v242, v162, v75
    v_mul_f32 v243, v163, v75
    v_exp_f32 v240, v240 clamp
    v_max_f32 v160, 0, v160
    v_exp_f32 v241, v241 clamp
    v_max_f32 v161, 0, v161
    v_exp_f32 v242, v242 clamp
    v_max_f32 v162, 0, v162
    v_exp_f32 v243, v243 clamp
    v_max_f32 v163, 0, v163
    v_fmac_f32 v240, v160, v82
    v_fmac_f32 v241, v161, v82
    v_fmac_f32 v242, v162, v82
    v_fmac_f32 v243, v163, v82
    v_add_f32 v240, s68, v240
    v_add_f32 v241, s68, v241
    v_add_f32 v242, s68, v242
    v_add_f32 v243, s68, v243
    v_cvt_pk_bf16_f32 v104, v240, v241
    v_cvt_pk_bf16_f32 v105, v242, v243
    v_fmac_f32 v164, v74, v60
    v_fmac_f32 v165, v74, v61
    v_fmac_f32 v166, v74, v62
    v_fmac_f32 v167, v74, v63
    v_mul_f32 v244, v164, v75
    v_mul_f32 v245, v165, v75
    v_mul_f32 v246, v166, v75
    v_mul_f32 v247, v167, v75
    v_exp_f32 v244, v244 clamp
    v_max_f32 v164, 0, v164
    v_exp_f32 v245, v245 clamp
    v_max_f32 v165, 0, v165
    v_exp_f32 v246, v246 clamp
    v_max_f32 v166, 0, v166
    v_exp_f32 v247, v247 clamp
    v_max_f32 v167, 0, v167
    v_fmac_f32 v244, v164, v82
    v_fmac_f32 v245, v165, v82
    v_fmac_f32 v246, v166, v82
    v_fmac_f32 v247, v167, v82
    v_add_f32 v244, s68, v244
    v_add_f32 v245, s68, v245
    v_add_f32 v246, s68, v246
    v_add_f32 v247, s68, v247
    v_cvt_pk_bf16_f32 v106, v244, v245
    v_cvt_pk_bf16_f32 v107, v246, v247
    buffer_store_dwordx4 v[104:107], v3, s[12:15], s67 offen offset:1024 sc1
    s_waitcnt lgkmcnt(0)
    s_barrier
    ds_read_b128 v[224:227], v5
    ds_read_b128 v[228:231], v5 offset:1024
    v_fmac_f32 v176, v76, v48
    v_fmac_f32 v177, v76, v49
    v_fmac_f32 v178, v76, v50
    v_fmac_f32 v179, v76, v51
    v_mul_f32 v240, v176, v77
    v_mul_f32 v241, v177, v77
    v_mul_f32 v242, v178, v77
    v_mul_f32 v243, v179, v77
    v_exp_f32 v240, v240 clamp
    v_max_f32 v176, 0, v176
    v_exp_f32 v241, v241 clamp
    v_max_f32 v177, 0, v177
    v_exp_f32 v242, v242 clamp
    v_max_f32 v178, 0, v178
    v_exp_f32 v243, v243 clamp
    v_max_f32 v179, 0, v179
    v_fmac_f32 v240, v176, v84
    v_fmac_f32 v241, v177, v84
    v_fmac_f32 v242, v178, v84
    v_fmac_f32 v243, v179, v84
    v_add_f32 v240, s68, v240
    v_add_f32 v241, s68, v241
    v_add_f32 v242, s68, v242
    v_add_f32 v243, s68, v243
    v_cvt_pk_bf16_f32 v88, v240, v241
    v_cvt_pk_bf16_f32 v89, v242, v243
    v_fmac_f32 v180, v76, v52
    v_fmac_f32 v181, v76, v53
    v_fmac_f32 v182, v76, v54
    v_fmac_f32 v183, v76, v55
    v_mul_f32 v244, v180, v77
    v_mul_f32 v245, v181, v77
    v_mul_f32 v246, v182, v77
    v_mul_f32 v247, v183, v77
    v_exp_f32 v244, v244 clamp
    v_max_f32 v180, 0, v180
    v_exp_f32 v245, v245 clamp
    v_max_f32 v181, 0, v181
    v_exp_f32 v246, v246 clamp
    v_max_f32 v182, 0, v182
    v_exp_f32 v247, v247 clamp
    v_max_f32 v183, 0, v183
    v_fmac_f32 v244, v180, v84
    v_fmac_f32 v245, v181, v84
    v_fmac_f32 v246, v182, v84
    v_fmac_f32 v247, v183, v84
    v_add_f32 v244, s68, v244
    v_add_f32 v245, s68, v245
    v_add_f32 v246, s68, v246
    v_add_f32 v247, s68, v247
    v_cvt_pk_bf16_f32 v90, v244, v245
    v_cvt_pk_bf16_f32 v91, v246, v247
    buffer_store_dwordx4 v[88:91], v3, s[12:15], s66 offen offset:2048 sc1
    v_fmac_f32 v184, v76, v56
    v_fmac_f32 v185, v76, v57
    v_fmac_f32 v186, v76, v58
    v_fmac_f32 v187, v76, v59
    v_mul_f32 v240, v184, v77
    v_mul_f32 v241, v185, v77
    v_mul_f32 v242, v186, v77
    v_mul_f32 v243, v187, v77
    v_exp_f32 v240, v240 clamp
    v_max_f32 v184, 0, v184
    v_exp_f32 v241, v241 clamp
    v_max_f32 v185, 0, v185
    v_exp_f32 v242, v242 clamp
    v_max_f32 v186, 0, v186
    v_exp_f32 v243, v243 clamp
    v_max_f32 v187, 0, v187
    v_fmac_f32 v240, v184, v84
    v_fmac_f32 v241, v185, v84
    v_fmac_f32 v242, v186, v84
    v_fmac_f32 v243, v187, v84
    v_add_f32 v240, s68, v240
    v_add_f32 v241, s68, v241
    v_add_f32 v242, s68, v242
    v_add_f32 v243, s68, v243
    v_cvt_pk_bf16_f32 v92, v240, v241
    v_cvt_pk_bf16_f32 v93, v242, v243
    v_fmac_f32 v188, v76, v60
    v_fmac_f32 v189, v76, v61
    v_fmac_f32 v190, v76, v62
    v_fmac_f32 v191, v76, v63
    v_mul_f32 v244, v188, v77
    v_mul_f32 v245, v189, v77
    v_mul_f32 v246, v190, v77
    v_mul_f32 v247, v191, v77
    v_exp_f32 v244, v244 clamp
    v_max_f32 v188, 0, v188
    v_exp_f32 v245, v245 clamp
    v_max_f32 v189, 0, v189
    v_exp_f32 v246, v246 clamp
    v_max_f32 v190, 0, v190
    v_exp_f32 v247, v247 clamp
    v_max_f32 v191, 0, v191
    v_fmac_f32 v244, v188, v84
    v_fmac_f32 v245, v189, v84
    v_fmac_f32 v246, v190, v84
    v_fmac_f32 v247, v191, v84
    v_add_f32 v244, s68, v244
    v_add_f32 v245, s68, v245
    v_add_f32 v246, s68, v246
    v_add_f32 v247, s68, v247
    v_cvt_pk_bf16_f32 v94, v244, v245
    v_cvt_pk_bf16_f32 v95, v246, v247
    buffer_store_dwordx4 v[92:95], v3, s[12:15], s67 offen offset:2048 sc1
    v_fmac_f32 v200, v78, v48
    v_fmac_f32 v201, v78, v49
    v_fmac_f32 v202, v78, v50
    v_fmac_f32 v203, v78, v51
    v_mul_f32 v240, v200, v79
    v_mul_f32 v241, v201, v79
    v_mul_f32 v242, v202, v79
    v_mul_f32 v243, v203, v79
    v_exp_f32 v240, v240 clamp
    v_max_f32 v200, 0, v200
    v_exp_f32 v241, v241 clamp
    v_max_f32 v201, 0, v201
    v_exp_f32 v242, v242 clamp
    v_max_f32 v202, 0, v202
    v_exp_f32 v243, v243 clamp
    v_max_f32 v203, 0, v203
    v_fmac_f32 v240, v200, v86
    v_fmac_f32 v241, v201, v86
    v_fmac_f32 v242, v202, v86
    v_fmac_f32 v243, v203, v86
    v_add_f32 v240, s68, v240
    v_add_f32 v241, s68, v241
    v_add_f32 v242, s68, v242
    v_add_f32 v243, s68, v243
    v_cvt_pk_bf16_f32 v100, v240, v241
    v_cvt_pk_bf16_f32 v101, v242, v243
    v_fmac_f32 v204, v78, v52
    v_fmac_f32 v205, v78, v53
    v_fmac_f32 v206, v78, v54
    v_fmac_f32 v207, v78, v55
    v_mul_f32 v244, v204, v79
    v_mul_f32 v245, v205, v79
    v_mul_f32 v246, v206, v79
    v_mul_f32 v247, v207, v79
    v_exp_f32 v244, v244 clamp
    v_max_f32 v204, 0, v204
    v_exp_f32 v245, v245 clamp
    v_max_f32 v205, 0, v205
    v_exp_f32 v246, v246 clamp
    v_max_f32 v206, 0, v206
    v_exp_f32 v247, v247 clamp
    v_max_f32 v207, 0, v207
    v_fmac_f32 v244, v204, v86
    v_fmac_f32 v245, v205, v86
    v_fmac_f32 v246, v206, v86
    v_fmac_f32 v247, v207, v86
    v_add_f32 v244, s68, v244
    v_add_f32 v245, s68, v245
    v_add_f32 v246, s68, v246
    v_add_f32 v247, s68, v247
    v_cvt_pk_bf16_f32 v102, v244, v245
    v_cvt_pk_bf16_f32 v103, v246, v247
    buffer_store_dwordx4 v[100:103], v3, s[12:15], s66 offen offset:3072 sc1
    v_fmac_f32 v208, v78, v56
    v_fmac_f32 v209, v78, v57
    v_fmac_f32 v210, v78, v58
    v_fmac_f32 v211, v78, v59
    v_mul_f32 v240, v208, v79
    v_mul_f32 v241, v209, v79
    v_mul_f32 v242, v210, v79
    v_mul_f32 v243, v211, v79
    v_exp_f32 v240, v240 clamp
    v_max_f32 v208, 0, v208
    v_exp_f32 v241, v241 clamp
    v_max_f32 v209, 0, v209
    v_exp_f32 v242, v242 clamp
    v_max_f32 v210, 0, v210
    v_exp_f32 v243, v243 clamp
    v_max_f32 v211, 0, v211
    v_fmac_f32 v240, v208, v86
    v_fmac_f32 v241, v209, v86
    v_fmac_f32 v242, v210, v86
    v_fmac_f32 v243, v211, v86
    v_add_f32 v240, s68, v240
    v_add_f32 v241, s68, v241
    v_add_f32 v242, s68, v242
    v_add_f32 v243, s68, v243
    v_cvt_pk_bf16_f32 v104, v240, v241
    v_cvt_pk_bf16_f32 v105, v242, v243
    v_fmac_f32 v212, v78, v60
    v_fmac_f32 v213, v78, v61
    v_fmac_f32 v214, v78, v62
    v_fmac_f32 v215, v78, v63
    v_mul_f32 v244, v212, v79
    v_mul_f32 v245, v213, v79
    v_mul_f32 v246, v214, v79
    v_mul_f32 v247, v215, v79
    v_exp_f32 v244, v244 clamp
    v_max_f32 v212, 0, v212
    v_exp_f32 v245, v245 clamp
    v_max_f32 v213, 0, v213
    v_exp_f32 v246, v246 clamp
    v_max_f32 v214, 0, v214
    v_exp_f32 v247, v247 clamp
    v_max_f32 v215, 0, v215
    v_fmac_f32 v244, v212, v86
    v_fmac_f32 v245, v213, v86
    v_fmac_f32 v246, v214, v86
    v_fmac_f32 v247, v215, v86
    v_add_f32 v244, s68, v244
    v_add_f32 v245, s68, v245
    v_add_f32 v246, s68, v246
    v_add_f32 v247, s68, v247
    v_cvt_pk_bf16_f32 v106, v244, v245
    v_cvt_pk_bf16_f32 v107, v246, v247
    buffer_store_dwordx4 v[104:107], v3, s[12:15], s67 offen offset:3072 sc1
    s_waitcnt lgkmcnt(0)
    buffer_store_dwordx4 v[224:227], v3, s[12:15], s65 offen sc1
    buffer_store_dwordx4 v[228:231], v3, s[12:15], s65 offen offset:1024 sc1
    s_branch L_pub
L_KV:
    s_and_b32 s61, s47, 1
    s_lshl_b32 s61, s61, 6
    s_mul_i32 s62, s46, 80
    s_add_u32 s61, s61, s62
    v_lshl_add_u32 v2, v8, 3, s61
    v_cmp_le_u32 vcc, 384, v2
    v_subrev_u32 v3, 384, v2
    s_nop 0
    v_cndmask_b32 v3, v2, v3, vcc
    v_cndmask_b32 v4, 0, v7, vcc
    v_lshrrev_b32 v16, 5, v3
    v_xor_b32 v16, v16, v6
    v_lshlrev_b32 v16, 5, v16
    v_and_b32 v3, 31, v3
    v_add3_u32 v16, v16, v3, v5
    v_add_u32 v16, v16, v4
    v_add_u32 v2, 32, v2
    v_cmp_le_u32 vcc, 384, v2
    v_subrev_u32 v3, 384, v2
    s_nop 0
    v_cndmask_b32 v3, v2, v3, vcc
    v_cndmask_b32 v4, 0, v7, vcc
    v_lshrrev_b32 v17, 5, v3
    v_xor_b32 v17, v17, v6
    v_lshlrev_b32 v17, 5, v17
    v_and_b32 v3, 31, v3
    v_add3_u32 v17, v17, v3, v5
    v_add_u32 v17, v17, v4
    v_add_u32 v2, 32, v2
    v_cmp_le_u32 vcc, 2, v8
    v_add_u32 v3, 368, v2
    s_nop 0
    v_cndmask_b32 v2, v2, v3, vcc
    v_cmp_le_u32 vcc, 384, v2
    v_subrev_u32 v3, 384, v2
    s_nop 0
    v_cndmask_b32 v3, v2, v3, vcc
    v_cndmask_b32 v4, 0, v7, vcc
    v_lshrrev_b32 v18, 5, v3
    v_xor_b32 v18, v18, v6
    v_lshlrev_b32 v18, 5, v18
    v_and_b32 v3, 31, v3
    v_add3_u32 v18, v18, v3, v5
    v_add_u32 v18, v18, v4
    v_and_b32 v2, 15, v1
    s_lshl_b32 s62, s61, 1
    s_add_u32 s62, s62, 159744
    v_lshl_add_u32 v31, v2, 2, s62
    v_cmp_le_u32 s[74:75], 8, v2
    v_add_u32 v32, 128, v31
    v_add_u32 v3, 864, v31
    v_cndmask_b32 v32, v32, v3, s[74:75]
    s_mul_i32 s61, s46, 3360
    s_mul_i32 s62, s45, 13568
    s_add_u32 s61, s61, s62
    s_add_u32 s61, s61, 122880
    v_add_u32 v3, 0, v2
    v_cmp_le_u32 vcc, 20, v3
    s_nop 1
    v_cndmask_b32 v224, 0, 1, vcc
    v_add_u32 v3, v3, v224
    v_mul_u32_u24 v3, 80, v3
    v_add_u32 v228, s61, v3
    v_add_u32 v3, 16, v2
    v_cmp_le_u32 vcc, 20, v3
    s_nop 1
    v_cndmask_b32 v225, 0, 1, vcc
    v_add_u32 v3, v3, v225
    v_mul_u32_u24 v3, 80, v3
    v_add_u32 v229, s61, v3
    v_add_u32 v3, 24, v2
    v_cmp_le_u32 vcc, 20, v3
    s_nop 1
    v_cndmask_b32 v226, 0, 1, vcc
    v_add_u32 v3, v3, v226
    v_mul_u32_u24 v3, 80, v3
    v_add_u32 v230, s61, v3
    v_cndmask_b32 v226, 9, v226, s[74:75]
    v_lshl_add_u32 v3, v9, 2, 0
    v_cmp_le_u32 vcc, 20, v3
    s_nop 1
    v_cndmask_b32 v232, 0, 1, vcc
    v_subrev_u32 v4, 20, v3
    v_cndmask_b32 v3, v3, v4, vcc
    v_lshlrev_b32 v236, 2, v3
    v_lshl_add_u32 v3, v9, 2, 16
    v_cmp_le_u32 vcc, 20, v3
    s_nop 1
    v_cndmask_b32 v233, 0, 1, vcc
    v_subrev_u32 v4, 20, v3
    v_cndmask_b32 v3, v3, v4, vcc
    v_lshlrev_b32 v237, 2, v3
    v_lshl_add_u32 v3, v9, 2, 32
    v_cmp_le_u32 vcc, 20, v3
    s_nop 1
    v_cndmask_b32 v234, 0, 1, vcc
    v_subrev_u32 v4, 20, v3
    v_cndmask_b32 v3, v3, v4, vcc
    v_lshlrev_b32 v238, 2, v3
    v_cmp_gt_u32 vcc, 2, v9
    s_nop 1
    v_cndmask_b32 v234, 7, v234, vcc
    v_mov_b32 v4, 153088
    v_cmp_eq_u32 vcc, v224, v232
    v_add_u32 v3, v228, v236
    s_nop 0
    v_cndmask_b32 v148, v4, v3, vcc
    v_cmp_eq_u32 vcc, v225, v232
    v_add_u32 v3, v229, v236
    s_nop 0
    v_cndmask_b32 v149, v4, v3, vcc
    v_cmp_eq_u32 vcc, v224, v233
    v_add_u32 v3, v228, v237
    s_nop 0
    v_cndmask_b32 v150, v4, v3, vcc
    v_cmp_eq_u32 vcc, v225, v233
    v_add_u32 v3, v229, v237
    s_nop 0
    v_cndmask_b32 v151, v4, v3, vcc
    v_cmp_eq_u32 vcc, v226, v233
    v_add_u32 v3, v230, v237
    s_nop 0
    v_cndmask_b32 v172, v4, v3, vcc
    v_cmp_eq_u32 vcc, v225, v234
    v_add_u32 v3, v229, v238
    s_nop 0
    v_cndmask_b32 v173, v4, v3, vcc
    v_cmp_eq_u32 vcc, v226, v234
    v_add_u32 v3, v230, v238
    s_nop 0
    v_cndmask_b32 v174, v4, v3, vcc
    v_cmp_eq_u32 s[80:81], 0, v2
    v_mul_u32_u24 v3, 1680, v232
    v_add3_u32 v3, v3, v236, s61
    v_add_u32 v3, 1600, v3
    v_cmp_gt_u32 vcc, 2, v232
    s_nop 0
    s_and_b64 vcc, vcc, s[80:81]
    v_cndmask_b32 v175, v4, v3, vcc
    v_mul_u32_u24 v3, 1680, v233
    v_add3_u32 v3, v3, v237, s61
    v_add_u32 v3, 1600, v3
    v_cmp_gt_u32 vcc, 2, v233
    s_nop 0
    s_and_b64 vcc, vcc, s[80:81]
    v_cndmask_b32 v196, v4, v3, vcc
    v_mul_u32_u24 v3, 1680, v234
    v_add3_u32 v3, v3, v238, s61
    v_add_u32 v3, 1600, v3
    v_cmp_gt_u32 vcc, 2, v234
    s_nop 0
    s_and_b64 vcc, vcc, s[80:81]
    v_cndmask_b32 v197, v4, v3, vcc
    v_add_u32 v22, 49152, v16
    v_add_u32 v23, 49152, v17
    v_add_u32 v24, 49152, v18
    v_add_u32 v25, 49152, v19
    v_add_u32 v26, 49152, v20
    s_waitcnt vmcnt(8)
    s_barrier
    ds_read_b128 v[48:51], v14 offset:0
    ds_read_b128 v[52:55], v14 offset:2048
    ds_read_b128 v[56:59], v14 offset:4096
    ds_read_b128 v[60:63], v14 offset:6144
    ds_read_b64_tr_b16 v[64:65], v16 offset:0
    ds_read_b64_tr_b16 v[66:67], v16 offset:1536
    ds_read_b64_tr_b16 v[68:69], v17 offset:0
    ds_read_b64_tr_b16 v[70:71], v17 offset:1536
    ds_read_b64_tr_b16 v[72:73], v18 offset:0
    ds_read_b64_tr_b16 v[74:75], v18 offset:1536
    ds_read_b64_tr_b16 v[76:77], v16 offset:12288
    ds_read_b64_tr_b16 v[78:79], v16 offset:13824
    ds_read_b64_tr_b16 v[80:81], v17 offset:12288
    ds_read_b64_tr_b16 v[82:83], v17 offset:13824
    s_add_u32 m0, s58, 73728
    s_nop 0
    buffer_load_dwordx4 v11, s[8:11], s50 offen lds
    s_add_u32 m0, s58, 74752
    s_nop 0
    buffer_load_dwordx4 v12, s[8:11], s50 offen lds
    s_add_u32 m0, s58, 75776
    s_nop 0
    buffer_load_dwordx4 v13, s[8:11], s50 offen lds
    s_add_u32 s50, s50, s55
    s_lshl_b32 s71, s43, 7
    s_mov_b32 s70, s71
    s_mov_b32 exec_hi, 0xffff
    buffer_load_dwordx4 v[228:231], v27, s[8:11], s70 offen
    s_mov_b64 exec, -1
    s_waitcnt vmcnt(9) lgkmcnt(0)
    s_barrier
    v_mfma_f32_16x16x32_bf16 v[128:131], v[48:51], v[64:67], 0
    ds_read_b128 v[88:91], v15 offset:0
    s_add_u32 m0, s57, 32768
    s_movk_i32 s53, 256
    v_mfma_f32_16x16x32_bf16 v[152:155], v[52:55], v[64:67], 0
    ds_read_b128 v[92:95], v15 offset:2048
    buffer_load_dwordx4 v10, s[4:7], s53 offen lds
    v_mfma_f32_16x16x32_bf16 v[176:179], v[56:59], v[64:67], 0
    ds_read_b128 v[96:99], v15 offset:4096
    s_add_u32 m0, s57, 33792
    s_movk_i32 s56, 10496
    v_mfma_f32_16x16x32_bf16 v[200:203], v[60:63], v[64:67], 0
    ds_read_b128 v[100:103], v15 offset:6144
    buffer_load_dwordx4 v10, s[4:7], s56 offen lds
    v_mfma_f32_16x16x32_bf16 v[132:135], v[48:51], v[68:71], 0
    ds_read_b64_tr_b16 v[104:105], v16 offset:24576
    s_add_u32 m0, s58, 0
    v_mfma_f32_16x16x32_bf16 v[156:159], v[52:55], v[68:71], 0
    ds_read_b64_tr_b16 v[106:107], v16 offset:26112
    buffer_load_dwordx4 v11, s[8:11], s50 offen lds
    v_mfma_f32_16x16x32_bf16 v[180:183], v[56:59], v[68:71], 0
    ds_read_b64_tr_b16 v[108:109], v17 offset:24576
    s_add_u32 m0, s58, 1024
    v_mfma_f32_16x16x32_bf16 v[204:207], v[60:63], v[68:71], 0
    ds_read_b64_tr_b16 v[110:111], v17 offset:26112
    buffer_load_dwordx4 v12, s[8:11], s50 offen lds
    v_mfma_f32_16x16x32_bf16 v[136:139], v[48:51], v[72:75], 0
    ds_read_b64_tr_b16 v[112:113], v18 offset:24576
    s_add_u32 m0, s58, 2048
    v_mfma_f32_16x16x32_bf16 v[160:163], v[52:55], v[72:75], 0
    ds_read_b64_tr_b16 v[114:115], v18 offset:26112
    buffer_load_dwordx4 v13, s[8:11], s50 offen lds
    s_add_u32 s50, s50, s55
    v_mfma_f32_16x16x32_bf16 v[184:187], v[56:59], v[72:75], 0
    ds_read_b64_tr_b16 v[116:117], v16 offset:36864
    v_mfma_f32_16x16x32_bf16 v[208:211], v[60:63], v[72:75], 0
    ds_read_b64_tr_b16 v[118:119], v16 offset:38400
    v_mfma_f32_16x16x32_bf16 v[140:143], v[48:51], v[76:79], 0
    ds_read_b64_tr_b16 v[120:121], v17 offset:36864
    v_mfma_f32_16x16x32_bf16 v[164:167], v[52:55], v[76:79], 0
    ds_read_b64_tr_b16 v[122:123], v17 offset:38400
    v_mfma_f32_16x16x32_bf16 v[188:191], v[56:59], v[76:79], 0
    v_mfma_f32_16x16x32_bf16 v[212:215], v[60:63], v[76:79], 0
    v_mfma_f32_16x16x32_bf16 v[144:147], v[48:51], v[80:83], 0
    v_mfma_f32_16x16x32_bf16 v[168:171], v[52:55], v[80:83], 0
    v_mfma_f32_16x16x32_bf16 v[192:195], v[56:59], v[80:83], 0
    v_mfma_f32_16x16x32_bf16 v[216:219], v[60:63], v[80:83], 0
    s_add_u32 s70, s70, s71
    s_mov_b32 exec_hi, 0xffff
    buffer_load_dwordx4 v[232:235], v27, s[8:11], s70 offen
    s_mov_b64 exec, -1
    s_waitcnt vmcnt(10) lgkmcnt(0)
    s_barrier
    v_mfma_f32_16x16x32_bf16 v[128:131], v[88:91], v[104:107], v[128:131]
    ds_read_b128 v[48:51], v14 offset:16384
    v_mfma_f32_16x16x32_bf16 v[152:155], v[92:95], v[104:107], v[152:155]
    ds_read_b128 v[52:55], v14 offset:18432
    v_mfma_f32_16x16x32_bf16 v[176:179], v[96:99], v[104:107], v[176:179]
    ds_read_b128 v[56:59], v14 offset:20480
    v_mfma_f32_16x16x32_bf16 v[200:203], v[100:103], v[104:107], v[200:203]
    ds_read_b128 v[60:63], v14 offset:22528
    v_mfma_f32_16x16x32_bf16 v[132:135], v[88:91], v[108:111], v[132:135]
    ds_read_b64_tr_b16 v[64:65], v22 offset:0
    v_mfma_f32_16x16x32_bf16 v[156:159], v[92:95], v[108:111], v[156:159]
    ds_read_b64_tr_b16 v[66:67], v22 offset:1536
    v_mfma_f32_16x16x32_bf16 v[180:183], v[96:99], v[108:111], v[180:183]
    ds_read_b64_tr_b16 v[68:69], v23 offset:0
    v_mfma_f32_16x16x32_bf16 v[204:207], v[100:103], v[108:111], v[204:207]
    ds_read_b64_tr_b16 v[70:71], v23 offset:1536
    v_mfma_f32_16x16x32_bf16 v[136:139], v[88:91], v[112:115], v[136:139]
    ds_read_b64_tr_b16 v[72:73], v24 offset:0
    v_mfma_f32_16x16x32_bf16 v[160:163], v[92:95], v[112:115], v[160:163]
    ds_read_b64_tr_b16 v[74:75], v24 offset:1536
    s_add_u32 m0, s58, 24576
    v_mfma_f32_16x16x32_bf16 v[184:187], v[96:99], v[112:115], v[184:187]
    ds_read_b64_tr_b16 v[76:77], v22 offset:12288
    buffer_load_dwordx4 v11, s[8:11], s50 offen lds
    v_mfma_f32_16x16x32_bf16 v[208:211], v[100:103], v[112:115], v[208:211]
    ds_read_b64_tr_b16 v[78:79], v22 offset:13824
    s_add_u32 m0, s58, 25600
    v_mfma_f32_16x16x32_bf16 v[140:143], v[88:91], v[116:119], v[140:143]
    ds_read_b64_tr_b16 v[80:81], v23 offset:12288
    buffer_load_dwordx4 v12, s[8:11], s50 offen lds
    v_mfma_f32_16x16x32_bf16 v[164:167], v[92:95], v[116:119], v[164:167]
    ds_read_b64_tr_b16 v[82:83], v23 offset:13824
    s_add_u32 m0, s58, 26624
    v_mfma_f32_16x16x32_bf16 v[188:191], v[96:99], v[116:119], v[188:191]
    buffer_load_dwordx4 v13, s[8:11], s50 offen lds
    s_add_u32 s50, s50, s55
    v_mfma_f32_16x16x32_bf16 v[212:215], v[100:103], v[116:119], v[212:215]
    s_add_u32 m0, s57, 0
    s_movk_i32 s53, 384
    v_mfma_f32_16x16x32_bf16 v[144:147], v[88:91], v[120:123], v[144:147]
    buffer_load_dwordx4 v10, s[4:7], s53 offen lds
    v_mfma_f32_16x16x32_bf16 v[168:171], v[92:95], v[120:123], v[168:171]
    s_add_u32 m0, s57, 1024
    s_movk_i32 s56, 10624
    v_mfma_f32_16x16x32_bf16 v[192:195], v[96:99], v[120:123], v[192:195]
    buffer_load_dwordx4 v10, s[4:7], s56 offen lds
    v_mfma_f32_16x16x32_bf16 v[216:219], v[100:103], v[120:123], v[216:219]
    s_add_u32 s70, s70, s71
    s_mov_b32 exec_hi, 0xffff
    buffer_load_dwordx4 v[236:239], v27, s[8:11], s70 offen
    s_mov_b64 exec, -1
    s_waitcnt vmcnt(13) lgkmcnt(0)
    s_barrier
    v_mfma_f32_16x16x32_bf16 v[128:131], v[48:51], v[64:67], v[128:131]
    ds_read_b128 v[88:91], v15 offset:16384
    v_mfma_f32_16x16x32_bf16 v[152:155], v[52:55], v[64:67], v[152:155]
    ds_read_b128 v[92:95], v15 offset:18432
    v_mfma_f32_16x16x32_bf16 v[176:179], v[56:59], v[64:67], v[176:179]
    ds_read_b128 v[96:99], v15 offset:20480
    v_mfma_f32_16x16x32_bf16 v[200:203], v[60:63], v[64:67], v[200:203]
    ds_read_b128 v[100:103], v15 offset:22528
    v_mfma_f32_16x16x32_bf16 v[132:135], v[48:51], v[68:71], v[132:135]
    ds_read_b64_tr_b16 v[104:105], v22 offset:24576
    v_mfma_f32_16x16x32_bf16 v[156:159], v[52:55], v[68:71], v[156:159]
    ds_read_b64_tr_b16 v[106:107], v22 offset:26112
    v_mfma_f32_16x16x32_bf16 v[180:183], v[56:59], v[68:71], v[180:183]
    ds_read_b64_tr_b16 v[108:109], v23 offset:24576
    v_mfma_f32_16x16x32_bf16 v[204:207], v[60:63], v[68:71], v[204:207]
    ds_read_b64_tr_b16 v[110:111], v23 offset:26112
    v_mfma_f32_16x16x32_bf16 v[136:139], v[48:51], v[72:75], v[136:139]
    ds_read_b64_tr_b16 v[112:113], v24 offset:24576
    v_mfma_f32_16x16x32_bf16 v[160:163], v[52:55], v[72:75], v[160:163]
    ds_read_b64_tr_b16 v[114:115], v24 offset:26112
    v_mfma_f32_16x16x32_bf16 v[184:187], v[56:59], v[72:75], v[184:187]
    ds_read_b64_tr_b16 v[116:117], v22 offset:36864
    v_mfma_f32_16x16x32_bf16 v[208:211], v[60:63], v[72:75], v[208:211]
    ds_read_b64_tr_b16 v[118:119], v22 offset:38400
    v_mfma_f32_16x16x32_bf16 v[140:143], v[48:51], v[76:79], v[140:143]
    ds_read_b64_tr_b16 v[120:121], v23 offset:36864
    v_mfma_f32_16x16x32_bf16 v[164:167], v[52:55], v[76:79], v[164:167]
    ds_read_b64_tr_b16 v[122:123], v23 offset:38400
    s_add_u32 m0, s58, 49152
    v_mfma_f32_16x16x32_bf16 v[188:191], v[56:59], v[76:79], v[188:191]
    buffer_load_dwordx4 v11, s[8:11], s50 offen lds
    v_mfma_f32_16x16x32_bf16 v[212:215], v[60:63], v[76:79], v[212:215]
    s_add_u32 m0, s58, 50176
    v_mfma_f32_16x16x32_bf16 v[144:147], v[48:51], v[80:83], v[144:147]
    buffer_load_dwordx4 v12, s[8:11], s50 offen lds
    v_mfma_f32_16x16x32_bf16 v[168:171], v[52:55], v[80:83], v[168:171]
    s_add_u32 m0, s58, 51200
    v_mfma_f32_16x16x32_bf16 v[192:195], v[56:59], v[80:83], v[192:195]
    buffer_load_dwordx4 v13, s[8:11], s50 offen lds
    s_add_u32 s50, s50, s55
    v_mfma_f32_16x16x32_bf16 v[216:219], v[60:63], v[80:83], v[216:219]
    s_cmp_eq_u32 s64, 2
    s_cbranch_scc0 L_KV_ep2
    s_not_b64 s[78:79], s[76:77]
    s_sub_u32 s78, s78, 200
    s_subb_u32 s79, s79, 0
    s_mov_b64 exec, 1
    v_mov_b32 v42, s78
    v_mov_b32 v43, s79
    v_mov_b32 v44, 0
    global_atomic_umax_x2 v44, v[42:43], s[36:37] sc1
    s_mov_b64 exec, -1
L_KV_ep2:
    s_add_u32 s70, s70, s71
    s_mov_b32 exec_hi, 0xffff
    buffer_load_dwordx4 v[240:243], v27, s[8:11], s70 offen
    s_mov_b64 exec, -1
    s_waitcnt vmcnt(11) lgkmcnt(0)
    s_barrier
    v_mfma_f32_16x16x32_bf16 v[128:131], v[88:91], v[104:107], v[128:131]
    ds_read_b128 v[48:51], v14 offset:32768
    v_mfma_f32_16x16x32_bf16 v[152:155], v[92:95], v[104:107], v[152:155]
    ds_read_b128 v[52:55], v14 offset:34816
    v_mfma_f32_16x16x32_bf16 v[176:179], v[96:99], v[104:107], v[176:179]
    ds_read_b128 v[56:59], v14 offset:36864
    v_mfma_f32_16x16x32_bf16 v[200:203], v[100:103], v[104:107], v[200:203]
    ds_read_b128 v[60:63], v14 offset:38912
    v_mfma_f32_16x16x32_bf16 v[132:135], v[88:91], v[108:111], v[132:135]
    ds_read_b64_tr_b16 v[64:65], v16 offset:0
    v_mfma_f32_16x16x32_bf16 v[156:159], v[92:95], v[108:111], v[156:159]
    ds_read_b64_tr_b16 v[66:67], v16 offset:1536
    v_mfma_f32_16x16x32_bf16 v[180:183], v[96:99], v[108:111], v[180:183]
    ds_read_b64_tr_b16 v[68:69], v17 offset:0
    v_mfma_f32_16x16x32_bf16 v[204:207], v[100:103], v[108:111], v[204:207]
    ds_read_b64_tr_b16 v[70:71], v17 offset:1536
    v_mfma_f32_16x16x32_bf16 v[136:139], v[88:91], v[112:115], v[136:139]
    ds_read_b64_tr_b16 v[72:73], v18 offset:0
    v_mfma_f32_16x16x32_bf16 v[160:163], v[92:95], v[112:115], v[160:163]
    ds_read_b64_tr_b16 v[74:75], v18 offset:1536
    s_add_u32 m0, s58, 73728
    v_mfma_f32_16x16x32_bf16 v[184:187], v[96:99], v[112:115], v[184:187]
    ds_read_b64_tr_b16 v[76:77], v16 offset:12288
    buffer_load_dwordx4 v11, s[8:11], s50 offen lds
    v_mfma_f32_16x16x32_bf16 v[208:211], v[100:103], v[112:115], v[208:211]
    ds_read_b64_tr_b16 v[78:79], v16 offset:13824
    s_add_u32 m0, s58, 74752
    v_mfma_f32_16x16x32_bf16 v[140:143], v[88:91], v[116:119], v[140:143]
    ds_read_b64_tr_b16 v[80:81], v17 offset:12288
    buffer_load_dwordx4 v12, s[8:11], s50 offen lds
    v_mfma_f32_16x16x32_bf16 v[164:167], v[92:95], v[116:119], v[164:167]
    ds_read_b64_tr_b16 v[82:83], v17 offset:13824
    s_add_u32 m0, s58, 75776
    v_mfma_f32_16x16x32_bf16 v[188:191], v[96:99], v[116:119], v[188:191]
    buffer_load_dwordx4 v13, s[8:11], s50 offen lds
    s_add_u32 s50, s50, s55
    v_mfma_f32_16x16x32_bf16 v[212:215], v[100:103], v[116:119], v[212:215]
    s_add_u32 m0, s57, 16384
    s_movk_i32 s53, 512
    v_mfma_f32_16x16x32_bf16 v[144:147], v[88:91], v[120:123], v[144:147]
    buffer_load_dwordx4 v10, s[4:7], s53 offen lds
    v_mfma_f32_16x16x32_bf16 v[168:171], v[92:95], v[120:123], v[168:171]
    s_add_u32 m0, s57, 17408
    s_movk_i32 s56, 10752
    v_mfma_f32_16x16x32_bf16 v[192:195], v[96:99], v[120:123], v[192:195]
    buffer_load_dwordx4 v10, s[4:7], s56 offen lds
    v_mfma_f32_16x16x32_bf16 v[216:219], v[100:103], v[120:123], v[216:219]
    s_cmp_eq_u32 s64, 3
    s_cbranch_scc0 L_KV_ep3
    s_not_b64 s[78:79], s[76:77]
    s_sub_u32 s78, s78, 200
    s_subb_u32 s79, s79, 0
    s_mov_b64 exec, 1
    v_mov_b32 v42, s78
    v_mov_b32 v43, s79
    v_mov_b32 v44, 0
    global_atomic_umax_x2 v44, v[42:43], s[36:37] sc1
    s_mov_b64 exec, -1
L_KV_ep3:
    s_mov_b32 s70, 0
    s_mov_b32 exec_hi, 0xffff
    buffer_load_dwordx4 v[224:227], v27, s[8:11], s70 offen
    s_mov_b64 exec, -1
    s_waitcnt vmcnt(13) lgkmcnt(0)
    s_barrier
    v_mfma_f32_16x16x32_bf16 v[128:131], v[48:51], v[64:67], v[128:131]
    ds_read_b128 v[88:91], v15 offset:32768
    v_mfma_f32_16x16x32_bf16 v[152:155], v[52:55], v[64:67], v[152:155]
    ds_read_b128 v[92:95], v15 offset:34816
    v_mfma_f32_16x16x32_bf16 v[176:179], v[56:59], v[64:67], v[176:179]
    ds_read_b128 v[96:99], v15 offset:36864
    v_mfma_f32_16x16x32_bf16 v[200:203], v[60:63], v[64:67], v[200:203]
    ds_read_b128 v[100:103], v15 offset:38912
    v_mfma_f32_16x16x32_bf16 v[132:135], v[48:51], v[68:71], v[132:135]
    ds_read_b64_tr_b16 v[104:105], v16 offset:24576
    v_mfma_f32_16x16x32_bf16 v[156:159], v[52:55], v[68:71], v[156:159]
    ds_read_b64_tr_b16 v[106:107], v16 offset:26112
    v_mfma_f32_16x16x32_bf16 v[180:183], v[56:59], v[68:71], v[180:183]
    ds_read_b64_tr_b16 v[108:109], v17 offset:24576
    v_mfma_f32_16x16x32_bf16 v[204:207], v[60:63], v[68:71], v[204:207]
    ds_read_b64_tr_b16 v[110:111], v17 offset:26112
    v_mfma_f32_16x16x32_bf16 v[136:139], v[48:51], v[72:75], v[136:139]
    ds_read_b64_tr_b16 v[112:113], v18 offset:24576
    v_mfma_f32_16x16x32_bf16 v[160:163], v[52:55], v[72:75], v[160:163]
    ds_read_b64_tr_b16 v[114:115], v18 offset:26112
    v_mfma_f32_16x16x32_bf16 v[184:187], v[56:59], v[72:75], v[184:187]
    ds_read_b64_tr_b16 v[116:117], v16 offset:36864
    v_mfma_f32_16x16x32_bf16 v[208:211], v[60:63], v[72:75], v[208:211]
    ds_read_b64_tr_b16 v[118:119], v16 offset:38400
    v_mfma_f32_16x16x32_bf16 v[140:143], v[48:51], v[76:79], v[140:143]
    ds_read_b64_tr_b16 v[120:121], v17 offset:36864
    v_mfma_f32_16x16x32_bf16 v[164:167], v[52:55], v[76:79], v[164:167]
    ds_read_b64_tr_b16 v[122:123], v17 offset:38400
    s_add_u32 m0, s58, 0
    v_mfma_f32_16x16x32_bf16 v[188:191], v[56:59], v[76:79], v[188:191]
    buffer_load_dwordx4 v11, s[8:11], s50 offen lds
    v_mfma_f32_16x16x32_bf16 v[212:215], v[60:63], v[76:79], v[212:215]
    s_add_u32 m0, s58, 1024
    v_mfma_f32_16x16x32_bf16 v[144:147], v[48:51], v[80:83], v[144:147]
    buffer_load_dwordx4 v12, s[8:11], s50 offen lds
    v_mfma_f32_16x16x32_bf16 v[168:171], v[52:55], v[80:83], v[168:171]
    s_add_u32 m0, s58, 2048
    v_mfma_f32_16x16x32_bf16 v[192:195], v[56:59], v[80:83], v[192:195]
    buffer_load_dwordx4 v13, s[8:11], s50 offen lds
    s_add_u32 s50, s50, s55
    v_mfma_f32_16x16x32_bf16 v[216:219], v[60:63], v[80:83], v[216:219]
    s_cmp_eq_u32 s64, 4
    s_cbranch_scc0 L_KV_ep4
    s_not_b64 s[78:79], s[76:77]
    s_sub_u32 s78, s78, 200
    s_subb_u32 s79, s79, 0
    s_mov_b64 exec, 1
    v_mov_b32 v42, s78
    v_mov_b32 v43, s79
    v_mov_b32 v44, 0
    global_atomic_umax_x2 v44, v[42:43], s[36:37] sc1
    s_mov_b64 exec, -1
L_KV_ep4:
    s_waitcnt vmcnt(10) lgkmcnt(0)
    s_barrier
    v_mfma_f32_16x16x32_bf16 v[128:131], v[88:91], v[104:107], v[128:131]
    ds_read_b128 v[48:51], v14 offset:0
    v_lshlrev_b32 v244, 16, v228
    v_and_b32 v245, s73, v228
    v_lshlrev_b32 v246, 16, v229
    v_mfma_f32_16x16x32_bf16 v[152:155], v[92:95], v[104:107], v[152:155]
    ds_read_b128 v[52:55], v14 offset:2048
    v_and_b32 v247, s73, v229
    v_lshlrev_b32 v248, 16, v230
    v_and_b32 v249, s73, v230
    v_mfma_f32_16x16x32_bf16 v[176:179], v[96:99], v[104:107], v[176:179]
    ds_read_b128 v[56:59], v14 offset:4096
    v_lshlrev_b32 v250, 16, v231
    v_and_b32 v251, s73, v231
    v_lshlrev_b32 v2, 16, v232
    v_mfma_f32_16x16x32_bf16 v[200:203], v[100:103], v[104:107], v[200:203]
    ds_read_b128 v[60:63], v14 offset:6144
    v_and_b32 v3, s73, v232
    v_add_f32 v244, v244, v2
    v_add_f32 v245, v245, v3
    v_mfma_f32_16x16x32_bf16 v[132:135], v[88:91], v[108:111], v[132:135]
    ds_read_b64_tr_b16 v[64:65], v22 offset:0
    v_lshlrev_b32 v4, 16, v233
    v_and_b32 v5, s73, v233
    v_add_f32 v246, v246, v4
    v_mfma_f32_16x16x32_bf16 v[156:159], v[92:95], v[108:111], v[156:159]
    ds_read_b64_tr_b16 v[66:67], v22 offset:1536
    v_add_f32 v247, v247, v5
    v_lshlrev_b32 v2, 16, v234
    v_and_b32 v3, s73, v234
    v_mfma_f32_16x16x32_bf16 v[180:183], v[96:99], v[108:111], v[180:183]
    ds_read_b64_tr_b16 v[68:69], v23 offset:0
    v_add_f32 v248, v248, v2
    v_add_f32 v249, v249, v3
    v_lshlrev_b32 v4, 16, v235
    v_mfma_f32_16x16x32_bf16 v[204:207], v[100:103], v[108:111], v[204:207]
    ds_read_b64_tr_b16 v[70:71], v23 offset:1536
    v_and_b32 v5, s73, v235
    v_add_f32 v250, v250, v4
    v_add_f32 v251, v251, v5
    v_mfma_f32_16x16x32_bf16 v[136:139], v[88:91], v[112:115], v[136:139]
    ds_read_b64_tr_b16 v[72:73], v24 offset:0
    v_lshlrev_b32 v2, 16, v236
    v_and_b32 v3, s73, v236
    v_mfma_f32_16x16x32_bf16 v[160:163], v[92:95], v[112:115], v[160:163]
    ds_read_b64_tr_b16 v[74:75], v24 offset:1536
    s_add_u32 m0, s58, 24576
    v_add_f32 v244, v244, v2
    v_add_f32 v245, v245, v3
    v_mfma_f32_16x16x32_bf16 v[184:187], v[96:99], v[112:115], v[184:187]
    ds_read_b64_tr_b16 v[76:77], v22 offset:12288
    buffer_load_dwordx4 v11, s[8:11], s50 offen lds
    v_lshlrev_b32 v4, 16, v237
    v_and_b32 v5, s73, v237
    v_mfma_f32_16x16x32_bf16 v[208:211], v[100:103], v[112:115], v[208:211]
    ds_read_b64_tr_b16 v[78:79], v22 offset:13824
    s_add_u32 m0, s58, 25600
    v_add_f32 v246, v246, v4
    v_add_f32 v247, v247, v5
    v_mfma_f32_16x16x32_bf16 v[140:143], v[88:91], v[116:119], v[140:143]
    ds_read_b64_tr_b16 v[80:81], v23 offset:12288
    buffer_load_dwordx4 v12, s[8:11], s50 offen lds
    v_lshlrev_b32 v2, 16, v238
    v_and_b32 v3, s73, v238
    v_mfma_f32_16x16x32_bf16 v[164:167], v[92:95], v[116:119], v[164:167]
    ds_read_b64_tr_b16 v[82:83], v23 offset:13824
    s_add_u32 m0, s58, 26624
    v_add_f32 v248, v248, v2
    v_add_f32 v249, v249, v3
    v_mfma_f32_16x16x32_bf16 v[188:191], v[96:99], v[116:119], v[188:191]
    buffer_load_dwordx4 v13, s[8:11], s50 offen lds
    s_add_u32 s50, s50, s55
    v_lshlrev_b32 v4, 16, v239
    v_and_b32 v5, s73, v239
    v_mfma_f32_16x16x32_bf16 v[212:215], v[100:103], v[116:119], v[212:215]
    s_add_u32 m0, s57, 32768
    s_movk_i32 s53, 640
    v_add_f32 v250, v250, v4
    v_add_f32 v251, v251, v5
    v_mfma_f32_16x16x32_bf16 v[144:147], v[88:91], v[120:123], v[144:147]
    buffer_load_dwordx4 v10, s[4:7], s53 offen lds
    v_mfma_f32_16x16x32_bf16 v[168:171], v[92:95], v[120:123], v[168:171]
    s_add_u32 m0, s57, 33792
    s_movk_i32 s56, 10880
    v_mfma_f32_16x16x32_bf16 v[192:195], v[96:99], v[120:123], v[192:195]
    buffer_load_dwordx4 v10, s[4:7], s56 offen lds
    v_mfma_f32_16x16x32_bf16 v[216:219], v[100:103], v[120:123], v[216:219]
    s_cmp_eq_u32 s64, 5
    s_cbranch_scc0 L_KV_ep5
    s_not_b64 s[78:79], s[76:77]
    s_sub_u32 s78, s78, 200
    s_subb_u32 s79, s79, 0
    s_mov_b64 exec, 1
    v_mov_b32 v42, s78
    v_mov_b32 v43, s79
    v_mov_b32 v44, 0
    global_atomic_umax_x2 v44, v[42:43], s[36:37] sc1
    s_mov_b64 exec, -1
L_KV_ep5:
    s_waitcnt vmcnt(8) lgkmcnt(0)
    s_barrier
    v_mfma_f32_16x16x32_bf16 v[128:131], v[48:51], v[64:67], v[128:131]
    ds_read_b128 v[88:91], v15 offset:0
    v_lshlrev_b32 v2, 16, v240
    v_and_b32 v3, s73, v240
    v_mfma_f32_16x16x32_bf16 v[152:155], v[52:55], v[64:67], v[152:155]
    ds_read_b128 v[92:95], v15 offset:2048
    v_add_f32 v244, v244, v2
    v_add_f32 v245, v245, v3
    v_mfma_f32_16x16x32_bf16 v[176:179], v[56:59], v[64:67], v[176:179]
    ds_read_b128 v[96:99], v15 offset:4096
    v_lshlrev_b32 v4, 16, v241
    v_and_b32 v5, s73, v241
    v_mfma_f32_16x16x32_bf16 v[200:203], v[60:63], v[64:67], v[200:203]
    ds_read_b128 v[100:103], v15 offset:6144
    v_add_f32 v246, v246, v4
    v_add_f32 v247, v247, v5
    v_mfma_f32_16x16x32_bf16 v[132:135], v[48:51], v[68:71], v[132:135]
    ds_read_b64_tr_b16 v[104:105], v22 offset:24576
    v_lshlrev_b32 v2, 16, v242
    v_and_b32 v3, s73, v242
    v_mfma_f32_16x16x32_bf16 v[156:159], v[52:55], v[68:71], v[156:159]
    ds_read_b64_tr_b16 v[106:107], v22 offset:26112
    v_add_f32 v248, v248, v2
    v_add_f32 v249, v249, v3
    v_mfma_f32_16x16x32_bf16 v[180:183], v[56:59], v[68:71], v[180:183]
    ds_read_b64_tr_b16 v[108:109], v23 offset:24576
    v_lshlrev_b32 v4, 16, v243
    v_and_b32 v5, s73, v243
    v_mfma_f32_16x16x32_bf16 v[204:207], v[60:63], v[68:71], v[204:207]
    ds_read_b64_tr_b16 v[110:111], v23 offset:26112
    v_add_f32 v250, v250, v4
    v_add_f32 v251, v251, v5
    v_mfma_f32_16x16x32_bf16 v[136:139], v[48:51], v[72:75], v[136:139]
    ds_read_b64_tr_b16 v[112:113], v24 offset:24576
    v_lshlrev_b32 v2, 16, v224
    v_and_b32 v3, s73, v224
    v_mfma_f32_16x16x32_bf16 v[160:163], v[52:55], v[72:75], v[160:163]
    ds_read_b64_tr_b16 v[114:115], v24 offset:26112
    v_add_f32 v244, v244, v2
    v_add_f32 v245, v245, v3
    v_mfma_f32_16x16x32_bf16 v[184:187], v[56:59], v[72:75], v[184:187]
    ds_read_b64_tr_b16 v[116:117], v22 offset:36864
    v_lshlrev_b32 v4, 16, v225
    v_and_b32 v5, s73, v225
    v_mfma_f32_16x16x32_bf16 v[208:211], v[60:63], v[72:75], v[208:211]
    ds_read_b64_tr_b16 v[118:119], v22 offset:38400
    v_add_f32 v246, v246, v4
    v_add_f32 v247, v247, v5
    v_mfma_f32_16x16x32_bf16 v[140:143], v[48:51], v[76:79], v[140:143]
    ds_read_b64_tr_b16 v[120:121], v23 offset:36864
    v_lshlrev_b32 v2, 16, v226
    v_and_b32 v3, s73, v226
    v_mfma_f32_16x16x32_bf16 v[164:167], v[52:55], v[76:79], v[164:167]
    ds_read_b64_tr_b16 v[122:123], v23 offset:38400
    s_add_u32 m0, s58, 49152
    v_add_f32 v248, v248, v2
    v_add_f32 v249, v249, v3
    v_mfma_f32_16x16x32_bf16 v[188:191], v[56:59], v[76:79], v[188:191]
    buffer_load_dwordx4 v11, s[8:11], s50 offen lds
    v_lshlrev_b32 v4, 16, v227
    v_and_b32 v5, s73, v227
    v_mfma_f32_16x16x32_bf16 v[212:215], v[60:63], v[76:79], v[212:215]
    s_add_u32 m0, s58, 50176
    v_add_f32 v250, v250, v4
    v_add_f32 v251, v251, v5
    v_mfma_f32_16x16x32_bf16 v[144:147], v[48:51], v[80:83], v[144:147]
    buffer_load_dwordx4 v12, s[8:11], s50 offen lds
    v_mfma_f32_16x16x32_bf16 v[168:171], v[52:55], v[80:83], v[168:171]
    s_add_u32 m0, s58, 51200
    v_mfma_f32_16x16x32_bf16 v[192:195], v[56:59], v[80:83], v[192:195]
    buffer_load_dwordx4 v13, s[8:11], s50 offen lds
    s_add_u32 s50, s50, s55
    v_mfma_f32_16x16x32_bf16 v[216:219], v[60:63], v[80:83], v[216:219]
    s_cmp_eq_u32 s64, 6
    s_cbranch_scc0 L_KV_ep6
    s_not_b64 s[78:79], s[76:77]
    s_sub_u32 s78, s78, 200
    s_subb_u32 s79, s79, 0
    s_mov_b64 exec, 1
    v_mov_b32 v42, s78
    v_mov_b32 v43, s79
    v_mov_b32 v44, 0
    global_atomic_umax_x2 v44, v[42:43], s[36:37] sc1
    s_mov_b64 exec, -1
L_KV_ep6:
    s_mov_b32 exec_hi, 0xffff
    ds_write_b128 v28, v[244:247]
    ds_write_b128 v28, v[248:251] offset:16
    s_mov_b64 exec, -1
    s_waitcnt vmcnt(8) lgkmcnt(0)
    s_barrier
    v_mfma_f32_16x16x32_bf16 v[128:131], v[88:91], v[104:107], v[128:131]
    ds_read_b128 v[48:51], v14 offset:16384
    v_mfma_f32_16x16x32_bf16 v[152:155], v[92:95], v[104:107], v[152:155]
    ds_read_b128 v[52:55], v14 offset:18432
    v_mfma_f32_16x16x32_bf16 v[176:179], v[96:99], v[104:107], v[176:179]
    ds_read_b128 v[56:59], v14 offset:20480
    v_mfma_f32_16x16x32_bf16 v[200:203], v[100:103], v[104:107], v[200:203]
    ds_read_b128 v[60:63], v14 offset:22528
    v_mfma_f32_16x16x32_bf16 v[132:135], v[88:91], v[108:111], v[132:135]
    ds_read_b64_tr_b16 v[64:65], v16 offset:0
    v_mfma_f32_16x16x32_bf16 v[156:159], v[92:95], v[108:111], v[156:159]
    ds_read_b64_tr_b16 v[66:67], v16 offset:1536
    v_mfma_f32_16x16x32_bf16 v[180:183], v[96:99], v[108:111], v[180:183]
    ds_read_b64_tr_b16 v[68:69], v17 offset:0
    v_mfma_f32_16x16x32_bf16 v[204:207], v[100:103], v[108:111], v[204:207]
    ds_read_b64_tr_b16 v[70:71], v17 offset:1536
    v_mfma_f32_16x16x32_bf16 v[136:139], v[88:91], v[112:115], v[136:139]
    ds_read_b64_tr_b16 v[72:73], v18 offset:0
    v_mfma_f32_16x16x32_bf16 v[160:163], v[92:95], v[112:115], v[160:163]
    ds_read_b64_tr_b16 v[74:75], v18 offset:1536
    s_add_u32 m0, s58, 73728
    v_mfma_f32_16x16x32_bf16 v[184:187], v[96:99], v[112:115], v[184:187]
    ds_read_b64_tr_b16 v[76:77], v16 offset:12288
    buffer_load_dwordx4 v11, s[8:11], s50 offen lds
    v_mfma_f32_16x16x32_bf16 v[208:211], v[100:103], v[112:115], v[208:211]
    ds_read_b64_tr_b16 v[78:79], v16 offset:13824
    s_add_u32 m0, s58, 74752
    v_mfma_f32_16x16x32_bf16 v[140:143], v[88:91], v[116:119], v[140:143]
    ds_read_b64_tr_b16 v[80:81], v17 offset:12288
    buffer_load_dwordx4 v12, s[8:11], s50 offen lds
    v_mfma_f32_16x16x32_bf16 v[164:167], v[92:95], v[116:119], v[164:167]
    ds_read_b64_tr_b16 v[82:83], v17 offset:13824
    s_add_u32 m0, s58, 75776
    v_mfma_f32_16x16x32_bf16 v[188:191], v[96:99], v[116:119], v[188:191]
    buffer_load_dwordx4 v13, s[8:11], s50 offen lds
    s_add_u32 s50, s50, s55
    v_mfma_f32_16x16x32_bf16 v[212:215], v[100:103], v[116:119], v[212:215]
    s_add_u32 m0, s57, 0
    s_movk_i32 s53, 768
    v_mfma_f32_16x16x32_bf16 v[144:147], v[88:91], v[120:123], v[144:147]
    buffer_load_dwordx4 v10, s[4:7], s53 offen lds
    v_mfma_f32_16x16x32_bf16 v[168:171], v[92:95], v[120:123], v[168:171]
    s_add_u32 m0, s57, 1024
    s_movk_i32 s56, 11008
    v_mfma_f32_16x16x32_bf16 v[192:195], v[96:99], v[120:123], v[192:195]
    buffer_load_dwordx4 v10, s[4:7], s56 offen lds
    v_mfma_f32_16x16x32_bf16 v[216:219], v[100:103], v[120:123], v[216:219]
    s_cmp_eq_u32 s64, 7
    s_cbranch_scc0 L_KV_ep7
    s_not_b64 s[78:79], s[76:77]
    s_sub_u32 s78, s78, 200
    s_subb_u32 s79, s79, 0
    s_mov_b64 exec, 1
    v_mov_b32 v42, s78
    v_mov_b32 v43, s79
    v_mov_b32 v44, 0
    global_atomic_umax_x2 v44, v[42:43], s[36:37] sc1
    s_mov_b64 exec, -1
L_KV_ep7:
    s_cmp_lt_u32 s40, 2
    s_cbranch_scc0 L_KV_e6
    v_cmp_gt_u32 vcc, 96, v0
    s_nop 0
    s_and_saveexec_b64 s[60:61], vcc
    v_lshlrev_b32 v2, 4, v0
    v_add_u32 v3, 147456, v2
    ds_read_b128 v[224:227], v3 offset:0
    ds_read_b128 v[228:231], v3 offset:1536
    ds_read_b128 v[232:235], v3 offset:3072
    ds_read_b128 v[236:239], v3 offset:4608
    ds_read_b128 v[240:243], v3 offset:6144
    ds_read_b128 v[244:247], v3 offset:7680
    ds_read_b128 v[248:251], v3 offset:9216
    ds_read_b128 v[252:255], v3 offset:10752
    s_lshl_b32 s62, s42, 4
    s_add_u32 s62, s62, s41
    s_mul_i32 s62, s62, 1536
    s_add_u32 s62, s62, 14680064
    s_waitcnt lgkmcnt(6)
    v_add_f32 v224, v224, v228
    v_add_f32 v225, v225, v229
    v_add_f32 v226, v226, v230
    v_add_f32 v227, v227, v231
    s_waitcnt lgkmcnt(5)
    v_add_f32 v224, v224, v232
    v_add_f32 v225, v225, v233
    v_add_f32 v226, v226, v234
    v_add_f32 v227, v227, v235
    s_waitcnt lgkmcnt(4)
    v_add_f32 v224, v224, v236
    v_add_f32 v225, v225, v237
    v_add_f32 v226, v226, v238
    v_add_f32 v227, v227, v239
    s_waitcnt lgkmcnt(3)
    v_add_f32 v224, v224, v240
    v_add_f32 v225, v225, v241
    v_add_f32 v226, v226, v242
    v_add_f32 v227, v227, v243
    s_waitcnt lgkmcnt(2)
    v_add_f32 v224, v224, v244
    v_add_f32 v225, v225, v245
    v_add_f32 v226, v226, v246
    v_add_f32 v227, v227, v247
    s_waitcnt lgkmcnt(1)
    v_add_f32 v224, v224, v248
    v_add_f32 v225, v225, v249
    v_add_f32 v226, v226, v250
    v_add_f32 v227, v227, v251
    s_waitcnt lgkmcnt(0)
    v_add_f32 v224, v224, v252
    v_add_f32 v225, v225, v253
    v_add_f32 v226, v226, v254
    v_add_f32 v227, v227, v255
    buffer_store_dwordx4 v[224:227], v2, s[12:15], s62 offen sc1
    s_mov_b64 exec, s[60:61]
L_KV_e6:
    s_waitcnt vmcnt(10) lgkmcnt(0)
    s_barrier
    v_mfma_f32_16x16x32_bf16 v[128:131], v[48:51], v[64:67], v[128:131]
    ds_read_b128 v[88:91], v15 offset:16384
    v_mfma_f32_16x16x32_bf16 v[152:155], v[52:55], v[64:67], v[152:155]
    ds_read_b128 v[92:95], v15 offset:18432
    v_mfma_f32_16x16x32_bf16 v[176:179], v[56:59], v[64:67], v[176:179]
    ds_read_b128 v[96:99], v15 offset:20480
    v_mfma_f32_16x16x32_bf16 v[200:203], v[60:63], v[64:67], v[200:203]
    ds_read_b128 v[100:103], v15 offset:22528
    v_mfma_f32_16x16x32_bf16 v[132:135], v[48:51], v[68:71], v[132:135]
    ds_read_b64_tr_b16 v[104:105], v16 offset:24576
    v_mfma_f32_16x16x32_bf16 v[156:159], v[52:55], v[68:71], v[156:159]
    ds_read_b64_tr_b16 v[106:107], v16 offset:26112
    v_mfma_f32_16x16x32_bf16 v[180:183], v[56:59], v[68:71], v[180:183]
    ds_read_b64_tr_b16 v[108:109], v17 offset:24576
    v_mfma_f32_16x16x32_bf16 v[204:207], v[60:63], v[68:71], v[204:207]
    ds_read_b64_tr_b16 v[110:111], v17 offset:26112
    v_mfma_f32_16x16x32_bf16 v[136:139], v[48:51], v[72:75], v[136:139]
    ds_read_b64_tr_b16 v[112:113], v18 offset:24576
    v_mfma_f32_16x16x32_bf16 v[160:163], v[52:55], v[72:75], v[160:163]
    ds_read_b64_tr_b16 v[114:115], v18 offset:26112
    v_mfma_f32_16x16x32_bf16 v[184:187], v[56:59], v[72:75], v[184:187]
    ds_read_b64_tr_b16 v[116:117], v16 offset:36864
    v_mfma_f32_16x16x32_bf16 v[208:211], v[60:63], v[72:75], v[208:211]
    ds_read_b64_tr_b16 v[118:119], v16 offset:38400
    v_mfma_f32_16x16x32_bf16 v[140:143], v[48:51], v[76:79], v[140:143]
    ds_read_b64_tr_b16 v[120:121], v17 offset:36864
    v_mfma_f32_16x16x32_bf16 v[164:167], v[52:55], v[76:79], v[164:167]
    ds_read_b64_tr_b16 v[122:123], v17 offset:38400
    s_add_u32 m0, s58, 0
    v_mfma_f32_16x16x32_bf16 v[188:191], v[56:59], v[76:79], v[188:191]
    buffer_load_dwordx4 v11, s[8:11], s50 offen lds
    v_mfma_f32_16x16x32_bf16 v[212:215], v[60:63], v[76:79], v[212:215]
    s_add_u32 m0, s58, 1024
    v_mfma_f32_16x16x32_bf16 v[144:147], v[48:51], v[80:83], v[144:147]
    buffer_load_dwordx4 v12, s[8:11], s50 offen lds
    v_mfma_f32_16x16x32_bf16 v[168:171], v[52:55], v[80:83], v[168:171]
    s_add_u32 m0, s58, 2048
    v_mfma_f32_16x16x32_bf16 v[192:195], v[56:59], v[80:83], v[192:195]
    buffer_load_dwordx4 v13, s[8:11], s50 offen lds
    s_add_u32 s50, s50, s55
    v_mfma_f32_16x16x32_bf16 v[216:219], v[60:63], v[80:83], v[216:219]
    s_cmp_eq_u32 s64, 8
    s_cbranch_scc0 L_KV_ep8
    s_not_b64 s[78:79], s[76:77]
    s_sub_u32 s78, s78, 200
    s_subb_u32 s79, s79, 0
    s_mov_b64 exec, 1
    v_mov_b32 v42, s78
    v_mov_b32 v43, s79
    v_mov_b32 v44, 0
    global_atomic_umax_x2 v44, v[42:43], s[36:37] sc1
    s_mov_b64 exec, -1
L_KV_ep8:
    s_cmp_ge_u32 s40, 5
    s_cbranch_scc0 L_KV_cpf
    s_getpc_b64 s[60:61]
L_KV_pc:
    s_cmp_eq_u32 s40, 5
    s_cselect_b32 s62, L_KV_ch0-L_KV_pc-2048, 0
    s_cmp_eq_u32 s40, 6
    s_cselect_b32 s62, L_pub-L_KV_pc+0, s62
    s_cmp_eq_u32 s40, 7
    s_cselect_b32 s62, L_pub-L_KV_pc+8192, s62
    v_lshl_add_u32 v44, v1, 7, s62
    v_min_u32 v44, L_code_end-L_KV_pc-4, v44
    v_mov_b32 v45, s61
    v_add_co_u32 v44, vcc, s60, v44
    s_nop 1
    v_addc_co_u32 v45, vcc, 0, v45, vcc
    global_load_dword v46, v[44:45], off
L_KV_cpf:
    s_waitcnt vmcnt(8) lgkmcnt(0)
    s_barrier
    v_mfma_f32_16x16x32_bf16 v[128:131], v[88:91], v[104:107], v[128:131]
    ds_read_b128 v[48:51], v14 offset:32768
    s_add_u32 m0, s58, 24576
    v_mfma_f32_16x16x32_bf16 v[152:155], v[92:95], v[104:107], v[152:155]
    ds_read_b128 v[52:55], v14 offset:34816
    buffer_load_dwordx4 v11, s[8:11], s50 offen lds
    v_mfma_f32_16x16x32_bf16 v[176:179], v[96:99], v[104:107], v[176:179]
    ds_read_b128 v[56:59], v14 offset:36864
    s_add_u32 m0, s58, 25600
    v_mfma_f32_16x16x32_bf16 v[200:203], v[100:103], v[104:107], v[200:203]
    ds_read_b128 v[60:63], v14 offset:38912
    buffer_load_dwordx4 v12, s[8:11], s50 offen lds
    v_mfma_f32_16x16x32_bf16 v[132:135], v[88:91], v[108:111], v[132:135]
    ds_read_b64_tr_b16 v[64:65], v22 offset:0
    s_add_u32 m0, s58, 26624
    v_mfma_f32_16x16x32_bf16 v[156:159], v[92:95], v[108:111], v[156:159]
    ds_read_b64_tr_b16 v[66:67], v22 offset:1536
    buffer_load_dwordx4 v13, s[8:11], s50 offen lds
    s_add_u32 s50, s50, s55
    v_mfma_f32_16x16x32_bf16 v[180:183], v[96:99], v[108:111], v[180:183]
    ds_read_b64_tr_b16 v[68:69], v23 offset:0
    s_add_u32 m0, s57, 16384
    s_movk_i32 s53, 896
    v_mfma_f32_16x16x32_bf16 v[204:207], v[100:103], v[108:111], v[204:207]
    ds_read_b64_tr_b16 v[70:71], v23 offset:1536
    buffer_load_dwordx4 v10, s[4:7], s53 offen lds
    v_mfma_f32_16x16x32_bf16 v[136:139], v[88:91], v[112:115], v[136:139]
    ds_read_b64_tr_b16 v[72:73], v24 offset:0
    s_add_u32 m0, s57, 17408
    s_movk_i32 s56, 11136
    v_mfma_f32_16x16x32_bf16 v[160:163], v[92:95], v[112:115], v[160:163]
    ds_read_b64_tr_b16 v[74:75], v24 offset:1536
    buffer_load_dwordx4 v10, s[4:7], s56 offen lds
    v_mfma_f32_16x16x32_bf16 v[184:187], v[96:99], v[112:115], v[184:187]
    ds_read_b64_tr_b16 v[76:77], v22 offset:12288
    v_mfma_f32_16x16x32_bf16 v[208:211], v[100:103], v[112:115], v[208:211]
    ds_read_b64_tr_b16 v[78:79], v22 offset:13824
    v_mfma_f32_16x16x32_bf16 v[140:143], v[88:91], v[116:119], v[140:143]
    ds_read_b64_tr_b16 v[80:81], v23 offset:12288
    v_mfma_f32_16x16x32_bf16 v[164:167], v[92:95], v[116:119], v[164:167]
    ds_read_b64_tr_b16 v[82:83], v23 offset:13824
    v_mfma_f32_16x16x32_bf16 v[188:191], v[96:99], v[116:119], v[188:191]
    v_mfma_f32_16x16x32_bf16 v[212:215], v[100:103], v[116:119], v[212:215]
    v_mfma_f32_16x16x32_bf16 v[144:147], v[88:91], v[120:123], v[144:147]
    v_mfma_f32_16x16x32_bf16 v[168:171], v[92:95], v[120:123], v[168:171]
    v_mfma_f32_16x16x32_bf16 v[192:195], v[96:99], v[120:123], v[192:195]
    v_mfma_f32_16x16x32_bf16 v[216:219], v[100:103], v[120:123], v[216:219]
    s_cmp_eq_u32 s64, 9
    s_cbranch_scc0 L_KV_ep9
    s_not_b64 s[78:79], s[76:77]
    s_sub_u32 s78, s78, 200
    s_subb_u32 s79, s79, 0
    s_mov_b64 exec, 1
    v_mov_b32 v42, s78
    v_mov_b32 v43, s79
    v_mov_b32 v44, 0
    global_atomic_umax_x2 v44, v[42:43], s[36:37] sc1
    s_mov_b64 exec, -1
L_KV_ep9:
    s_cmp_lt_u32 s40, 2
    s_cbranch_scc0 L_KV_t10
    s_waitcnt vmcnt(0)
L_KV_t10:
    s_waitcnt vmcnt(10) lgkmcnt(0)
    s_barrier
    v_mfma_f32_16x16x32_bf16 v[128:131], v[48:51], v[64:67], v[128:131]
    ds_read_b128 v[88:91], v15 offset:32768
    v_mfma_f32_16x16x32_bf16 v[152:155], v[52:55], v[64:67], v[152:155]
    ds_read_b128 v[92:95], v15 offset:34816
    v_mfma_f32_16x16x32_bf16 v[176:179], v[56:59], v[64:67], v[176:179]
    ds_read_b128 v[96:99], v15 offset:36864
    v_mfma_f32_16x16x32_bf16 v[200:203], v[60:63], v[64:67], v[200:203]
    ds_read_b128 v[100:103], v15 offset:38912
    v_mfma_f32_16x16x32_bf16 v[132:135], v[48:51], v[68:71], v[132:135]
    ds_read_b64_tr_b16 v[104:105], v22 offset:24576
    v_mfma_f32_16x16x32_bf16 v[156:159], v[52:55], v[68:71], v[156:159]
    ds_read_b64_tr_b16 v[106:107], v22 offset:26112
    v_mfma_f32_16x16x32_bf16 v[180:183], v[56:59], v[68:71], v[180:183]
    ds_read_b64_tr_b16 v[108:109], v23 offset:24576
    v_mfma_f32_16x16x32_bf16 v[204:207], v[60:63], v[68:71], v[204:207]
    ds_read_b64_tr_b16 v[110:111], v23 offset:26112
    v_mfma_f32_16x16x32_bf16 v[136:139], v[48:51], v[72:75], v[136:139]
    ds_read_b64_tr_b16 v[112:113], v24 offset:24576
    v_mfma_f32_16x16x32_bf16 v[160:163], v[52:55], v[72:75], v[160:163]
    ds_read_b64_tr_b16 v[114:115], v24 offset:26112
    v_mfma_f32_16x16x32_bf16 v[184:187], v[56:59], v[72:75], v[184:187]
    ds_read_b64_tr_b16 v[116:117], v22 offset:36864
    v_mfma_f32_16x16x32_bf16 v[208:211], v[60:63], v[72:75], v[208:211]
    ds_read_b64_tr_b16 v[118:119], v22 offset:38400
    v_mfma_f32_16x16x32_bf16 v[140:143], v[48:51], v[76:79], v[140:143]
    ds_read_b64_tr_b16 v[120:121], v23 offset:36864
    v_mfma_f32_16x16x32_bf16 v[164:167], v[52:55], v[76:79], v[164:167]
    ds_read_b64_tr_b16 v[122:123], v23 offset:38400
    s_add_u32 m0, s58, 49152
    v_mfma_f32_16x16x32_bf16 v[188:191], v[56:59], v[76:79], v[188:191]
    buffer_load_dwordx4 v11, s[8:11], s50 offen lds
    v_mfma_f32_16x16x32_bf16 v[212:215], v[60:63], v[76:79], v[212:215]
    s_add_u32 m0, s58, 50176
    v_mfma_f32_16x16x32_bf16 v[144:147], v[48:51], v[80:83], v[144:147]
    buffer_load_dwordx4 v12, s[8:11], s50 offen lds
    v_mfma_f32_16x16x32_bf16 v[168:171], v[52:55], v[80:83], v[168:171]
    s_add_u32 m0, s58, 51200
    v_mfma_f32_16x16x32_bf16 v[192:195], v[56:59], v[80:83], v[192:195]
    buffer_load_dwordx4 v13, s[8:11], s50 offen lds
    s_add_u32 s50, s50, s55
    v_mfma_f32_16x16x32_bf16 v[216:219], v[60:63], v[80:83], v[216:219]
    s_cmp_eq_u32 s40, 0
    s_cbranch_scc0 L_KV_e9
    s_lshl_b32 s60, s41, 3
    s_memrealtime s[78:79]
    s_mov_b64 exec, 1
    s_waitcnt lgkmcnt(0)
    v_mov_b32 v40, s78
    v_mov_b32 v41, s79
    buffer_store_dwordx2 v[40:41], v37, s[12:15], s60 offen offset:0 sc1
    s_mov_b64 exec, -1
L_KV_e9:
    s_waitcnt vmcnt(8) lgkmcnt(0)
    s_barrier
    v_mfma_f32_16x16x32_bf16 v[128:131], v[88:91], v[104:107], v[128:131]
    ds_read_b128 v[48:51], v14 offset:0
    v_mfma_f32_16x16x32_bf16 v[152:155], v[92:95], v[104:107], v[152:155]
    ds_read_b128 v[52:55], v14 offset:2048
    v_mfma_f32_16x16x32_bf16 v[176:179], v[96:99], v[104:107], v[176:179]
    ds_read_b128 v[56:59], v14 offset:4096
    v_mfma_f32_16x16x32_bf16 v[200:203], v[100:103], v[104:107], v[200:203]
    ds_read_b128 v[60:63], v14 offset:6144
    v_mfma_f32_16x16x32_bf16 v[132:135], v[88:91], v[108:111], v[132:135]
    ds_read_b64_tr_b16 v[64:65], v16 offset:0
    v_mfma_f32_16x16x32_bf16 v[156:159], v[92:95], v[108:111], v[156:159]
    ds_read_b64_tr_b16 v[66:67], v16 offset:1536
    v_mfma_f32_16x16x32_bf16 v[180:183], v[96:99], v[108:111], v[180:183]
    ds_read_b64_tr_b16 v[68:69], v17 offset:0
    v_mfma_f32_16x16x32_bf16 v[204:207], v[100:103], v[108:111], v[204:207]
    ds_read_b64_tr_b16 v[70:71], v17 offset:1536
    v_mfma_f32_16x16x32_bf16 v[136:139], v[88:91], v[112:115], v[136:139]
    ds_read_b64_tr_b16 v[72:73], v18 offset:0
    v_mfma_f32_16x16x32_bf16 v[160:163], v[92:95], v[112:115], v[160:163]
    ds_read_b64_tr_b16 v[74:75], v18 offset:1536
    s_add_u32 m0, s58, 73728
    v_mfma_f32_16x16x32_bf16 v[184:187], v[96:99], v[112:115], v[184:187]
    ds_read_b64_tr_b16 v[76:77], v16 offset:12288
    buffer_load_dwordx4 v11, s[8:11], s50 offen lds
    v_mfma_f32_16x16x32_bf16 v[208:211], v[100:103], v[112:115], v[208:211]
    ds_read_b64_tr_b16 v[78:79], v16 offset:13824
    s_add_u32 m0, s58, 74752
    v_mfma_f32_16x16x32_bf16 v[140:143], v[88:91], v[116:119], v[140:143]
    ds_read_b64_tr_b16 v[80:81], v17 offset:12288
    buffer_load_dwordx4 v12, s[8:11], s50 offen lds
    v_mfma_f32_16x16x32_bf16 v[164:167], v[92:95], v[116:119], v[164:167]
    ds_read_b64_tr_b16 v[82:83], v17 offset:13824
    s_add_u32 m0, s58, 75776
    v_mfma_f32_16x16x32_bf16 v[188:191], v[96:99], v[116:119], v[188:191]
    buffer_load_dwordx4 v13, s[8:11], s50 offen lds
    s_add_u32 s50, s50, s55
    v_mfma_f32_16x16x32_bf16 v[212:215], v[100:103], v[116:119], v[212:215]
    s_add_u32 m0, s57, 32768
    s_movk_i32 s53, 1024
    v_mfma_f32_16x16x32_bf16 v[144:147], v[88:91], v[120:123], v[144:147]
    buffer_load_dwordx4 v10, s[4:7], s53 offen lds
    v_mfma_f32_16x16x32_bf16 v[168:171], v[92:95], v[120:123], v[168:171]
    s_add_u32 m0, s57, 33792
    s_movk_i32 s56, 11264
    v_mfma_f32_16x16x32_bf16 v[192:195], v[96:99], v[120:123], v[192:195]
    buffer_load_dwordx4 v10, s[4:7], s56 offen lds
    v_mfma_f32_16x16x32_bf16 v[216:219], v[100:103], v[120:123], v[216:219]
    s_waitcnt vmcnt(10) lgkmcnt(0)
    s_barrier
    v_mfma_f32_16x16x32_bf16 v[128:131], v[48:51], v[64:67], v[128:131]
    ds_read_b128 v[88:91], v15 offset:0
    v_mfma_f32_16x16x32_bf16 v[152:155], v[52:55], v[64:67], v[152:155]
    ds_read_b128 v[92:95], v15 offset:2048
    v_mfma_f32_16x16x32_bf16 v[176:179], v[56:59], v[64:67], v[176:179]
    ds_read_b128 v[96:99], v15 offset:4096
    v_mfma_f32_16x16x32_bf16 v[200:203], v[60:63], v[64:67], v[200:203]
    ds_read_b128 v[100:103], v15 offset:6144
    v_mfma_f32_16x16x32_bf16 v[132:135], v[48:51], v[68:71], v[132:135]
    ds_read_b64_tr_b16 v[104:105], v16 offset:24576
    v_mfma_f32_16x16x32_bf16 v[156:159], v[52:55], v[68:71], v[156:159]
    ds_read_b64_tr_b16 v[106:107], v16 offset:26112
    v_mfma_f32_16x16x32_bf16 v[180:183], v[56:59], v[68:71], v[180:183]
    ds_read_b64_tr_b16 v[108:109], v17 offset:24576
    v_mfma_f32_16x16x32_bf16 v[204:207], v[60:63], v[68:71], v[204:207]
    ds_read_b64_tr_b16 v[110:111], v17 offset:26112
    v_mfma_f32_16x16x32_bf16 v[136:139], v[48:51], v[72:75], v[136:139]
    ds_read_b64_tr_b16 v[112:113], v18 offset:24576
    v_mfma_f32_16x16x32_bf16 v[160:163], v[52:55], v[72:75], v[160:163]
    ds_read_b64_tr_b16 v[114:115], v18 offset:26112
    v_mfma_f32_16x16x32_bf16 v[184:187], v[56:59], v[72:75], v[184:187]
    ds_read_b64_tr_b16 v[116:117], v16 offset:36864
    v_mfma_f32_16x16x32_bf16 v[208:211], v[60:63], v[72:75], v[208:211]
    ds_read_b64_tr_b16 v[118:119], v16 offset:38400
    v_mfma_f32_16x16x32_bf16 v[140:143], v[48:51], v[76:79], v[140:143]
    ds_read_b64_tr_b16 v[120:121], v17 offset:36864
    v_mfma_f32_16x16x32_bf16 v[164:167], v[52:55], v[76:79], v[164:167]
    ds_read_b64_tr_b16 v[122:123], v17 offset:38400
    s_add_u32 m0, s58, 0
    v_mfma_f32_16x16x32_bf16 v[188:191], v[56:59], v[76:79], v[188:191]
    buffer_load_dwordx4 v11, s[8:11], s50 offen lds
    v_mfma_f32_16x16x32_bf16 v[212:215], v[60:63], v[76:79], v[212:215]
    s_add_u32 m0, s58, 1024
    v_mfma_f32_16x16x32_bf16 v[144:147], v[48:51], v[80:83], v[144:147]
    buffer_load_dwordx4 v12, s[8:11], s50 offen lds
    v_mfma_f32_16x16x32_bf16 v[168:171], v[52:55], v[80:83], v[168:171]
    s_add_u32 m0, s58, 2048
    v_mfma_f32_16x16x32_bf16 v[192:195], v[56:59], v[80:83], v[192:195]
    buffer_load_dwordx4 v13, s[8:11], s50 offen lds
    s_add_u32 s50, s50, s55
    v_mfma_f32_16x16x32_bf16 v[216:219], v[60:63], v[80:83], v[216:219]
    s_waitcnt vmcnt(8) lgkmcnt(0)
    s_barrier
    v_mfma_f32_16x16x32_bf16 v[128:131], v[88:91], v[104:107], v[128:131]
    ds_read_b128 v[48:51], v14 offset:16384
    v_mfma_f32_16x16x32_bf16 v[152:155], v[92:95], v[104:107], v[152:155]
    ds_read_b128 v[52:55], v14 offset:18432
    v_mfma_f32_16x16x32_bf16 v[176:179], v[96:99], v[104:107], v[176:179]
    ds_read_b128 v[56:59], v14 offset:20480
    v_mfma_f32_16x16x32_bf16 v[200:203], v[100:103], v[104:107], v[200:203]
    ds_read_b128 v[60:63], v14 offset:22528
    v_mfma_f32_16x16x32_bf16 v[132:135], v[88:91], v[108:111], v[132:135]
    ds_read_b64_tr_b16 v[64:65], v22 offset:0
    v_mfma_f32_16x16x32_bf16 v[156:159], v[92:95], v[108:111], v[156:159]
    ds_read_b64_tr_b16 v[66:67], v22 offset:1536
    v_mfma_f32_16x16x32_bf16 v[180:183], v[96:99], v[108:111], v[180:183]
    ds_read_b64_tr_b16 v[68:69], v23 offset:0
    v_mfma_f32_16x16x32_bf16 v[204:207], v[100:103], v[108:111], v[204:207]
    ds_read_b64_tr_b16 v[70:71], v23 offset:1536
    v_mfma_f32_16x16x32_bf16 v[136:139], v[88:91], v[112:115], v[136:139]
    ds_read_b64_tr_b16 v[72:73], v24 offset:0
    v_mfma_f32_16x16x32_bf16 v[160:163], v[92:95], v[112:115], v[160:163]
    ds_read_b64_tr_b16 v[74:75], v24 offset:1536
    s_add_u32 m0, s58, 24576
    v_mfma_f32_16x16x32_bf16 v[184:187], v[96:99], v[112:115], v[184:187]
    ds_read_b64_tr_b16 v[76:77], v22 offset:12288
    buffer_load_dwordx4 v11, s[8:11], s50 offen lds
    v_mfma_f32_16x16x32_bf16 v[208:211], v[100:103], v[112:115], v[208:211]
    ds_read_b64_tr_b16 v[78:79], v22 offset:13824
    s_add_u32 m0, s58, 25600
    v_mfma_f32_16x16x32_bf16 v[140:143], v[88:91], v[116:119], v[140:143]
    ds_read_b64_tr_b16 v[80:81], v23 offset:12288
    buffer_load_dwordx4 v12, s[8:11], s50 offen lds
    v_mfma_f32_16x16x32_bf16 v[164:167], v[92:95], v[116:119], v[164:167]
    ds_read_b64_tr_b16 v[82:83], v23 offset:13824
    s_add_u32 m0, s58, 26624
    v_mfma_f32_16x16x32_bf16 v[188:191], v[96:99], v[116:119], v[188:191]
    buffer_load_dwordx4 v13, s[8:11], s50 offen lds
    s_add_u32 s50, s50, s55
    v_mfma_f32_16x16x32_bf16 v[212:215], v[100:103], v[116:119], v[212:215]
    s_add_u32 m0, s57, 0
    s_movk_i32 s53, 1152
    v_mfma_f32_16x16x32_bf16 v[144:147], v[88:91], v[120:123], v[144:147]
    buffer_load_dwordx4 v10, s[4:7], s53 offen lds
    v_mfma_f32_16x16x32_bf16 v[168:171], v[92:95], v[120:123], v[168:171]
    s_add_u32 m0, s57, 1024
    s_movk_i32 s56, 11392
    v_mfma_f32_16x16x32_bf16 v[192:195], v[96:99], v[120:123], v[192:195]
    buffer_load_dwordx4 v10, s[4:7], s56 offen lds
    v_mfma_f32_16x16x32_bf16 v[216:219], v[100:103], v[120:123], v[216:219]
    s_cmp_eq_u32 s40, 0
    s_cbranch_scc0 L_KV_e12
    s_mov_b64 exec, 0xffffffff
    buffer_load_dwordx2 v[40:41], v37, s[12:15], 0 offen offset:0 sc1
    s_mov_b64 exec, -1
L_KV_e12:
    s_waitcnt vmcnt(10) lgkmcnt(0)
    s_barrier
    v_mfma_f32_16x16x32_bf16 v[128:131], v[48:51], v[64:67], v[128:131]
    ds_read_b128 v[88:91], v15 offset:16384
    v_mfma_f32_16x16x32_bf16 v[152:155], v[52:55], v[64:67], v[152:155]
    ds_read_b128 v[92:95], v15 offset:18432
    v_mfma_f32_16x16x32_bf16 v[176:179], v[56:59], v[64:67], v[176:179]
    ds_read_b128 v[96:99], v15 offset:20480
    v_mfma_f32_16x16x32_bf16 v[200:203], v[60:63], v[64:67], v[200:203]
    ds_read_b128 v[100:103], v15 offset:22528
    v_mfma_f32_16x16x32_bf16 v[132:135], v[48:51], v[68:71], v[132:135]
    ds_read_b64_tr_b16 v[104:105], v22 offset:24576
    v_mfma_f32_16x16x32_bf16 v[156:159], v[52:55], v[68:71], v[156:159]
    ds_read_b64_tr_b16 v[106:107], v22 offset:26112
    v_mfma_f32_16x16x32_bf16 v[180:183], v[56:59], v[68:71], v[180:183]
    ds_read_b64_tr_b16 v[108:109], v23 offset:24576
    v_mfma_f32_16x16x32_bf16 v[204:207], v[60:63], v[68:71], v[204:207]
    ds_read_b64_tr_b16 v[110:111], v23 offset:26112
    v_mfma_f32_16x16x32_bf16 v[136:139], v[48:51], v[72:75], v[136:139]
    ds_read_b64_tr_b16 v[112:113], v24 offset:24576
    v_mfma_f32_16x16x32_bf16 v[160:163], v[52:55], v[72:75], v[160:163]
    ds_read_b64_tr_b16 v[114:115], v24 offset:26112
    v_mfma_f32_16x16x32_bf16 v[184:187], v[56:59], v[72:75], v[184:187]
    ds_read_b64_tr_b16 v[116:117], v22 offset:36864
    v_mfma_f32_16x16x32_bf16 v[208:211], v[60:63], v[72:75], v[208:211]
    ds_read_b64_tr_b16 v[118:119], v22 offset:38400
    v_mfma_f32_16x16x32_bf16 v[140:143], v[48:51], v[76:79], v[140:143]
    ds_read_b64_tr_b16 v[120:121], v23 offset:36864
    v_mfma_f32_16x16x32_bf16 v[164:167], v[52:55], v[76:79], v[164:167]
    ds_read_b64_tr_b16 v[122:123], v23 offset:38400
    s_add_u32 m0, s58, 49152
    v_mfma_f32_16x16x32_bf16 v[188:191], v[56:59], v[76:79], v[188:191]
    buffer_load_dwordx4 v11, s[8:11], s50 offen lds
    v_mfma_f32_16x16x32_bf16 v[212:215], v[60:63], v[76:79], v[212:215]
    s_add_u32 m0, s58, 50176
    v_mfma_f32_16x16x32_bf16 v[144:147], v[48:51], v[80:83], v[144:147]
    buffer_load_dwordx4 v12, s[8:11], s50 offen lds
    v_mfma_f32_16x16x32_bf16 v[168:171], v[52:55], v[80:83], v[168:171]
    s_add_u32 m0, s58, 51200
    v_mfma_f32_16x16x32_bf16 v[192:195], v[56:59], v[80:83], v[192:195]
    buffer_load_dwordx4 v13, s[8:11], s50 offen lds
    s_add_u32 s50, s50, s55
    v_mfma_f32_16x16x32_bf16 v[216:219], v[60:63], v[80:83], v[216:219]
    s_cmp_eq_u32 s40, 0
    s_cbranch_scc0 L_KV_ck15
    s_waitcnt vmcnt(3)
    s_mov_b32 s65, 0
L_KV_sp15:
    s_mov_b64 exec, 0xffffffff
    v_mov_b32 v43, s77
    v_subrev_co_u32 v42, vcc, s76, v40
    s_nop 1
    v_subb_co_u32 v43, vcc, v41, v43, vcc
    v_lshrrev_b32 v42, 30, v42
    v_or_b32 v42, v42, v43
    v_cmp_ne_u32 vcc, 0, v42
    s_mov_b64 exec, -1
    s_cmp_eq_u64 vcc, 0
    s_cbranch_scc1 L_KV_ck15
    s_add_u32 s65, s65, 1
    s_cmp_ge_u32 s65, 0x400000
    s_cbranch_scc1 L_KV_ck15
    s_sleep 4
    s_mov_b64 exec, 0xffffffff
    buffer_load_dwordx2 v[40:41], v37, s[12:15], 0 offen offset:0 sc1
    s_mov_b64 exec, -1
    s_and_b32 s66, s65, 15
    s_cmp_lg_u32 s66, 0
    s_cbranch_scc1 L_KV_sp15_w
    v_mov_b32 v42, 0
    global_load_dwordx2 v[42:43], v42, s[36:37] sc1
    s_waitcnt vmcnt(0)
    v_readfirstlane_b32 s78, v42
    v_readfirstlane_b32 s79, v43
    s_nop 0
    s_cmp_eq_u64 s[78:79], 0
    s_cbranch_scc1 L_KV_sp15_w
    s_not_b64 s[78:79], s[78:79]
    s_sub_u32 s78, s78, 200
    s_subb_u32 s79, s79, 0
    s_sub_u32 s66, s78, s76
    s_subb_u32 s66, s79, s77
    s_cselect_b32 s76, s78, s76
    s_cselect_b32 s77, s79, s77
L_KV_sp15_w:
    s_waitcnt vmcnt(0)
    s_branch L_KV_sp15
L_KV_ck15:
    s_waitcnt vmcnt(8) lgkmcnt(0)
    s_barrier
    buffer_load_dwordx4 v[224:227], v39, s[12:15], 0 offen offset:0 sc1
    buffer_load_dwordx4 v[228:231], v39, s[12:15], 0 offen offset:1536 sc1
    buffer_load_dwordx4 v[232:235], v39, s[12:15], 0 offen offset:3072 sc1
    buffer_load_dwordx4 v[236:239], v39, s[12:15], s67 offen sc1
    s_cmp_ge_u32 s40, 6
    s_cbranch_scc0 L_KV_s16
    buffer_load_dwordx2 v[240:241], v29, s[12:15], 0 offen sc1
L_KV_s16:
    v_mfma_f32_16x16x32_bf16 v[128:131], v[88:91], v[104:107], v[128:131]
    ds_read_b128 v[48:51], v14 offset:32768
    v_mfma_f32_16x16x32_bf16 v[152:155], v[92:95], v[104:107], v[152:155]
    ds_read_b128 v[52:55], v14 offset:34816
    v_mfma_f32_16x16x32_bf16 v[176:179], v[96:99], v[104:107], v[176:179]
    ds_read_b128 v[56:59], v14 offset:36864
    v_mfma_f32_16x16x32_bf16 v[200:203], v[100:103], v[104:107], v[200:203]
    ds_read_b128 v[60:63], v14 offset:38912
    v_mfma_f32_16x16x32_bf16 v[132:135], v[88:91], v[108:111], v[132:135]
    ds_read_b64_tr_b16 v[64:65], v16 offset:0
    v_mfma_f32_16x16x32_bf16 v[156:159], v[92:95], v[108:111], v[156:159]
    ds_read_b64_tr_b16 v[66:67], v16 offset:1536
    v_mfma_f32_16x16x32_bf16 v[180:183], v[96:99], v[108:111], v[180:183]
    ds_read_b64_tr_b16 v[68:69], v17 offset:0
    v_mfma_f32_16x16x32_bf16 v[204:207], v[100:103], v[108:111], v[204:207]
    ds_read_b64_tr_b16 v[70:71], v17 offset:1536
    v_mfma_f32_16x16x32_bf16 v[136:139], v[88:91], v[112:115], v[136:139]
    ds_read_b64_tr_b16 v[72:73], v18 offset:0
    v_mfma_f32_16x16x32_bf16 v[160:163], v[92:95], v[112:115], v[160:163]
    ds_read_b64_tr_b16 v[74:75], v18 offset:1536
    v_mfma_f32_16x16x32_bf16 v[184:187], v[96:99], v[112:115], v[184:187]
    ds_read_b64_tr_b16 v[76:77], v16 offset:12288
    v_mfma_f32_16x16x32_bf16 v[208:211], v[100:103], v[112:115], v[208:211]
    ds_read_b64_tr_b16 v[78:79], v16 offset:13824
    v_mfma_f32_16x16x32_bf16 v[140:143], v[88:91], v[116:119], v[140:143]
    ds_read_b64_tr_b16 v[80:81], v17 offset:12288
    v_mfma_f32_16x16x32_bf16 v[164:167], v[92:95], v[116:119], v[164:167]
    ds_read_b64_tr_b16 v[82:83], v17 offset:13824
    s_add_u32 m0, s58, 73728
    v_mfma_f32_16x16x32_bf16 v[188:191], v[96:99], v[116:119], v[188:191]
    buffer_load_dwordx4 v11, s[8:11], s50 offen lds
    v_mfma_f32_16x16x32_bf16 v[212:215], v[100:103], v[116:119], v[212:215]
    s_add_u32 m0, s58, 74752
    v_mfma_f32_16x16x32_bf16 v[144:147], v[88:91], v[120:123], v[144:147]
    buffer_load_dwordx4 v12, s[8:11], s50 offen lds
    v_mfma_f32_16x16x32_bf16 v[168:171], v[92:95], v[120:123], v[168:171]
    s_add_u32 m0, s58, 75776
    v_mfma_f32_16x16x32_bf16 v[192:195], v[96:99], v[120:123], v[192:195]
    buffer_load_dwordx4 v13, s[8:11], s50 offen lds
    s_add_u32 s50, s50, s55
    v_mfma_f32_16x16x32_bf16 v[216:219], v[100:103], v[120:123], v[216:219]
    s_add_u32 m0, s16, 20480
    s_add_u32 s52, s3, 0
    s_cmp_eq_u32 s19, 0
    buffer_load_dwordx4 v21, s[12:15], s52 offen sc1 lds
    s_cbranch_scc1 L_p2_x25
    s_add_u32 m0, s17, 20480
    s_add_u32 s52, s52, s18
    buffer_load_dwordx4 v21, s[12:15], s52 offen sc1 lds
L_p2_x25:
    s_waitcnt vmcnt(13) lgkmcnt(0)
    s_barrier
    v_mfma_f32_16x16x32_bf16 v[128:131], v[48:51], v[64:67], v[128:131]
    ds_read_b128 v[88:91], v15 offset:32768
    v_mfma_f32_16x16x32_bf16 v[152:155], v[52:55], v[64:67], v[152:155]
    ds_read_b128 v[92:95], v15 offset:34816
    v_mfma_f32_16x16x32_bf16 v[176:179], v[56:59], v[64:67], v[176:179]
    ds_read_b128 v[96:99], v15 offset:36864
    v_mfma_f32_16x16x32_bf16 v[200:203], v[60:63], v[64:67], v[200:203]
    ds_read_b128 v[100:103], v15 offset:38912
    v_mfma_f32_16x16x32_bf16 v[132:135], v[48:51], v[68:71], v[132:135]
    ds_read_b64_tr_b16 v[104:105], v16 offset:24576
    v_mfma_f32_16x16x32_bf16 v[156:159], v[52:55], v[68:71], v[156:159]
    ds_read_b64_tr_b16 v[106:107], v16 offset:26112
    v_mfma_f32_16x16x32_bf16 v[180:183], v[56:59], v[68:71], v[180:183]
    ds_read_b64_tr_b16 v[108:109], v17 offset:24576
    v_mfma_f32_16x16x32_bf16 v[204:207], v[60:63], v[68:71], v[204:207]
    ds_read_b64_tr_b16 v[110:111], v17 offset:26112
    v_mfma_f32_16x16x32_bf16 v[136:139], v[48:51], v[72:75], v[136:139]
    ds_read_b64_tr_b16 v[112:113], v18 offset:24576
    v_mfma_f32_16x16x32_bf16 v[160:163], v[52:55], v[72:75], v[160:163]
    ds_read_b64_tr_b16 v[114:115], v18 offset:26112
    v_mfma_f32_16x16x32_bf16 v[184:187], v[56:59], v[72:75], v[184:187]
    ds_read_b64_tr_b16 v[116:117], v16 offset:36864
    v_mfma_f32_16x16x32_bf16 v[208:211], v[60:63], v[72:75], v[208:211]
    ds_read_b64_tr_b16 v[118:119], v16 offset:38400
    v_mfma_f32_16x16x32_bf16 v[140:143], v[48:51], v[76:79], v[140:143]
    ds_read_b64_tr_b16 v[120:121], v17 offset:36864
    v_mfma_f32_16x16x32_bf16 v[164:167], v[52:55], v[76:79], v[164:167]
    ds_read_b64_tr_b16 v[122:123], v17 offset:38400
    v_mfma_f32_16x16x32_bf16 v[188:191], v[56:59], v[76:79], v[188:191]
    v_mfma_f32_16x16x32_bf16 v[212:215], v[60:63], v[76:79], v[212:215]
    v_mfma_f32_16x16x32_bf16 v[144:147], v[48:51], v[80:83], v[144:147]
    s_add_u32 m0, s16, 51200
    s_add_u32 s52, s3, 10240
    s_cmp_eq_u32 s19, 0
    buffer_load_dwordx4 v21, s[12:15], s52 offen sc1 lds
    s_cbranch_scc1 L_p2_x26
    s_add_u32 m0, s17, 51200
    s_add_u32 s52, s52, s18
    buffer_load_dwordx4 v21, s[12:15], s52 offen sc1 lds
L_p2_x26:
    v_mfma_f32_16x16x32_bf16 v[168:171], v[52:55], v[80:83], v[168:171]
    v_mfma_f32_16x16x32_bf16 v[192:195], v[56:59], v[80:83], v[192:195]
    s_add_u32 m0, s16, 61440
    s_add_u32 s52, s3, 20480
    s_cmp_eq_u32 s19, 0
    buffer_load_dwordx4 v21, s[12:15], s52 offen sc1 lds
    s_cbranch_scc1 L_p2_x27
    s_add_u32 m0, s17, 61440
    s_add_u32 s52, s52, s18
    buffer_load_dwordx4 v21, s[12:15], s52 offen sc1 lds
L_p2_x27:
    v_mfma_f32_16x16x32_bf16 v[216:219], v[60:63], v[80:83], v[216:219]
    s_waitcnt vmcnt(6) lgkmcnt(0)
    s_barrier
    s_cmp_lt_u32 s40, 6
    s_cbranch_scc0 L_KV_s17
    v_add_f32 v224, v224, v228
    v_add_f32 v225, v225, v229
    v_add_f32 v226, v226, v230
    v_add_f32 v227, v227, v231
    v_add_f32 v224, v224, v232
    v_add_f32 v225, v225, v233
    v_add_f32 v226, v226, v234
    v_add_f32 v227, v227, v235
    v_add_f32 v224, v224, v236
    v_add_f32 v225, v225, v237
    v_add_f32 v226, v226, v238
    v_add_f32 v227, v227, v239
    ds_write_b128 v30, v[224:227]
L_KV_s17:
    v_mfma_f32_16x16x32_bf16 v[128:131], v[88:91], v[104:107], v[128:131]
    ds_read_b128 v[48:51], v14 offset:0
    v_mfma_f32_16x16x32_bf16 v[152:155], v[92:95], v[104:107], v[152:155]
    ds_read_b128 v[52:55], v14 offset:2048
    v_mfma_f32_16x16x32_bf16 v[176:179], v[96:99], v[104:107], v[176:179]
    ds_read_b128 v[56:59], v14 offset:4096
    v_mfma_f32_16x16x32_bf16 v[200:203], v[100:103], v[104:107], v[200:203]
    ds_read_b128 v[60:63], v14 offset:6144
    v_mfma_f32_16x16x32_bf16 v[132:135], v[88:91], v[108:111], v[132:135]
    ds_read_b64_tr_b16 v[64:65], v22 offset:0
    v_mfma_f32_16x16x32_bf16 v[156:159], v[92:95], v[108:111], v[156:159]
    ds_read_b64_tr_b16 v[66:67], v22 offset:1536
    v_mfma_f32_16x16x32_bf16 v[180:183], v[96:99], v[108:111], v[180:183]
    ds_read_b64_tr_b16 v[68:69], v23 offset:0
    v_mfma_f32_16x16x32_bf16 v[204:207], v[100:103], v[108:111], v[204:207]
    ds_read_b64_tr_b16 v[70:71], v23 offset:1536
    v_mfma_f32_16x16x32_bf16 v[136:139], v[88:91], v[112:115], v[136:139]
    ds_read_b64_tr_b16 v[72:73], v24 offset:0
    v_mfma_f32_16x16x32_bf16 v[160:163], v[92:95], v[112:115], v[160:163]
    ds_read_b64_tr_b16 v[74:75], v24 offset:1536
    v_mfma_f32_16x16x32_bf16 v[184:187], v[96:99], v[112:115], v[184:187]
    ds_read_b64_tr_b16 v[76:77], v22 offset:12288
    v_mfma_f32_16x16x32_bf16 v[208:211], v[100:103], v[112:115], v[208:211]
    ds_read_b64_tr_b16 v[78:79], v22 offset:13824
    v_mfma_f32_16x16x32_bf16 v[140:143], v[88:91], v[116:119], v[140:143]
    ds_read_b64_tr_b16 v[80:81], v23 offset:12288
    s_add_u32 m0, s16, 30720
    s_add_u32 s52, s3, 30720
    s_cmp_eq_u32 s19, 0
    buffer_load_dwordx4 v21, s[12:15], s52 offen sc1 lds
    s_cbranch_scc1 L_p2_x28
    s_add_u32 m0, s17, 30720
    s_add_u32 s52, s52, s18
    buffer_load_dwordx4 v21, s[12:15], s52 offen sc1 lds
L_p2_x28:
    v_mfma_f32_16x16x32_bf16 v[164:167], v[92:95], v[116:119], v[164:167]
    ds_read_b64_tr_b16 v[82:83], v23 offset:13824
    v_mfma_f32_16x16x32_bf16 v[188:191], v[96:99], v[116:119], v[188:191]
    s_add_u32 m0, s16, 40960
    s_add_u32 s52, s3, 40960
    s_cmp_eq_u32 s19, 0
    buffer_load_dwordx4 v21, s[12:15], s52 offen sc1 lds
    s_cbranch_scc1 L_p2_x29
    s_add_u32 m0, s17, 40960
    s_add_u32 s52, s52, s18
    buffer_load_dwordx4 v21, s[12:15], s52 offen sc1 lds
L_p2_x29:
    v_mfma_f32_16x16x32_bf16 v[212:215], v[100:103], v[116:119], v[212:215]
    v_mfma_f32_16x16x32_bf16 v[144:147], v[88:91], v[120:123], v[144:147]
    s_add_u32 m0, s16, 71680
    s_add_u32 s52, s3, 51200
    s_cmp_eq_u32 s19, 0
    buffer_load_dwordx4 v21, s[12:15], s52 offen sc1 lds
    s_cbranch_scc1 L_p2_x30
    s_add_u32 m0, s17, 71680
    s_add_u32 s52, s52, s18
    buffer_load_dwordx4 v21, s[12:15], s52 offen sc1 lds
L_p2_x30:
    v_mfma_f32_16x16x32_bf16 v[168:171], v[92:95], v[120:123], v[168:171]
    v_mfma_f32_16x16x32_bf16 v[192:195], v[96:99], v[120:123], v[192:195]
    s_add_u32 m0, s16, 81920
    s_add_u32 s52, s3, 61440
    s_cmp_eq_u32 s19, 0
    buffer_load_dwordx4 v21, s[12:15], s52 offen sc1 lds
    s_cbranch_scc1 L_p2_x31
    s_add_u32 m0, s17, 81920
    s_add_u32 s52, s52, s18
    buffer_load_dwordx4 v21, s[12:15], s52 offen sc1 lds
L_p2_x31:
    v_mfma_f32_16x16x32_bf16 v[216:219], v[100:103], v[120:123], v[216:219]
    s_waitcnt vmcnt(7) lgkmcnt(0)
    s_barrier
    s_cmp_lt_u32 s40, 2
    s_cbranch_scc0 L_KV_s18
    v_cmp_gt_u32 vcc, 96, v0
    s_nop 0
    s_and_saveexec_b64 s[60:61], vcc
    v_lshlrev_b32 v2, 4, v0
    v_add_u32 v3, 147456, v2
    ds_read_b128 v[224:227], v3 offset:0
    ds_read_b128 v[228:231], v3 offset:1536
    ds_read_b128 v[232:235], v3 offset:3072
    ds_read_b128 v[236:239], v3 offset:4608
    s_mov_b64 exec, s[60:61]
L_KV_s18:
    v_mfma_f32_16x16x32_bf16 v[128:131], v[48:51], v[64:67], v[128:131]
    ds_read_b128 v[88:91], v15 offset:0
    v_mfma_f32_16x16x32_bf16 v[152:155], v[52:55], v[64:67], v[152:155]
    ds_read_b128 v[92:95], v15 offset:2048
    v_mfma_f32_16x16x32_bf16 v[176:179], v[56:59], v[64:67], v[176:179]
    ds_read_b128 v[96:99], v15 offset:4096
    v_mfma_f32_16x16x32_bf16 v[200:203], v[60:63], v[64:67], v[200:203]
    ds_read_b128 v[100:103], v15 offset:6144
    v_mfma_f32_16x16x32_bf16 v[132:135], v[48:51], v[68:71], v[132:135]
    ds_read_b64_tr_b16 v[104:105], v22 offset:24576
    v_mfma_f32_16x16x32_bf16 v[156:159], v[52:55], v[68:71], v[156:159]
    ds_read_b64_tr_b16 v[106:107], v22 offset:26112
    v_mfma_f32_16x16x32_bf16 v[180:183], v[56:59], v[68:71], v[180:183]
    ds_read_b64_tr_b16 v[108:109], v23 offset:24576
    v_mfma_f32_16x16x32_bf16 v[204:207], v[60:63], v[68:71], v[204:207]
    ds_read_b64_tr_b16 v[110:111], v23 offset:26112
    v_mfma_f32_16x16x32_bf16 v[136:139], v[48:51], v[72:75], v[136:139]
    ds_read_b64_tr_b16 v[112:113], v24 offset:24576
    v_mfma_f32_16x16x32_bf16 v[160:163], v[52:55], v[72:75], v[160:163]
    ds_read_b64_tr_b16 v[114:115], v24 offset:26112
    v_mfma_f32_16x16x32_bf16 v[184:187], v[56:59], v[72:75], v[184:187]
    ds_read_b64_tr_b16 v[116:117], v22 offset:36864
    v_mfma_f32_16x16x32_bf16 v[208:211], v[60:63], v[72:75], v[208:211]
    ds_read_b64_tr_b16 v[118:119], v22 offset:38400
    v_mfma_f32_16x16x32_bf16 v[140:143], v[48:51], v[76:79], v[140:143]
    ds_read_b64_tr_b16 v[120:121], v23 offset:36864
    v_mfma_f32_16x16x32_bf16 v[164:167], v[52:55], v[76:79], v[164:167]
    ds_read_b64_tr_b16 v[122:123], v23 offset:38400
    v_mfma_f32_16x16x32_bf16 v[188:191], v[56:59], v[76:79], v[188:191]
    s_add_u32 m0, s16, 92160
    s_add_u32 s52, s3, 71680
    s_cmp_eq_u32 s19, 0
    buffer_load_dwordx4 v21, s[12:15], s52 offen sc1 lds
    s_cbranch_scc1 L_p2_x32
    s_add_u32 m0, s17, 92160
    s_add_u32 s52, s52, s18
    buffer_load_dwordx4 v21, s[12:15], s52 offen sc1 lds
L_p2_x32:
    v_mfma_f32_16x16x32_bf16 v[212:215], v[60:63], v[76:79], v[212:215]
    v_mfma_f32_16x16x32_bf16 v[144:147], v[48:51], v[80:83], v[144:147]
    s_add_u32 m0, s16, 102400
    s_add_u32 s52, s3, 81920
    s_cmp_eq_u32 s19, 0
    buffer_load_dwordx4 v21, s[12:15], s52 offen sc1 lds
    s_cbranch_scc1 L_p2_x33
    s_add_u32 m0, s17, 102400
    s_add_u32 s52, s52, s18
    buffer_load_dwordx4 v21, s[12:15], s52 offen sc1 lds
L_p2_x33:
    v_mfma_f32_16x16x32_bf16 v[168:171], v[52:55], v[80:83], v[168:171]
    v_mfma_f32_16x16x32_bf16 v[192:195], v[56:59], v[80:83], v[192:195]
    s_add_u32 m0, s16, 112640
    s_add_u32 s52, s3, 92160
    s_cmp_eq_u32 s19, 0
    buffer_load_dwordx4 v21, s[12:15], s52 offen sc1 lds
    s_cbranch_scc1 L_p2_x34
    s_add_u32 m0, s17, 112640
    s_add_u32 s52, s52, s18
    buffer_load_dwordx4 v21, s[12:15], s52 offen sc1 lds
L_p2_x34:
    v_mfma_f32_16x16x32_bf16 v[216:219], v[60:63], v[80:83], v[216:219]
    s_cmp_lt_u32 s40, 2
    s_cbranch_scc0 L_KV_e18a
    s_and_saveexec_b64 s[60:61], vcc
    s_waitcnt lgkmcnt(0)
    v_add_f32 v224, v224, v228
    v_add_f32 v225, v225, v229
    v_add_f32 v226, v226, v230
    v_add_f32 v227, v227, v231
    v_add_f32 v224, v224, v232
    v_add_f32 v225, v225, v233
    v_add_f32 v226, v226, v234
    v_add_f32 v227, v227, v235
    v_add_f32 v224, v224, v236
    v_add_f32 v225, v225, v237
    v_add_f32 v226, v226, v238
    v_add_f32 v227, v227, v239
    ds_write_b128 v3, v[224:227] offset:12288
    s_mov_b64 exec, s[60:61]
L_KV_e18a:
    s_cmp_ge_u32 s40, 6
    s_cbranch_scc0 L_KV_e18b
    s_waitcnt vmcnt(10)
    ds_write_b32 v30, v240
    ds_write_b32 v30, v241 offset:512
L_KV_e18b:
    s_waitcnt lgkmcnt(0)
    s_barrier
    s_lshl_b32 s60, s45, 8
    s_add_u32 s60, s60, 161280
    v_lshl_add_u32 v2, v9, 4, s60
    v_mfma_f32_16x16x32_bf16 v[128:131], v[88:91], v[104:107], v[128:131]
    ds_read_b32 v48, v31
    v_mfma_f32_16x16x32_bf16 v[152:155], v[92:95], v[104:107], v[152:155]
    ds_read_b32 v49, v31 offset:64
    v_mfma_f32_16x16x32_bf16 v[176:179], v[96:99], v[104:107], v[176:179]
    ds_read_b32 v50, v32
    s_add_u32 m0, s16, 0
    s_add_u32 s52, s3, 102400
    s_cmp_eq_u32 s19, 0
    buffer_load_dwordx4 v21, s[12:15], s52 offen sc1 lds
    s_cbranch_scc1 L_p2_x35
    s_add_u32 m0, s17, 0
    s_add_u32 s52, s52, s18
    buffer_load_dwordx4 v21, s[12:15], s52 offen sc1 lds
L_p2_x35:
    v_mfma_f32_16x16x32_bf16 v[200:203], v[100:103], v[104:107], v[200:203]
    ds_read_b32 v51, v31 offset:768
    v_mfma_f32_16x16x32_bf16 v[132:135], v[88:91], v[108:111], v[132:135]
    ds_read_b32 v52, v31 offset:832
    v_mfma_f32_16x16x32_bf16 v[156:159], v[92:95], v[108:111], v[156:159]
    ds_read_b128 v[56:59], v2 offset:0
    v_mfma_f32_16x16x32_bf16 v[180:183], v[96:99], v[108:111], v[180:183]
    ds_read_b128 v[72:75], v2 offset:512
    s_add_u32 m0, s16, 10240
    s_add_u32 s52, s3, 112640
    s_cmp_eq_u32 s19, 0
    buffer_load_dwordx4 v21, s[12:15], s52 offen sc1 lds
    s_cbranch_scc1 L_p2_x36
    s_add_u32 m0, s17, 10240
    s_add_u32 s52, s52, s18
    buffer_load_dwordx4 v21, s[12:15], s52 offen sc1 lds
L_p2_x36:
    v_mfma_f32_16x16x32_bf16 v[204:207], v[100:103], v[108:111], v[204:207]
    ds_read_b128 v[60:63], v2 offset:64
    v_mfma_f32_16x16x32_bf16 v[136:139], v[88:91], v[112:115], v[136:139]
    ds_read_b128 v[76:79], v2 offset:576
    v_mfma_f32_16x16x32_bf16 v[160:163], v[92:95], v[112:115], v[160:163]
    ds_read_b128 v[64:67], v2 offset:128
    v_mfma_f32_16x16x32_bf16 v[184:187], v[96:99], v[112:115], v[184:187]
    ds_read_b128 v[80:83], v2 offset:640
    v_mfma_f32_16x16x32_bf16 v[208:211], v[100:103], v[112:115], v[208:211]
    ds_read_b128 v[68:71], v2 offset:192
    v_mfma_f32_16x16x32_bf16 v[140:143], v[88:91], v[116:119], v[140:143]
    ds_read_b128 v[84:87], v2 offset:704
    v_mfma_f32_16x16x32_bf16 v[164:167], v[92:95], v[116:119], v[164:167]
    s_mov_b32 s60, 0x3fb8aa3b
    v_mfma_f32_16x16x32_bf16 v[188:191], v[96:99], v[116:119], v[188:191]
    v_mfma_f32_16x16x32_bf16 v[212:215], v[100:103], v[116:119], v[212:215]
    v_mfma_f32_16x16x32_bf16 v[144:147], v[88:91], v[120:123], v[144:147]
    v_mfma_f32_16x16x32_bf16 v[168:171], v[92:95], v[120:123], v[168:171]
    v_mfma_f32_16x16x32_bf16 v[192:195], v[96:99], v[120:123], v[192:195]
    v_mfma_f32_16x16x32_bf16 v[216:219], v[100:103], v[120:123], v[216:219]
L_KV_ch0:
    s_waitcnt lgkmcnt(0)
    s_mov_b32 s69, s68
    v_mov_b32 v244, 0x3f803f80
    v_mov_b32 v245, 0x3f803f80
    v_mov_b32 v246, 0x3f803f80
    v_mov_b32 v247, 0x3f803f80
    v_mul_f32 v224, s60, v72
    v_mul_f32 v225, s60, v73
    v_mul_f32 v226, s60, v74
    v_mul_f32 v227, s60, v75
    v_fmac_f32 v128, v56, v48
    v_fmac_f32 v129, v57, v48
    v_fmac_f32 v130, v58, v48
    v_fmac_f32 v131, v59, v48
    v_mul_f32 v232, v128, v224
    v_mul_f32 v233, v129, v225
    v_mul_f32 v234, v130, v226
    v_mul_f32 v235, v131, v227
    v_exp_f32 v232, v232 clamp
    v_max_f32 v128, 0, v128
    v_exp_f32 v233, v233 clamp
    v_max_f32 v129, 0, v129
    v_exp_f32 v234, v234 clamp
    v_max_f32 v130, 0, v130
    v_exp_f32 v235, v235 clamp
    v_max_f32 v131, 0, v131
    v_fmac_f32 v232, v128, v72
    v_fmac_f32 v233, v129, v73
    v_fmac_f32 v234, v130, v74
    v_fmac_f32 v235, v131, v75
    v_add_f32 v232, s68, v232
    v_add_f32 v233, s68, v233
    v_add_f32 v234, s68, v234
    v_add_f32 v235, s68, v235
    v_cvt_pk_bf16_f32 v88, v232, v233
    v_cvt_pk_bf16_f32 v89, v234, v235
    v_fmac_f32 v132, v56, v49
    v_fmac_f32 v133, v57, v49
    v_fmac_f32 v134, v58, v49
    v_fmac_f32 v135, v59, v49
    v_mul_f32 v236, v132, v224
    v_mul_f32 v237, v133, v225
    v_mul_f32 v238, v134, v226
    v_mul_f32 v239, v135, v227
    v_exp_f32 v236, v236 clamp
    v_max_f32 v132, 0, v132
    v_exp_f32 v237, v237 clamp
    v_max_f32 v133, 0, v133
    v_exp_f32 v238, v238 clamp
    v_max_f32 v134, 0, v134
    v_exp_f32 v239, v239 clamp
    v_max_f32 v135, 0, v135
    v_fmac_f32 v236, v132, v72
    v_fmac_f32 v237, v133, v73
    v_fmac_f32 v238, v134, v74
    v_fmac_f32 v239, v135, v75
    v_add_f32 v236, s68, v236
    v_add_f32 v237, s68, v237
    v_add_f32 v238, s68, v238
    v_add_f32 v239, s68, v239
    v_cvt_pk_bf16_f32 v96, v236, v237
    v_cvt_pk_bf16_f32 v97, v238, v239
    v_fmac_f32 v136, v56, v50
    v_fmac_f32 v137, v57, v50
    v_fmac_f32 v138, v58, v50
    v_fmac_f32 v139, v59, v50
    v_mul_f32 v240, v136, v72
    v_mul_f32 v241, v137, v73
    v_mul_f32 v242, v138, v74
    v_mul_f32 v243, v139, v75
    v_mul_f32 v232, v136, v224
    v_mul_f32 v233, v137, v225
    v_mul_f32 v234, v138, v226
    v_mul_f32 v235, v139, v227
    v_exp_f32 v232, v232 clamp
    v_max_f32 v136, 0, v136
    v_exp_f32 v233, v233 clamp
    v_max_f32 v137, 0, v137
    v_exp_f32 v234, v234 clamp
    v_max_f32 v138, 0, v138
    v_exp_f32 v235, v235 clamp
    v_max_f32 v139, 0, v139
    v_fmac_f32 v232, v136, v72
    v_fmac_f32 v233, v137, v73
    v_fmac_f32 v234, v138, v74
    v_fmac_f32 v235, v139, v75
    v_add_f32 v232, s68, v232
    v_add_f32 v233, s68, v233
    v_add_f32 v234, s68, v234
    v_add_f32 v235, s68, v235
    v_cndmask_b32 v232, v232, v240, s[74:75]
    v_cndmask_b32 v233, v233, v241, s[74:75]
    v_cndmask_b32 v234, v234, v242, s[74:75]
    v_cndmask_b32 v235, v235, v243, s[74:75]
    v_cvt_pk_bf16_f32 v104, v232, v233
    v_cvt_pk_bf16_f32 v105, v234, v235
    v_fmac_f32 v140, v56, v51
    v_fmac_f32 v141, v57, v51
    v_fmac_f32 v142, v58, v51
    v_fmac_f32 v143, v59, v51
    v_mul_f32 v140, v140, v72
    v_mul_f32 v141, v141, v73
    v_mul_f32 v142, v142, v74
    v_mul_f32 v143, v143, v75
    v_cvt_pk_bf16_f32 v112, v140, v141
    v_cvt_pk_bf16_f32 v113, v142, v143
    v_fmac_f32 v144, v56, v52
    v_fmac_f32 v145, v57, v52
    v_fmac_f32 v146, v58, v52
    v_fmac_f32 v147, v59, v52
    v_mul_f32 v144, v144, v72
    v_mul_f32 v145, v145, v73
    v_mul_f32 v146, v146, v74
    v_mul_f32 v147, v147, v75
    v_cvt_pk_bf16_f32 v120, v144, v145
    v_cvt_pk_bf16_f32 v121, v146, v147
    v_mul_f32 v228, s60, v76
    v_mul_f32 v229, s60, v77
    v_mul_f32 v230, s60, v78
    v_mul_f32 v231, s60, v79
    v_fmac_f32 v152, v60, v48
    v_fmac_f32 v153, v61, v48
    v_fmac_f32 v154, v62, v48
    v_fmac_f32 v155, v63, v48
    v_mul_f32 v232, v152, v228
    v_mul_f32 v233, v153, v229
    v_mul_f32 v234, v154, v230
    v_mul_f32 v235, v155, v231
    v_exp_f32 v232, v232 clamp
    v_max_f32 v152, 0, v152
    v_exp_f32 v233, v233 clamp
    v_max_f32 v153, 0, v153
    v_exp_f32 v234, v234 clamp
    v_max_f32 v154, 0, v154
    v_exp_f32 v235, v235 clamp
    v_max_f32 v155, 0, v155
    v_fmac_f32 v232, v152, v76
    v_fmac_f32 v233, v153, v77
    v_fmac_f32 v234, v154, v78
    v_fmac_f32 v235, v155, v79
    v_add_f32 v232, s68, v232
    v_add_f32 v233, s68, v233
    v_add_f32 v234, s68, v234
    v_add_f32 v235, s68, v235
    v_cvt_pk_bf16_f32 v90, v232, v233
    v_cvt_pk_bf16_f32 v91, v234, v235
    v_fmac_f32 v156, v60, v49
    v_fmac_f32 v157, v61, v49
    v_fmac_f32 v158, v62, v49
    v_fmac_f32 v159, v63, v49
    v_mul_f32 v236, v156, v228
    v_mul_f32 v237, v157, v229
    v_mul_f32 v238, v158, v230
    v_mul_f32 v239, v159, v231
    v_exp_f32 v236, v236 clamp
    v_max_f32 v156, 0, v156
    v_exp_f32 v237, v237 clamp
    v_max_f32 v157, 0, v157
    v_exp_f32 v238, v238 clamp
    v_max_f32 v158, 0, v158
    v_exp_f32 v239, v239 clamp
    v_max_f32 v159, 0, v159
    v_fmac_f32 v236, v156, v76
    v_fmac_f32 v237, v157, v77
    v_fmac_f32 v238, v158, v78
    v_fmac_f32 v239, v159, v79
    v_add_f32 v236, s68, v236
    v_add_f32 v237, s68, v237
    v_add_f32 v238, s68, v238
    v_add_f32 v239, s68, v239
    v_cvt_pk_bf16_f32 v98, v236, v237
    v_cvt_pk_bf16_f32 v99, v238, v239
    v_fmac_f32 v160, v60, v50
    v_fmac_f32 v161, v61, v50
    v_fmac_f32 v162, v62, v50
    v_fmac_f32 v163, v63, v50
    v_mul_f32 v240, v160, v76
    v_mul_f32 v241, v161, v77
    v_mul_f32 v242, v162, v78
    v_mul_f32 v243, v163, v79
    v_mul_f32 v232, v160, v228
    v_mul_f32 v233, v161, v229
    v_mul_f32 v234, v162, v230
    v_mul_f32 v235, v163, v231
    v_exp_f32 v232, v232 clamp
    v_max_f32 v160, 0, v160
    v_exp_f32 v233, v233 clamp
    v_max_f32 v161, 0, v161
    v_exp_f32 v234, v234 clamp
    v_max_f32 v162, 0, v162
    v_exp_f32 v235, v235 clamp
    v_max_f32 v163, 0, v163
    v_fmac_f32 v232, v160, v76
    v_fmac_f32 v233, v161, v77
    v_fmac_f32 v234, v162, v78
    v_fmac_f32 v235, v163, v79
    v_add_f32 v232, s68, v232
    v_add_f32 v233, s68, v233
    v_add_f32 v234, s68, v234
    v_add_f32 v235, s68, v235
    v_cndmask_b32 v232, v232, v240, s[74:75]
    v_cndmask_b32 v233, v233, v241, s[74:75]
    v_cndmask_b32 v234, v234, v242, s[74:75]
    v_cndmask_b32 v235, v235, v243, s[74:75]
    v_cvt_pk_bf16_f32 v106, v232, v233
    v_cvt_pk_bf16_f32 v107, v234, v235
    v_fmac_f32 v164, v60, v51
    v_fmac_f32 v165, v61, v51
    v_fmac_f32 v166, v62, v51
    v_fmac_f32 v167, v63, v51
    v_mul_f32 v164, v164, v76
    v_mul_f32 v165, v165, v77
    v_mul_f32 v166, v166, v78
    v_mul_f32 v167, v167, v79
    v_cvt_pk_bf16_f32 v114, v164, v165
    v_cvt_pk_bf16_f32 v115, v166, v167
    v_fmac_f32 v168, v60, v52
    v_fmac_f32 v169, v61, v52
    v_fmac_f32 v170, v62, v52
    v_fmac_f32 v171, v63, v52
    v_mul_f32 v168, v168, v76
    v_mul_f32 v169, v169, v77
    v_mul_f32 v170, v170, v78
    v_mul_f32 v171, v171, v79
    v_cvt_pk_bf16_f32 v122, v168, v169
    v_cvt_pk_bf16_f32 v123, v170, v171
    v_mfma_f32_16x16x32_bf16 v[128:131], v[88:91], v[112:115], 0
    s_nop 0
    v_mfma_f32_16x16x32_bf16 v[132:135], v[88:91], v[120:123], 0
    v_mfma_f32_16x16x32_bf16 v[136:139], v[96:99], v[112:115], 0
    v_mfma_f32_16x16x32_bf16 v[140:143], v[96:99], v[120:123], 0
    v_mfma_f32_16x16x32_bf16 v[144:147], v[96:99], v[104:107], 0
    v_mfma_f32_16x16x32_bf16 v[152:155], v[104:107], v[120:123], 0
    v_mfma_f32_16x16x32_bf16 v[156:159], v[104:107], v[104:107], 0
    v_mfma_f32_16x16x32_bf16 v[160:163], v[88:91], v[244:247], 0
    v_mfma_f32_16x16x32_bf16 v[164:167], v[96:99], v[244:247], 0
    v_mfma_f32_16x16x32_bf16 v[168:171], v[104:107], v[244:247], 0
    v_mul_f32 v224, s60, v80
    v_mul_f32 v225, s60, v81
    v_mul_f32 v226, s60, v82
    v_mul_f32 v227, s60, v83
    v_fmac_f32 v176, v64, v48
    v_fmac_f32 v177, v65, v48
    v_fmac_f32 v178, v66, v48
    v_fmac_f32 v179, v67, v48
    v_mul_f32 v232, v176, v224
    v_mul_f32 v233, v177, v225
    v_mul_f32 v234, v178, v226
    v_mul_f32 v235, v179, v227
    v_exp_f32 v232, v232 clamp
    v_max_f32 v176, 0, v176
    v_exp_f32 v233, v233 clamp
    v_max_f32 v177, 0, v177
    v_exp_f32 v234, v234 clamp
    v_max_f32 v178, 0, v178
    v_exp_f32 v235, v235 clamp
    v_max_f32 v179, 0, v179
    v_fmac_f32 v232, v176, v80
    v_fmac_f32 v233, v177, v81
    v_fmac_f32 v234, v178, v82
    v_fmac_f32 v235, v179, v83
    v_add_f32 v232, s68, v232
    v_add_f32 v233, s68, v233
    v_add_f32 v234, s68, v234
    v_add_f32 v235, s68, v235
    v_cvt_pk_bf16_f32 v92, v232, v233
    v_cvt_pk_bf16_f32 v93, v234, v235
    v_fmac_f32 v180, v64, v49
    v_fmac_f32 v181, v65, v49
    v_fmac_f32 v182, v66, v49
    v_fmac_f32 v183, v67, v49
    v_mul_f32 v236, v180, v224
    v_mul_f32 v237, v181, v225
    v_mul_f32 v238, v182, v226
    v_mul_f32 v239, v183, v227
    v_exp_f32 v236, v236 clamp
    v_max_f32 v180, 0, v180
    v_exp_f32 v237, v237 clamp
    v_max_f32 v181, 0, v181
    v_exp_f32 v238, v238 clamp
    v_max_f32 v182, 0, v182
    v_exp_f32 v239, v239 clamp
    v_max_f32 v183, 0, v183
    v_fmac_f32 v236, v180, v80
    v_fmac_f32 v237, v181, v81
    v_fmac_f32 v238, v182, v82
    v_fmac_f32 v239, v183, v83
    v_add_f32 v236, s68, v236
    v_add_f32 v237, s68, v237
    v_add_f32 v238, s68, v238
    v_add_f32 v239, s68, v239
    v_cvt_pk_bf16_f32 v100, v236, v237
    v_cvt_pk_bf16_f32 v101, v238, v239
    v_fmac_f32 v184, v64, v50
    v_fmac_f32 v185, v65, v50
    v_fmac_f32 v186, v66, v50
    v_fmac_f32 v187, v67, v50
    v_mul_f32 v240, v184, v80
    v_mul_f32 v241, v185, v81
    v_mul_f32 v242, v186, v82
    v_mul_f32 v243, v187, v83
    v_mul_f32 v232, v184, v224
    v_mul_f32 v233, v185, v225
    v_mul_f32 v234, v186, v226
    v_mul_f32 v235, v187, v227
    v_exp_f32 v232, v232 clamp
    v_max_f32 v184, 0, v184
    v_exp_f32 v233, v233 clamp
    v_max_f32 v185, 0, v185
    v_exp_f32 v234, v234 clamp
    v_max_f32 v186, 0, v186
    v_exp_f32 v235, v235 clamp
    v_max_f32 v187, 0, v187
    v_fmac_f32 v232, v184, v80
    v_fmac_f32 v233, v185, v81
    v_fmac_f32 v234, v186, v82
    v_fmac_f32 v235, v187, v83
    v_add_f32 v232, s68, v232
    v_add_f32 v233, s68, v233
    v_add_f32 v234, s68, v234
    v_add_f32 v235, s68, v235
    v_cndmask_b32 v232, v232, v240, s[74:75]
    v_cndmask_b32 v233, v233, v241, s[74:75]
    v_cndmask_b32 v234, v234, v242, s[74:75]
    v_cndmask_b32 v235, v235, v243, s[74:75]
    v_cvt_pk_bf16_f32 v108, v232, v233
    v_cvt_pk_bf16_f32 v109, v234, v235
    v_fmac_f32 v188, v64, v51
    v_fmac_f32 v189, v65, v51
    v_fmac_f32 v190, v66, v51
    v_fmac_f32 v191, v67, v51
    v_mul_f32 v188, v188, v80
    v_mul_f32 v189, v189, v81
    v_mul_f32 v190, v190, v82
    v_mul_f32 v191, v191, v83
    v_cvt_pk_bf16_f32 v116, v188, v189
    v_cvt_pk_bf16_f32 v117, v190, v191
    v_fmac_f32 v192, v64, v52
    v_fmac_f32 v193, v65, v52
    v_fmac_f32 v194, v66, v52
    v_fmac_f32 v195, v67, v52
    v_mul_f32 v192, v192, v80
    v_mul_f32 v193, v193, v81
    v_mul_f32 v194, v194, v82
    v_mul_f32 v195, v195, v83
    v_cvt_pk_bf16_f32 v124, v192, v193
    v_cvt_pk_bf16_f32 v125, v194, v195
    v_mul_f32 v228, s60, v84
    v_mul_f32 v229, s60, v85
    v_mul_f32 v230, s60, v86
    v_mul_f32 v231, s60, v87
    v_fmac_f32 v200, v68, v48
    v_fmac_f32 v201, v69, v48
    v_fmac_f32 v202, v70, v48
    v_fmac_f32 v203, v71, v48
    v_mul_f32 v232, v200, v228
    v_mul_f32 v233, v201, v229
    v_mul_f32 v234, v202, v230
    v_mul_f32 v235, v203, v231
    v_exp_f32 v232, v232 clamp
    v_max_f32 v200, 0, v200
    v_exp_f32 v233, v233 clamp
    v_max_f32 v201, 0, v201
    v_exp_f32 v234, v234 clamp
    v_max_f32 v202, 0, v202
    v_exp_f32 v235, v235 clamp
    v_max_f32 v203, 0, v203
    v_fmac_f32 v232, v200, v84
    v_fmac_f32 v233, v201, v85
    v_fmac_f32 v234, v202, v86
    v_fmac_f32 v235, v203, v87
    v_add_f32 v232, s68, v232
    v_add_f32 v233, s68, v233
    v_add_f32 v234, s68, v234
    v_add_f32 v235, s68, v235
    v_cvt_pk_bf16_f32 v94, v232, v233
    v_cvt_pk_bf16_f32 v95, v234, v235
    v_fmac_f32 v204, v68, v49
    v_fmac_f32 v205, v69, v49
    v_fmac_f32 v206, v70, v49
    v_fmac_f32 v207, v71, v49
    v_mul_f32 v236, v204, v228
    v_mul_f32 v237, v205, v229
    v_mul_f32 v238, v206, v230
    v_mul_f32 v239, v207, v231
    v_exp_f32 v236, v236 clamp
    v_max_f32 v204, 0, v204
    v_exp_f32 v237, v237 clamp
    v_max_f32 v205, 0, v205
    v_exp_f32 v238, v238 clamp
    v_max_f32 v206, 0, v206
    v_exp_f32 v239, v239 clamp
    v_max_f32 v207, 0, v207
    v_fmac_f32 v236, v204, v84
    v_fmac_f32 v237, v205, v85
    v_fmac_f32 v238, v206, v86
    v_fmac_f32 v239, v207, v87
    v_add_f32 v236, s68, v236
    v_add_f32 v237, s68, v237
    v_add_f32 v238, s68, v238
    v_add_f32 v239, s68, v239
    v_cvt_pk_bf16_f32 v102, v236, v237
    v_cvt_pk_bf16_f32 v103, v238, v239
    v_fmac_f32 v208, v68, v50
    v_fmac_f32 v209, v69, v50
    v_fmac_f32 v210, v70, v50
    v_fmac_f32 v211, v71, v50
    v_mul_f32 v240, v208, v84
    v_mul_f32 v241, v209, v85
    v_mul_f32 v242, v210, v86
    v_mul_f32 v243, v211, v87
    v_mul_f32 v232, v208, v228
    v_mul_f32 v233, v209, v229
    v_mul_f32 v234, v210, v230
    v_mul_f32 v235, v211, v231
    v_exp_f32 v232, v232 clamp
    v_max_f32 v208, 0, v208
    v_exp_f32 v233, v233 clamp
    v_max_f32 v209, 0, v209
    v_exp_f32 v234, v234 clamp
    v_max_f32 v210, 0, v210
    v_exp_f32 v235, v235 clamp
    v_max_f32 v211, 0, v211
    v_fmac_f32 v232, v208, v84
    v_fmac_f32 v233, v209, v85
    v_fmac_f32 v234, v210, v86
    v_fmac_f32 v235, v211, v87
    v_add_f32 v232, s68, v232
    v_add_f32 v233, s68, v233
    v_add_f32 v234, s68, v234
    v_add_f32 v235, s68, v235
    v_cndmask_b32 v232, v232, v240, s[74:75]
    v_cndmask_b32 v233, v233, v241, s[74:75]
    v_cndmask_b32 v234, v234, v242, s[74:75]
    v_cndmask_b32 v235, v235, v243, s[74:75]
    v_cvt_pk_bf16_f32 v110, v232, v233
    v_cvt_pk_bf16_f32 v111, v234, v235
    v_fmac_f32 v212, v68, v51
    v_fmac_f32 v213, v69, v51
    v_fmac_f32 v214, v70, v51
    v_fmac_f32 v215, v71, v51
    v_mul_f32 v212, v212, v84
    v_mul_f32 v213, v213, v85
    v_mul_f32 v214, v214, v86
    v_mul_f32 v215, v215, v87
    v_cvt_pk_bf16_f32 v118, v212, v213
    v_cvt_pk_bf16_f32 v119, v214, v215
    v_fmac_f32 v216, v68, v52
    v_fmac_f32 v217, v69, v52
    v_fmac_f32 v218, v70, v52
    v_fmac_f32 v219, v71, v52
    v_mul_f32 v216, v216, v84
    v_mul_f32 v217, v217, v85
    v_mul_f32 v218, v218, v86
    v_mul_f32 v219, v219, v87
    v_cvt_pk_bf16_f32 v126, v216, v217
    v_cvt_pk_bf16_f32 v127, v218, v219
    v_mfma_f32_16x16x32_bf16 v[128:131], v[92:95], v[116:119], v[128:131]
    s_nop 0
    v_mfma_f32_16x16x32_bf16 v[132:135], v[92:95], v[124:127], v[132:135]
    v_mfma_f32_16x16x32_bf16 v[136:139], v[100:103], v[116:119], v[136:139]
    v_mfma_f32_16x16x32_bf16 v[140:143], v[100:103], v[124:127], v[140:143]
    v_mfma_f32_16x16x32_bf16 v[144:147], v[100:103], v[108:111], v[144:147]
    v_mfma_f32_16x16x32_bf16 v[152:155], v[108:111], v[124:127], v[152:155]
    v_mfma_f32_16x16x32_bf16 v[156:159], v[108:111], v[108:111], v[156:159]
    v_mfma_f32_16x16x32_bf16 v[160:163], v[92:95], v[244:247], v[160:163]
    v_mfma_f32_16x16x32_bf16 v[164:167], v[100:103], v[244:247], v[164:167]
    v_mfma_f32_16x16x32_bf16 v[168:171], v[108:111], v[244:247], v[168:171]
    s_lshl_b32 s60, s41, 2
    s_add_u32 s60, s60, s47
    s_mul_i32 s60, s60, 13440
    s_add_u32 s60, s60, 15728640
    s_add_u32 s62, s60, 8192
    ds_write_b128 v148, v[128:131]
    ds_write_b128 v149, v[132:135]
    ds_write_b128 v150, v[136:139]
    ds_write_b128 v151, v[140:143]
    ds_write_b128 v172, v[144:147]
    ds_write_b128 v173, v[152:155]
    ds_write_b128 v174, v[156:159]
    ds_write_b128 v175, v[160:163]
    ds_write_b128 v196, v[164:167]
    ds_write_b128 v197, v[168:171]
    s_waitcnt lgkmcnt(0)
    s_barrier
    v_lshlrev_b32 v2, 4, v0
    v_add_u32 v3, 122880, v2
    ds_read_b128 v[224:227], v3
    ds_read_b128 v[228:231], v3 offset:13568
    ds_read_b128 v[232:235], v3 offset:8192
    ds_read_b128 v[236:239], v3 offset:21760
    s_waitcnt lgkmcnt(2)
    v_add_f32 v224, v224, v228
    v_add_f32 v225, v225, v229
    v_add_f32 v226, v226, v230
    v_add_f32 v227, v227, v231
    buffer_store_dwordx4 v[224:227], v2, s[12:15], s60 offen sc1
    s_waitcnt lgkmcnt(0)
    v_add_f32 v232, v232, v236
    v_add_f32 v233, v233, v237
    v_add_f32 v234, v234, v238
    v_add_f32 v235, v235, v239
    v_cmp_gt_u32 vcc, 328, v0
    s_nop 0
    s_and_saveexec_b64 s[60:61], vcc
    s_cbranch_execz L_KV_end
    buffer_store_dwordx4 v[232:235], v2, s[12:15], s62 offen sc1
L_KV_end:
    s_mov_b64 exec, -1
    s_lshl_b32 s82, s47, 7
    s_lshl_b32 s61, s41, 3
    s_add_u32 s82, s82, s61
    s_add_u32 s82, s82, 16920576
    s_branch L_pub
L_helper:
    s_mov_b32 s73, 0xffff0000
    v_lshrrev_b32 v2, 4, v1
    v_and_b32 v3, 15, v1
    s_lshl_b32 s60, s41, 7
    s_lshl_b32 s61, s40, 4
    s_add_u32 s60, s60, s61
    v_add_u32 v4, s60, v2
    v_mul_u32_u24 v5, 1280, v4
    v_lshl_add_u32 v5, v3, 4, v5
    v_lshlrev_b32 v4, 3, v4
    v_add_u32 v4, 15204352, v4
    s_mul_i32 s60, s40, 320
    v_add_u32 v6, s60, v1
    v_mul_u32_u24 v7, 3277, v6
    v_lshrrev_b32 v10, 18, v7
    v_mul_u32_u24 v7, 80, v10
    v_sub_u32 v7, v6, v7
    v_and_b32 v8, 7, v10
    v_lshlrev_b32 v8, 1, v8
    v_xor_b32 v7, v7, v8
    v_lshlrev_b32 v15, 4, v7
    v_mul_u32_u24 v7, 1280, v10
    v_add_u32 v20, v7, v15
    v_add_u32 v6, s60, v1
    v_add_u32 v6, 64, v6
    v_mul_u32_u24 v7, 3277, v6
    v_lshrrev_b32 v11, 18, v7
    v_mul_u32_u24 v7, 80, v11
    v_sub_u32 v7, v6, v7
    v_and_b32 v8, 7, v11
    v_lshlrev_b32 v8, 1, v8
    v_xor_b32 v7, v7, v8
    v_lshlrev_b32 v16, 4, v7
    v_mul_u32_u24 v7, 1280, v11
    v_add_u32 v21, v7, v16
    v_add_u32 v6, s60, v1
    v_add_u32 v6, 128, v6
    v_mul_u32_u24 v7, 3277, v6
    v_lshrrev_b32 v12, 18, v7
    v_mul_u32_u24 v7, 80, v12
    v_sub_u32 v7, v6, v7
    v_and_b32 v8, 7, v12
    v_lshlrev_b32 v8, 1, v8
    v_xor_b32 v7, v7, v8
    v_lshlrev_b32 v17, 4, v7
    v_mul_u32_u24 v7, 1280, v12
    v_add_u32 v22, v7, v17
    v_add_u32 v6, s60, v1
    v_add_u32 v6, 192, v6
    v_mul_u32_u24 v7, 3277, v6
    v_lshrrev_b32 v13, 18, v7
    v_mul_u32_u24 v7, 80, v13
    v_sub_u32 v7, v6, v7
    v_and_b32 v8, 7, v13
    v_lshlrev_b32 v8, 1, v8
    v_xor_b32 v7, v7, v8
    v_lshlrev_b32 v18, 4, v7
    v_mul_u32_u24 v7, 1280, v13
    v_add_u32 v23, v7, v18
    v_add_u32 v6, s60, v1
    v_add_u32 v6, 256, v6
    v_mul_u32_u24 v7, 3277, v6
    v_lshrrev_b32 v14, 18, v7
    v_mul_u32_u24 v7, 80, v14
    v_sub_u32 v7, v6, v7
    v_and_b32 v8, 7, v14
    v_lshlrev_b32 v8, 1, v8
    v_xor_b32 v7, v7, v8
    v_lshlrev_b32 v19, 4, v7
    v_mul_u32_u24 v7, 1280, v14
    v_add_u32 v24, v7, v19
    v_lshrrev_b32 v6, 2, v1
    v_and_b32 v7, 7, v6
    v_mul_u32_u24 v8, 1280, v6
    v_and_b32 v9, 3, v1
    v_lshl_add_u32 v8, v9, 3, v8
    s_mul_i32 s60, s40, 5
    s_add_u32 s61, s60, 0
    v_xor_b32 v9, s61, v7
    v_lshl_add_u32 v30, v9, 5, v8
    s_add_u32 s61, s60, 1
    v_xor_b32 v9, s61, v7
    v_lshl_add_u32 v31, v9, 5, v8
    s_add_u32 s61, s60, 2
    v_xor_b32 v9, s61, v7
    v_lshl_add_u32 v32, v9, 5, v8
    s_add_u32 s61, s60, 3
    v_xor_b32 v9, s61, v7
    v_lshl_add_u32 v33, v9, 5, v8
    s_add_u32 s61, s60, 4
    v_xor_b32 v9, s61, v7
    v_lshl_add_u32 v34, v9, 5, v8
    v_lshlrev_b32 v35, 4, v1
    s_mul_i32 s48, s40, 5120
    s_mul_i32 s49, s40, 378880
    s_add_u32 s49, s49, 10485760
    s_waitcnt lgkmcnt(0)
    s_mov_b32 s4, s20
    s_and_b32 s5, s21, 0xffff
    s_mov_b32 s6, 0x280000
    s_mov_b32 s7, 0x20000
    s_mov_b32 s12, s38
    s_and_b32 s13, s39, 0xffff
    s_mov_b32 s14, 0x1100000
    s_mov_b32 s15, 0x20000
    s_cmp_lg_u32 s40, 7
    s_cbranch_scc1 L_h_ep
    s_not_b64 s[78:79], s[76:77]
    s_mov_b64 exec, 1
    v_mov_b32 v42, s78
    v_mov_b32 v43, s79
    v_mov_b32 v44, 0
    global_atomic_umax_x2 v44, v[42:43], s[36:37] sc1
    s_mov_b64 exec, -1
L_h_ep:
    s_mov_b32 s8, s32
    s_and_b32 s9, s33, 0xffff
    s_mov_b32 s10, 0x21c000
    s_mov_b32 s11, 0x20000
    s_mov_b32 s68, s24
    s_and_b32 s69, s25, 0xffff
    s_mov_b32 s70, 0xc8000
    s_mov_b32 s71, 0x20000
    s_mov_b32 s60, 0
    buffer_load_dwordx4 v[64:67], v5, s[4:7], s60 offen offset:0
    buffer_load_dwordx4 v[68:71], v5, s[4:7], s60 offen offset:256
    buffer_load_dwordx4 v[72:75], v5, s[4:7], s60 offen offset:512
    buffer_load_dwordx4 v[76:79], v5, s[4:7], s60 offen offset:768
    buffer_load_dwordx4 v[80:83], v5, s[4:7], s60 offen offset:1024
    s_mov_b32 s60, 5120
    buffer_load_dwordx4 v[84:87], v5, s[4:7], s60 offen offset:0
    buffer_load_dwordx4 v[88:91], v5, s[4:7], s60 offen offset:256
    buffer_load_dwordx4 v[92:95], v5, s[4:7], s60 offen offset:512
    buffer_load_dwordx4 v[96:99], v5, s[4:7], s60 offen offset:768
    buffer_load_dwordx4 v[100:103], v5, s[4:7], s60 offen offset:1024
    s_mov_b32 s60, 10240
    buffer_load_dwordx4 v[104:107], v5, s[4:7], s60 offen offset:0
    buffer_load_dwordx4 v[108:111], v5, s[4:7], s60 offen offset:256
    buffer_load_dwordx4 v[112:115], v5, s[4:7], s60 offen offset:512
    buffer_load_dwordx4 v[116:119], v5, s[4:7], s60 offen offset:768
    buffer_load_dwordx4 v[120:123], v5, s[4:7], s60 offen offset:1024
    s_mov_b32 s60, 15360
    buffer_load_dwordx4 v[124:127], v5, s[4:7], s60 offen offset:0
    buffer_load_dwordx4 v[128:131], v5, s[4:7], s60 offen offset:256
    buffer_load_dwordx4 v[132:135], v5, s[4:7], s60 offen offset:512
    buffer_load_dwordx4 v[136:139], v5, s[4:7], s60 offen offset:768
    buffer_load_dwordx4 v[140:143], v5, s[4:7], s60 offen offset:1024
    s_add_u32 s63, s41, 0
    s_lshr_b32 s64, s63, 1
    s_mul_i32 s62, s64, 3
    s_and_b32 s65, s63, 1
    s_lshl_b32 s65, s65, 1
    s_add_u32 s62, s62, s65
    s_sub_u32 s63, s63, 36
    s_mul_i32 s63, s63, 3
    s_add_u32 s63, s63, 1
    s_cmp_ge_u32 s64, 18
    s_cselect_b32 s62, s63, s62
    s_mul_i32 s60, s62, 40960
    s_add_u32 m0, s48, 0
    s_nop 0
    buffer_load_dwordx4 v20, s[8:11], s60 offen lds
    s_add_u32 m0, s48, 1024
    s_nop 0
    buffer_load_dwordx4 v21, s[8:11], s60 offen lds
    s_add_u32 m0, s48, 2048
    s_nop 0
    buffer_load_dwordx4 v22, s[8:11], s60 offen lds
    s_add_u32 m0, s48, 3072
    s_nop 0
    buffer_load_dwordx4 v23, s[8:11], s60 offen lds
    s_add_u32 m0, s48, 4096
    s_nop 0
    buffer_load_dwordx4 v24, s[8:11], s60 offen lds
    s_add_u32 s63, s41, 16
    s_lshr_b32 s64, s63, 1
    s_mul_i32 s62, s64, 3
    s_and_b32 s65, s63, 1
    s_lshl_b32 s65, s65, 1
    s_add_u32 s62, s62, s65
    s_sub_u32 s63, s63, 36
    s_mul_i32 s63, s63, 3
    s_add_u32 s63, s63, 1
    s_cmp_ge_u32 s64, 18
    s_cselect_b32 s62, s63, s62
    s_mul_i32 s60, s62, 40960
    s_add_u32 m0, s48, 40960
    s_nop 0
    buffer_load_dwordx4 v20, s[8:11], s60 offen lds
    s_add_u32 m0, s48, 41984
    s_nop 0
    buffer_load_dwordx4 v21, s[8:11], s60 offen lds
    s_add_u32 m0, s48, 43008
    s_nop 0
    buffer_load_dwordx4 v22, s[8:11], s60 offen lds
    s_add_u32 m0, s48, 44032
    s_nop 0
    buffer_load_dwordx4 v23, s[8:11], s60 offen lds
    s_add_u32 m0, s48, 45056
    s_nop 0
    buffer_load_dwordx4 v24, s[8:11], s60 offen lds
    s_add_u32 s63, s41, 32
    s_lshr_b32 s64, s63, 1
    s_mul_i32 s62, s64, 3
    s_and_b32 s65, s63, 1
    s_lshl_b32 s65, s65, 1
    s_add_u32 s62, s62, s65
    s_sub_u32 s63, s63, 36
    s_mul_i32 s63, s63, 3
    s_add_u32 s63, s63, 1
    s_cmp_ge_u32 s64, 18
    s_cselect_b32 s62, s63, s62
    s_mul_i32 s60, s62, 40960
    s_add_u32 m0, s48, 81920
    s_nop 0
    buffer_load_dwordx4 v20, s[8:11], s60 offen lds
    s_add_u32 m0, s48, 82944
    s_nop 0
    buffer_load_dwordx4 v21, s[8:11], s60 offen lds
    s_add_u32 m0, s48, 83968
    s_nop 0
    buffer_load_dwordx4 v22, s[8:11], s60 offen lds
    s_add_u32 m0, s48, 84992
    s_nop 0
    buffer_load_dwordx4 v23, s[8:11], s60 offen lds
    s_add_u32 m0, s48, 86016
    s_nop 0
    buffer_load_dwordx4 v24, s[8:11], s60 offen lds
    v_mov_b32 v40, 0x3f803f80
    s_mov_b32 s63, 0x3acccccd
    s_mov_b32 s64, 0x3727c5ac
    s_waitcnt vmcnt(15)
    v_mov_b32 v44, 0
    v_mov_b32 v48, 0
    v_dot2_f32_bf16 v44, v64, v40, v44
    v_dot2_f32_bf16 v48, v64, v64, v48
    v_dot2_f32_bf16 v44, v65, v40, v44
    v_dot2_f32_bf16 v48, v65, v65, v48
    v_dot2_f32_bf16 v44, v66, v40, v44
    v_dot2_f32_bf16 v48, v66, v66, v48
    v_dot2_f32_bf16 v44, v67, v40, v44
    v_dot2_f32_bf16 v48, v67, v67, v48
    v_dot2_f32_bf16 v44, v68, v40, v44
    v_dot2_f32_bf16 v48, v68, v68, v48
    v_dot2_f32_bf16 v44, v69, v40, v44
    v_dot2_f32_bf16 v48, v69, v69, v48
    v_dot2_f32_bf16 v44, v70, v40, v44
    v_dot2_f32_bf16 v48, v70, v70, v48
    v_dot2_f32_bf16 v44, v71, v40, v44
    v_dot2_f32_bf16 v48, v71, v71, v48
    v_dot2_f32_bf16 v44, v72, v40, v44
    v_dot2_f32_bf16 v48, v72, v72, v48
    v_dot2_f32_bf16 v44, v73, v40, v44
    v_dot2_f32_bf16 v48, v73, v73, v48
    v_dot2_f32_bf16 v44, v74, v40, v44
    v_dot2_f32_bf16 v48, v74, v74, v48
    v_dot2_f32_bf16 v44, v75, v40, v44
    v_dot2_f32_bf16 v48, v75, v75, v48
    v_dot2_f32_bf16 v44, v76, v40, v44
    v_dot2_f32_bf16 v48, v76, v76, v48
    v_dot2_f32_bf16 v44, v77, v40, v44
    v_dot2_f32_bf16 v48, v77, v77, v48
    v_dot2_f32_bf16 v44, v78, v40, v44
    v_dot2_f32_bf16 v48, v78, v78, v48
    v_dot2_f32_bf16 v44, v79, v40, v44
    v_dot2_f32_bf16 v48, v79, v79, v48
    v_dot2_f32_bf16 v44, v80, v40, v44
    v_dot2_f32_bf16 v48, v80, v80, v48
    v_dot2_f32_bf16 v44, v81, v40, v44
    v_dot2_f32_bf16 v48, v81, v81, v48
    v_dot2_f32_bf16 v44, v82, v40, v44
    v_dot2_f32_bf16 v48, v82, v82, v48
    v_dot2_f32_bf16 v44, v83, v40, v44
    v_dot2_f32_bf16 v48, v83, v83, v48
    v_mov_b32 v45, 0
    v_mov_b32 v49, 0
    v_dot2_f32_bf16 v45, v84, v40, v45
    v_dot2_f32_bf16 v49, v84, v84, v49
    v_dot2_f32_bf16 v45, v85, v40, v45
    v_dot2_f32_bf16 v49, v85, v85, v49
    v_dot2_f32_bf16 v45, v86, v40, v45
    v_dot2_f32_bf16 v49, v86, v86, v49
    v_dot2_f32_bf16 v45, v87, v40, v45
    v_dot2_f32_bf16 v49, v87, v87, v49
    v_dot2_f32_bf16 v45, v88, v40, v45
    v_dot2_f32_bf16 v49, v88, v88, v49
    v_dot2_f32_bf16 v45, v89, v40, v45
    v_dot2_f32_bf16 v49, v89, v89, v49
    v_dot2_f32_bf16 v45, v90, v40, v45
    v_dot2_f32_bf16 v49, v90, v90, v49
    v_dot2_f32_bf16 v45, v91, v40, v45
    v_dot2_f32_bf16 v49, v91, v91, v49
    v_dot2_f32_bf16 v45, v92, v40, v45
    v_dot2_f32_bf16 v49, v92, v92, v49
    v_dot2_f32_bf16 v45, v93, v40, v45
    v_dot2_f32_bf16 v49, v93, v93, v49
    v_dot2_f32_bf16 v45, v94, v40, v45
    v_dot2_f32_bf16 v49, v94, v94, v49
    v_dot2_f32_bf16 v45, v95, v40, v45
    v_dot2_f32_bf16 v49, v95, v95, v49
    v_dot2_f32_bf16 v45, v96, v40, v45
    v_dot2_f32_bf16 v49, v96, v96, v49
    v_dot2_f32_bf16 v45, v97, v40, v45
    v_dot2_f32_bf16 v49, v97, v97, v49
    v_dot2_f32_bf16 v45, v98, v40, v45
    v_dot2_f32_bf16 v49, v98, v98, v49
    v_dot2_f32_bf16 v45, v99, v40, v45
    v_dot2_f32_bf16 v49, v99, v99, v49
    v_dot2_f32_bf16 v45, v100, v40, v45
    v_dot2_f32_bf16 v49, v100, v100, v49
    v_dot2_f32_bf16 v45, v101, v40, v45
    v_dot2_f32_bf16 v49, v101, v101, v49
    v_dot2_f32_bf16 v45, v102, v40, v45
    v_dot2_f32_bf16 v49, v102, v102, v49
    v_dot2_f32_bf16 v45, v103, v40, v45
    v_dot2_f32_bf16 v49, v103, v103, v49
    v_mov_b32 v46, 0
    v_mov_b32 v50, 0
    v_dot2_f32_bf16 v46, v104, v40, v46
    v_dot2_f32_bf16 v50, v104, v104, v50
    v_dot2_f32_bf16 v46, v105, v40, v46
    v_dot2_f32_bf16 v50, v105, v105, v50
    v_dot2_f32_bf16 v46, v106, v40, v46
    v_dot2_f32_bf16 v50, v106, v106, v50
    v_dot2_f32_bf16 v46, v107, v40, v46
    v_dot2_f32_bf16 v50, v107, v107, v50
    v_dot2_f32_bf16 v46, v108, v40, v46
    v_dot2_f32_bf16 v50, v108, v108, v50
    v_dot2_f32_bf16 v46, v109, v40, v46
    v_dot2_f32_bf16 v50, v109, v109, v50
    v_dot2_f32_bf16 v46, v110, v40, v46
    v_dot2_f32_bf16 v50, v110, v110, v50
    v_dot2_f32_bf16 v46, v111, v40, v46
    v_dot2_f32_bf16 v50, v111, v111, v50
    v_dot2_f32_bf16 v46, v112, v40, v46
    v_dot2_f32_bf16 v50, v112, v112, v50
    v_dot2_f32_bf16 v46, v113, v40, v46
    v_dot2_f32_bf16 v50, v113, v113, v50
    v_dot2_f32_bf16 v46, v114, v40, v46
    v_dot2_f32_bf16 v50, v114, v114, v50
    v_dot2_f32_bf16 v46, v115, v40, v46
    v_dot2_f32_bf16 v50, v115, v115, v50
    v_dot2_f32_bf16 v46, v116, v40, v46
    v_dot2_f32_bf16 v50, v116, v116, v50
    v_dot2_f32_bf16 v46, v117, v40, v46
    v_dot2_f32_bf16 v50, v117, v117, v50
    v_dot2_f32_bf16 v46, v118, v40, v46
    v_dot2_f32_bf16 v50, v118, v118, v50
    v_dot2_f32_bf16 v46, v119, v40, v46
    v_dot2_f32_bf16 v50, v119, v119, v50
    v_dot2_f32_bf16 v46, v120, v40, v46
    v_dot2_f32_bf16 v50, v120, v120, v50
    v_dot2_f32_bf16 v46, v121, v40, v46
    v_dot2_f32_bf16 v50, v121, v121, v50
    v_dot2_f32_bf16 v46, v122, v40, v46
    v_dot2_f32_bf16 v50, v122, v122, v50
    v_dot2_f32_bf16 v46, v123, v40, v46
    v_dot2_f32_bf16 v50, v123, v123, v50
    v_mov_b32 v47, 0
    v_mov_b32 v51, 0
    v_dot2_f32_bf16 v47, v124, v40, v47
    v_dot2_f32_bf16 v51, v124, v124, v51
    v_dot2_f32_bf16 v47, v125, v40, v47
    v_dot2_f32_bf16 v51, v125, v125, v51
    v_dot2_f32_bf16 v47, v126, v40, v47
    v_dot2_f32_bf16 v51, v126, v126, v51
    v_dot2_f32_bf16 v47, v127, v40, v47
    v_dot2_f32_bf16 v51, v127, v127, v51
    v_dot2_f32_bf16 v47, v128, v40, v47
    v_dot2_f32_bf16 v51, v128, v128, v51
    v_dot2_f32_bf16 v47, v129, v40, v47
    v_dot2_f32_bf16 v51, v129, v129, v51
    v_dot2_f32_bf16 v47, v130, v40, v47
    v_dot2_f32_bf16 v51, v130, v130, v51
    v_dot2_f32_bf16 v47, v131, v40, v47
    v_dot2_f32_bf16 v51, v131, v131, v51
    v_dot2_f32_bf16 v47, v132, v40, v47
    v_dot2_f32_bf16 v51, v132, v132, v51
    v_dot2_f32_bf16 v47, v133, v40, v47
    v_dot2_f32_bf16 v51, v133, v133, v51
    v_dot2_f32_bf16 v47, v134, v40, v47
    v_dot2_f32_bf16 v51, v134, v134, v51
    v_dot2_f32_bf16 v47, v135, v40, v47
    v_dot2_f32_bf16 v51, v135, v135, v51
    v_dot2_f32_bf16 v47, v136, v40, v47
    v_dot2_f32_bf16 v51, v136, v136, v51
    v_dot2_f32_bf16 v47, v137, v40, v47
    v_dot2_f32_bf16 v51, v137, v137, v51
    v_dot2_f32_bf16 v47, v138, v40, v47
    v_dot2_f32_bf16 v51, v138, v138, v51
    v_dot2_f32_bf16 v47, v139, v40, v47
    v_dot2_f32_bf16 v51, v139, v139, v51
    v_dot2_f32_bf16 v47, v140, v40, v47
    v_dot2_f32_bf16 v51, v140, v140, v51
    v_dot2_f32_bf16 v47, v141, v40, v47
    v_dot2_f32_bf16 v51, v141, v141, v51
    v_dot2_f32_bf16 v47, v142, v40, v47
    v_dot2_f32_bf16 v51, v142, v142, v51
    v_dot2_f32_bf16 v47, v143, v40, v47
    v_dot2_f32_bf16 v51, v143, v143, v51
    v_add_f32_dpp v44, v44, v44 row_ror:8 row_mask:0xf bank_mask:0xf
    v_add_f32_dpp v45, v45, v45 row_ror:8 row_mask:0xf bank_mask:0xf
    v_add_f32_dpp v46, v46, v46 row_ror:8 row_mask:0xf bank_mask:0xf
    v_add_f32_dpp v47, v47, v47 row_ror:8 row_mask:0xf bank_mask:0xf
    v_add_f32_dpp v48, v48, v48 row_ror:8 row_mask:0xf bank_mask:0xf
    v_add_f32_dpp v49, v49, v49 row_ror:8 row_mask:0xf bank_mask:0xf
    v_add_f32_dpp v50, v50, v50 row_ror:8 row_mask:0xf bank_mask:0xf
    v_add_f32_dpp v51, v51, v51 row_ror:8 row_mask:0xf bank_mask:0xf
    v_add_f32_dpp v44, v44, v44 row_ror:4 row_mask:0xf bank_mask:0xf
    v_add_f32_dpp v45, v45, v45 row_ror:4 row_mask:0xf bank_mask:0xf
    v_add_f32_dpp v46, v46, v46 row_ror:4 row_mask:0xf bank_mask:0xf
    v_add_f32_dpp v47, v47, v47 row_ror:4 row_mask:0xf bank_mask:0xf
    v_add_f32_dpp v48, v48, v48 row_ror:4 row_mask:0xf bank_mask:0xf
    v_add_f32_dpp v49, v49, v49 row_ror:4 row_mask:0xf bank_mask:0xf
    v_add_f32_dpp v50, v50, v50 row_ror:4 row_mask:0xf bank_mask:0xf
    v_add_f32_dpp v51, v51, v51 row_ror:4 row_mask:0xf bank_mask:0xf
    v_add_f32_dpp v44, v44, v44 row_ror:2 row_mask:0xf bank_mask:0xf
    v_add_f32_dpp v45, v45, v45 row_ror:2 row_mask:0xf bank_mask:0xf
    v_add_f32_dpp v46, v46, v46 row_ror:2 row_mask:0xf bank_mask:0xf
    v_add_f32_dpp v47, v47, v47 row_ror:2 row_mask:0xf bank_mask:0xf
    v_add_f32_dpp v48, v48, v48 row_ror:2 row_mask:0xf bank_mask:0xf
    v_add_f32_dpp v49, v49, v49 row_ror:2 row_mask:0xf bank_mask:0xf
    v_add_f32_dpp v50, v50, v50 row_ror:2 row_mask:0xf bank_mask:0xf
    v_add_f32_dpp v51, v51, v51 row_ror:2 row_mask:0xf bank_mask:0xf
    v_add_f32_dpp v44, v44, v44 row_ror:1 row_mask:0xf bank_mask:0xf
    v_add_f32_dpp v45, v45, v45 row_ror:1 row_mask:0xf bank_mask:0xf
    v_add_f32_dpp v46, v46, v46 row_ror:1 row_mask:0xf bank_mask:0xf
    v_add_f32_dpp v47, v47, v47 row_ror:1 row_mask:0xf bank_mask:0xf
    v_add_f32_dpp v48, v48, v48 row_ror:1 row_mask:0xf bank_mask:0xf
    v_add_f32_dpp v49, v49, v49 row_ror:1 row_mask:0xf bank_mask:0xf
    v_add_f32_dpp v50, v50, v50 row_ror:1 row_mask:0xf bank_mask:0xf
    v_add_f32_dpp v51, v51, v51 row_ror:1 row_mask:0xf bank_mask:0xf
    v_mul_f32 v52, s63, v44
    v_mul_f32 v48, s63, v48
    v_fma_f32 v48, -v52, v52, v48
    v_max_f32 v48, 0, v48
    v_cvt_pk_bf16_f32 v52, v52, v52
    v_and_b32 v52, s73, v52
    v_cvt_pk_bf16_f32 v48, v48, v48
    v_and_b32 v48, s73, v48
    v_add_f32 v48, s64, v48
    v_cvt_pk_bf16_f32 v48, v48, v48
    v_and_b32 v48, s73, v48
    v_sqrt_f32 v48, v48
    s_nop 0
    v_cvt_pk_bf16_f32 v48, v48, v48
    v_and_b32 v48, s73, v48
    v_rcp_f32 v53, v48
    v_xor_b32 v52, 0x80000000, v52
    v_mul_f32 v54, s63, v45
    v_mul_f32 v49, s63, v49
    v_fma_f32 v49, -v54, v54, v49
    v_max_f32 v49, 0, v49
    v_cvt_pk_bf16_f32 v54, v54, v54
    v_and_b32 v54, s73, v54
    v_cvt_pk_bf16_f32 v49, v49, v49
    v_and_b32 v49, s73, v49
    v_add_f32 v49, s64, v49
    v_cvt_pk_bf16_f32 v49, v49, v49
    v_and_b32 v49, s73, v49
    v_sqrt_f32 v49, v49
    s_nop 0
    v_cvt_pk_bf16_f32 v49, v49, v49
    v_and_b32 v49, s73, v49
    v_rcp_f32 v55, v49
    v_xor_b32 v54, 0x80000000, v54
    v_mul_f32 v56, s63, v46
    v_mul_f32 v50, s63, v50
    v_fma_f32 v50, -v56, v56, v50
    v_max_f32 v50, 0, v50
    v_cvt_pk_bf16_f32 v56, v56, v56
    v_and_b32 v56, s73, v56
    v_cvt_pk_bf16_f32 v50, v50, v50
    v_and_b32 v50, s73, v50
    v_add_f32 v50, s64, v50
    v_cvt_pk_bf16_f32 v50, v50, v50
    v_and_b32 v50, s73, v50
    v_sqrt_f32 v50, v50
    s_nop 0
    v_cvt_pk_bf16_f32 v50, v50, v50
    v_and_b32 v50, s73, v50
    v_rcp_f32 v57, v50
    v_xor_b32 v56, 0x80000000, v56
    v_mul_f32 v58, s63, v47
    v_mul_f32 v51, s63, v51
    v_fma_f32 v51, -v58, v58, v51
    v_max_f32 v51, 0, v51
    v_cvt_pk_bf16_f32 v58, v58, v58
    v_and_b32 v58, s73, v58
    v_cvt_pk_bf16_f32 v51, v51, v51
    v_and_b32 v51, s73, v51
    v_add_f32 v51, s64, v51
    v_cvt_pk_bf16_f32 v51, v51, v51
    v_and_b32 v51, s73, v51
    v_sqrt_f32 v51, v51
    s_nop 0
    v_cvt_pk_bf16_f32 v51, v51, v51
    v_and_b32 v51, s73, v51
    v_rcp_f32 v59, v51
    v_xor_b32 v58, 0x80000000, v58
    v_cmp_eq_u32 vcc, 0, v3
    s_nop 0
    s_and_saveexec_b64 s[60:61], vcc
    buffer_store_dwordx2 v[52:53], v4, s[12:15], 0 offen offset:0 sc1
    buffer_store_dwordx2 v[54:55], v4, s[12:15], 0 offen offset:32 sc1
    buffer_store_dwordx2 v[56:57], v4, s[12:15], 0 offen offset:64 sc1
    buffer_store_dwordx2 v[58:59], v4, s[12:15], 0 offen offset:96 sc1
    s_mov_b64 exec, s[60:61]
    s_waitcnt vmcnt(0)
    s_barrier
    s_cmp_lg_u32 s40, 0
    s_cbranch_scc1 L_h_nf
    s_lshl_b32 s60, s41, 3
    s_add_u32 s60, s60, 16910336
    v_mov_b32 v43, s60
    s_memrealtime s[78:79]
    s_mov_b64 exec, 1
    s_waitcnt lgkmcnt(0)
    v_mov_b32 v40, s78
    v_mov_b32 v41, s79
    buffer_store_dwordx2 v[40:41], v43, s[12:15], 0 offen offset:0 sc1
    s_mov_b64 exec, -1
L_h_nf:
    s_waitcnt lgkmcnt(0)
    s_mul_i32 s65, s41, 5120
    s_add_u32 s65, s65, s49
    v_add_u32 v44, 0, v30
    v_add_u32 v45, 0, v31
    v_add_u32 v46, 0, v32
    v_add_u32 v47, 0, v33
    v_add_u32 v48, 0, v34
    ds_read_b64_tr_b16 v[64:65], v44
    ds_read_b64_tr_b16 v[66:67], v44 offset:20480
    ds_read_b64_tr_b16 v[68:69], v45
    ds_read_b64_tr_b16 v[70:71], v45 offset:20480
    ds_read_b64_tr_b16 v[72:73], v46
    ds_read_b64_tr_b16 v[74:75], v46 offset:20480
    ds_read_b64_tr_b16 v[76:77], v47
    ds_read_b64_tr_b16 v[78:79], v47 offset:20480
    ds_read_b64_tr_b16 v[80:81], v48
    ds_read_b64_tr_b16 v[82:83], v48 offset:20480
    s_waitcnt lgkmcnt(8)
    buffer_store_dwordx4 v[64:67], v35, s[12:15], s65 offen offset:0 sc1
    s_waitcnt lgkmcnt(6)
    buffer_store_dwordx4 v[68:71], v35, s[12:15], s65 offen offset:1024 sc1
    s_waitcnt lgkmcnt(4)
    buffer_store_dwordx4 v[72:75], v35, s[12:15], s65 offen offset:2048 sc1
    s_waitcnt lgkmcnt(2)
    buffer_store_dwordx4 v[76:79], v35, s[12:15], s65 offen offset:3072 sc1
    s_waitcnt lgkmcnt(0)
    s_add_u32 s61, s65, 4096
    buffer_store_dwordx4 v[80:83], v35, s[12:15], s61 offen sc1
    s_add_u32 s65, s65, 81920
    v_add_u32 v44, 40960, v30
    v_add_u32 v45, 40960, v31
    v_add_u32 v46, 40960, v32
    v_add_u32 v47, 40960, v33
    v_add_u32 v48, 40960, v34
    ds_read_b64_tr_b16 v[84:85], v44
    ds_read_b64_tr_b16 v[86:87], v44 offset:20480
    ds_read_b64_tr_b16 v[88:89], v45
    ds_read_b64_tr_b16 v[90:91], v45 offset:20480
    ds_read_b64_tr_b16 v[92:93], v46
    ds_read_b64_tr_b16 v[94:95], v46 offset:20480
    ds_read_b64_tr_b16 v[96:97], v47
    ds_read_b64_tr_b16 v[98:99], v47 offset:20480
    ds_read_b64_tr_b16 v[100:101], v48
    ds_read_b64_tr_b16 v[102:103], v48 offset:20480
    s_waitcnt lgkmcnt(8)
    buffer_store_dwordx4 v[84:87], v35, s[12:15], s65 offen offset:0 sc1
    s_waitcnt lgkmcnt(6)
    buffer_store_dwordx4 v[88:91], v35, s[12:15], s65 offen offset:1024 sc1
    s_waitcnt lgkmcnt(4)
    buffer_store_dwordx4 v[92:95], v35, s[12:15], s65 offen offset:2048 sc1
    s_waitcnt lgkmcnt(2)
    buffer_store_dwordx4 v[96:99], v35, s[12:15], s65 offen offset:3072 sc1
    s_waitcnt lgkmcnt(0)
    s_add_u32 s61, s65, 4096
    buffer_store_dwordx4 v[100:103], v35, s[12:15], s61 offen sc1
    s_lshl_b32 s60, s41, 3
    s_add_u32 s60, s60, 16922880
    v_mov_b32 v43, s60
    s_waitcnt vmcnt(0)
    s_barrier
    s_cmp_lg_u32 s40, 0
    s_cbranch_scc1 L_h_nf1
    s_memrealtime s[78:79]
    s_mov_b64 exec, 1
    s_waitcnt lgkmcnt(0)
    v_mov_b32 v40, s78
    v_mov_b32 v41, s79
    buffer_store_dwordx2 v[40:41], v43, s[12:15], 0 offen offset:0 sc1
    s_mov_b64 exec, -1
L_h_nf1:
    s_add_u32 s72, s65, 81920
    s_add_u32 s62, s41, 48
    s_cmp_ge_u32 s62, 74
    s_cbranch_scc1 L_h_skip3
    s_cmp_ge_u32 s62, 54
    s_cbranch_scc1 L_h_wo3
    s_add_u32 s63, s41, 48
    s_lshr_b32 s64, s63, 1
    s_mul_i32 s62, s64, 3
    s_and_b32 s65, s63, 1
    s_lshl_b32 s65, s65, 1
    s_add_u32 s62, s62, s65
    s_sub_u32 s63, s63, 36
    s_mul_i32 s63, s63, 3
    s_add_u32 s63, s63, 1
    s_cmp_ge_u32 s64, 18
    s_cselect_b32 s62, s63, s62
    s_mul_i32 s60, s62, 40960
    s_add_u32 m0, s48, 0
    s_nop 0
    buffer_load_dwordx4 v20, s[8:11], s60 offen lds
    s_add_u32 m0, s48, 1024
    s_nop 0
    buffer_load_dwordx4 v21, s[8:11], s60 offen lds
    s_add_u32 m0, s48, 2048
    s_nop 0
    buffer_load_dwordx4 v22, s[8:11], s60 offen lds
    s_add_u32 m0, s48, 3072
    s_nop 0
    buffer_load_dwordx4 v23, s[8:11], s60 offen lds
    s_add_u32 m0, s48, 4096
    s_nop 0
    buffer_load_dwordx4 v24, s[8:11], s60 offen lds
    s_branch L_h_skip3
L_h_wo3:
    s_and_b32 s63, s62, 1
    s_sub_u32 s62, s62, 54
    s_lshr_b32 s62, s62, 1
    s_cmp_ge_u32 s62, 5
    s_cselect_b32 s64, 1, 0
    s_mul_i32 s65, s64, 5
    s_sub_u32 s65, s62, s65
    s_lshl_b32 s63, s63, 1
    s_add_u32 s63, s63, s64
    s_mul_i32 s63, s63, 204800
    s_lshl_b32 s65, s65, 3
    v_bfe_u32 v6, v10, 2, 2
    v_lshrrev_b32 v7, 4, v10
    v_and_b32 v8, 3, v10
    v_lshl_add_u32 v7, v7, 2, v8
    v_add_u32 v7, s65, v7
    v_mul_u32_u24 v8, 52, v7
    v_lshrrev_b32 v8, 8, v8
    v_mul_u32_u24 v9, 5, v8
    v_sub_u32 v7, v7, v9
    v_mul_u32_u24 v9, 3, v6
    v_lshl_add_u32 v6, v6, 1, 9
    v_cmp_gt_u32 vcc, 3, v7
    s_nop 1
    v_cndmask_b32 v6, v6, v9, vcc
    v_mul_u32_u24 v8, 20, v8
    v_add3_u32 v7, v7, v8, v6
    v_mul_u32_u24 v7, 1280, v7
    v_add_u32 v25, v7, v15
    v_bfe_u32 v6, v11, 2, 2
    v_lshrrev_b32 v7, 4, v11
    v_and_b32 v8, 3, v11
    v_lshl_add_u32 v7, v7, 2, v8
    v_add_u32 v7, s65, v7
    v_mul_u32_u24 v8, 52, v7
    v_lshrrev_b32 v8, 8, v8
    v_mul_u32_u24 v9, 5, v8
    v_sub_u32 v7, v7, v9
    v_mul_u32_u24 v9, 3, v6
    v_lshl_add_u32 v6, v6, 1, 9
    v_cmp_gt_u32 vcc, 3, v7
    s_nop 1
    v_cndmask_b32 v6, v6, v9, vcc
    v_mul_u32_u24 v8, 20, v8
    v_add3_u32 v7, v7, v8, v6
    v_mul_u32_u24 v7, 1280, v7
    v_add_u32 v26, v7, v16
    v_bfe_u32 v6, v12, 2, 2
    v_lshrrev_b32 v7, 4, v12
    v_and_b32 v8, 3, v12
    v_lshl_add_u32 v7, v7, 2, v8
    v_add_u32 v7, s65, v7
    v_mul_u32_u24 v8, 52, v7
    v_lshrrev_b32 v8, 8, v8
    v_mul_u32_u24 v9, 5, v8
    v_sub_u32 v7, v7, v9
    v_mul_u32_u24 v9, 3, v6
    v_lshl_add_u32 v6, v6, 1, 9
    v_cmp_gt_u32 vcc, 3, v7
    s_nop 1
    v_cndmask_b32 v6, v6, v9, vcc
    v_mul_u32_u24 v8, 20, v8
    v_add3_u32 v7, v7, v8, v6
    v_mul_u32_u24 v7, 1280, v7
    v_add_u32 v27, v7, v17
    v_bfe_u32 v6, v13, 2, 2
    v_lshrrev_b32 v7, 4, v13
    v_and_b32 v8, 3, v13
    v_lshl_add_u32 v7, v7, 2, v8
    v_add_u32 v7, s65, v7
    v_mul_u32_u24 v8, 52, v7
    v_lshrrev_b32 v8, 8, v8
    v_mul_u32_u24 v9, 5, v8
    v_sub_u32 v7, v7, v9
    v_mul_u32_u24 v9, 3, v6
    v_lshl_add_u32 v6, v6, 1, 9
    v_cmp_gt_u32 vcc, 3, v7
    s_nop 1
    v_cndmask_b32 v6, v6, v9, vcc
    v_mul_u32_u24 v8, 20, v8
    v_add3_u32 v7, v7, v8, v6
    v_mul_u32_u24 v7, 1280, v7
    v_add_u32 v28, v7, v18
    v_bfe_u32 v6, v14, 2, 2
    v_lshrrev_b32 v7, 4, v14
    v_and_b32 v8, 3, v14
    v_lshl_add_u32 v7, v7, 2, v8
    v_add_u32 v7, s65, v7
    v_mul_u32_u24 v8, 52, v7
    v_lshrrev_b32 v8, 8, v8
    v_mul_u32_u24 v9, 5, v8
    v_sub_u32 v7, v7, v9
    v_mul_u32_u24 v9, 3, v6
    v_lshl_add_u32 v6, v6, 1, 9
    v_cmp_gt_u32 vcc, 3, v7
    s_nop 1
    v_cndmask_b32 v6, v6, v9, vcc
    v_mul_u32_u24 v8, 20, v8
    v_add3_u32 v7, v7, v8, v6
    v_mul_u32_u24 v7, 1280, v7
    v_add_u32 v29, v7, v19
    s_add_u32 m0, s48, 0
    s_nop 0
    buffer_load_dwordx4 v25, s[68:71], s63 offen lds
    s_add_u32 m0, s48, 1024
    s_nop 0
    buffer_load_dwordx4 v26, s[68:71], s63 offen lds
    s_add_u32 m0, s48, 2048
    s_nop 0
    buffer_load_dwordx4 v27, s[68:71], s63 offen lds
    s_add_u32 m0, s48, 3072
    s_nop 0
    buffer_load_dwordx4 v28, s[68:71], s63 offen lds
    s_add_u32 m0, s48, 4096
    s_nop 0
    buffer_load_dwordx4 v29, s[68:71], s63 offen lds
L_h_skip3:
    s_add_u32 s62, s41, 64
    s_cmp_ge_u32 s62, 74
    s_cbranch_scc1 L_h_skip4
    s_cmp_ge_u32 s62, 54
    s_cbranch_scc1 L_h_wo4
    s_add_u32 s63, s41, 64
    s_lshr_b32 s64, s63, 1
    s_mul_i32 s62, s64, 3
    s_and_b32 s65, s63, 1
    s_lshl_b32 s65, s65, 1
    s_add_u32 s62, s62, s65
    s_sub_u32 s63, s63, 36
    s_mul_i32 s63, s63, 3
    s_add_u32 s63, s63, 1
    s_cmp_ge_u32 s64, 18
    s_cselect_b32 s62, s63, s62
    s_mul_i32 s60, s62, 40960
    s_add_u32 m0, s48, 40960
    s_nop 0
    buffer_load_dwordx4 v20, s[8:11], s60 offen lds
    s_add_u32 m0, s48, 41984
    s_nop 0
    buffer_load_dwordx4 v21, s[8:11], s60 offen lds
    s_add_u32 m0, s48, 43008
    s_nop 0
    buffer_load_dwordx4 v22, s[8:11], s60 offen lds
    s_add_u32 m0, s48, 44032
    s_nop 0
    buffer_load_dwordx4 v23, s[8:11], s60 offen lds
    s_add_u32 m0, s48, 45056
    s_nop 0
    buffer_load_dwordx4 v24, s[8:11], s60 offen lds
    s_branch L_h_skip4
L_h_wo4:
    s_and_b32 s63, s62, 1
    s_sub_u32 s62, s62, 54
    s_lshr_b32 s62, s62, 1
    s_cmp_ge_u32 s62, 5
    s_cselect_b32 s64, 1, 0
    s_mul_i32 s65, s64, 5
    s_sub_u32 s65, s62, s65
    s_lshl_b32 s63, s63, 1
    s_add_u32 s63, s63, s64
    s_mul_i32 s63, s63, 204800
    s_lshl_b32 s65, s65, 3
    v_bfe_u32 v6, v10, 2, 2
    v_lshrrev_b32 v7, 4, v10
    v_and_b32 v8, 3, v10
    v_lshl_add_u32 v7, v7, 2, v8
    v_add_u32 v7, s65, v7
    v_mul_u32_u24 v8, 52, v7
    v_lshrrev_b32 v8, 8, v8
    v_mul_u32_u24 v9, 5, v8
    v_sub_u32 v7, v7, v9
    v_mul_u32_u24 v9, 3, v6
    v_lshl_add_u32 v6, v6, 1, 9
    v_cmp_gt_u32 vcc, 3, v7
    s_nop 1
    v_cndmask_b32 v6, v6, v9, vcc
    v_mul_u32_u24 v8, 20, v8
    v_add3_u32 v7, v7, v8, v6
    v_mul_u32_u24 v7, 1280, v7
    v_add_u32 v25, v7, v15
    v_bfe_u32 v6, v11, 2, 2
    v_lshrrev_b32 v7, 4, v11
    v_and_b32 v8, 3, v11
    v_lshl_add_u32 v7, v7, 2, v8
    v_add_u32 v7, s65, v7
    v_mul_u32_u24 v8, 52, v7
    v_lshrrev_b32 v8, 8, v8
    v_mul_u32_u24 v9, 5, v8
    v_sub_u32 v7, v7, v9
    v_mul_u32_u24 v9, 3, v6
    v_lshl_add_u32 v6, v6, 1, 9
    v_cmp_gt_u32 vcc, 3, v7
    s_nop 1
    v_cndmask_b32 v6, v6, v9, vcc
    v_mul_u32_u24 v8, 20, v8
    v_add3_u32 v7, v7, v8, v6
    v_mul_u32_u24 v7, 1280, v7
    v_add_u32 v26, v7, v16
    v_bfe_u32 v6, v12, 2, 2
    v_lshrrev_b32 v7, 4, v12
    v_and_b32 v8, 3, v12
    v_lshl_add_u32 v7, v7, 2, v8
    v_add_u32 v7, s65, v7
    v_mul_u32_u24 v8, 52, v7
    v_lshrrev_b32 v8, 8, v8
    v_mul_u32_u24 v9, 5, v8
    v_sub_u32 v7, v7, v9
    v_mul_u32_u24 v9, 3, v6
    v_lshl_add_u32 v6, v6, 1, 9
    v_cmp_gt_u32 vcc, 3, v7
    s_nop 1
    v_cndmask_b32 v6, v6, v9, vcc
    v_mul_u32_u24 v8, 20, v8
    v_add3_u32 v7, v7, v8, v6
    v_mul_u32_u24 v7, 1280, v7
    v_add_u32 v27, v7, v17
    v_bfe_u32 v6, v13, 2, 2
    v_lshrrev_b32 v7, 4, v13
    v_and_b32 v8, 3, v13
    v_lshl_add_u32 v7, v7, 2, v8
    v_add_u32 v7, s65, v7
    v_mul_u32_u24 v8, 52, v7
    v_lshrrev_b32 v8, 8, v8
    v_mul_u32_u24 v9, 5, v8
    v_sub_u32 v7, v7, v9
    v_mul_u32_u24 v9, 3, v6
    v_lshl_add_u32 v6, v6, 1, 9
    v_cmp_gt_u32 vcc, 3, v7
    s_nop 1
    v_cndmask_b32 v6, v6, v9, vcc
    v_mul_u32_u24 v8, 20, v8
    v_add3_u32 v7, v7, v8, v6
    v_mul_u32_u24 v7, 1280, v7
    v_add_u32 v28, v7, v18
    v_bfe_u32 v6, v14, 2, 2
    v_lshrrev_b32 v7, 4, v14
    v_and_b32 v8, 3, v14
    v_lshl_add_u32 v7, v7, 2, v8
    v_add_u32 v7, s65, v7
    v_mul_u32_u24 v8, 52, v7
    v_lshrrev_b32 v8, 8, v8
    v_mul_u32_u24 v9, 5, v8
    v_sub_u32 v7, v7, v9
    v_mul_u32_u24 v9, 3, v6
    v_lshl_add_u32 v6, v6, 1, 9
    v_cmp_gt_u32 vcc, 3, v7
    s_nop 1
    v_cndmask_b32 v6, v6, v9, vcc
    v_mul_u32_u24 v8, 20, v8
    v_add3_u32 v7, v7, v8, v6
    v_mul_u32_u24 v7, 1280, v7
    v_add_u32 v29, v7, v19
    s_add_u32 m0, s48, 40960
    s_nop 0
    buffer_load_dwordx4 v25, s[68:71], s63 offen lds
    s_add_u32 m0, s48, 41984
    s_nop 0
    buffer_load_dwordx4 v26, s[68:71], s63 offen lds
    s_add_u32 m0, s48, 43008
    s_nop 0
    buffer_load_dwordx4 v27, s[68:71], s63 offen lds
    s_add_u32 m0, s48, 44032
    s_nop 0
    buffer_load_dwordx4 v28, s[68:71], s63 offen lds
    s_add_u32 m0, s48, 45056
    s_nop 0
    buffer_load_dwordx4 v29, s[68:71], s63 offen lds
L_h_skip4:
    s_waitcnt lgkmcnt(0)
    v_add_u32 v44, 81920, v30
    v_add_u32 v45, 81920, v31
    v_add_u32 v46, 81920, v32
    v_add_u32 v47, 81920, v33
    v_add_u32 v48, 81920, v34
    ds_read_b64_tr_b16 v[64:65], v44
    ds_read_b64_tr_b16 v[66:67], v44 offset:20480
    ds_read_b64_tr_b16 v[68:69], v45
    ds_read_b64_tr_b16 v[70:71], v45 offset:20480
    ds_read_b64_tr_b16 v[72:73], v46
    ds_read_b64_tr_b16 v[74:75], v46 offset:20480
    ds_read_b64_tr_b16 v[76:77], v47
    ds_read_b64_tr_b16 v[78:79], v47 offset:20480
    ds_read_b64_tr_b16 v[80:81], v48
    ds_read_b64_tr_b16 v[82:83], v48 offset:20480
    s_waitcnt lgkmcnt(8)
    buffer_store_dwordx4 v[64:67], v35, s[12:15], s72 offen offset:0 sc1
    s_waitcnt lgkmcnt(6)
    buffer_store_dwordx4 v[68:71], v35, s[12:15], s72 offen offset:1024 sc1
    s_waitcnt lgkmcnt(4)
    buffer_store_dwordx4 v[72:75], v35, s[12:15], s72 offen offset:2048 sc1
    s_waitcnt lgkmcnt(2)
    buffer_store_dwordx4 v[76:79], v35, s[12:15], s72 offen offset:3072 sc1
    s_waitcnt lgkmcnt(0)
    s_add_u32 s61, s72, 4096
    buffer_store_dwordx4 v[80:83], v35, s[12:15], s61 offen sc1
    s_add_u32 s66, s72, 81920
    s_add_u32 s67, s66, 81920
    s_waitcnt vmcnt(0)
    s_barrier
    s_waitcnt lgkmcnt(0)
    v_add_u32 v44, 0, v30
    v_add_u32 v45, 0, v31
    v_add_u32 v46, 0, v32
    v_add_u32 v47, 0, v33
    v_add_u32 v48, 0, v34
    ds_read_b64_tr_b16 v[64:65], v44
    ds_read_b64_tr_b16 v[66:67], v44 offset:20480
    ds_read_b64_tr_b16 v[68:69], v45
    ds_read_b64_tr_b16 v[70:71], v45 offset:20480
    ds_read_b64_tr_b16 v[72:73], v46
    ds_read_b64_tr_b16 v[74:75], v46 offset:20480
    ds_read_b64_tr_b16 v[76:77], v47
    ds_read_b64_tr_b16 v[78:79], v47 offset:20480
    ds_read_b64_tr_b16 v[80:81], v48
    ds_read_b64_tr_b16 v[82:83], v48 offset:20480
    s_waitcnt lgkmcnt(8)
    buffer_store_dwordx4 v[64:67], v35, s[12:15], s66 offen offset:0 sc1
    s_waitcnt lgkmcnt(6)
    buffer_store_dwordx4 v[68:71], v35, s[12:15], s66 offen offset:1024 sc1
    s_waitcnt lgkmcnt(4)
    buffer_store_dwordx4 v[72:75], v35, s[12:15], s66 offen offset:2048 sc1
    s_waitcnt lgkmcnt(2)
    buffer_store_dwordx4 v[76:79], v35, s[12:15], s66 offen offset:3072 sc1
    s_waitcnt lgkmcnt(0)
    s_add_u32 s61, s66, 4096
    buffer_store_dwordx4 v[80:83], v35, s[12:15], s61 offen sc1
    s_cmp_ge_u32 s41, 10
    s_cbranch_scc1 L_h_end
    v_add_u32 v44, 40960, v30
    v_add_u32 v45, 40960, v31
    v_add_u32 v46, 40960, v32
    v_add_u32 v47, 40960, v33
    v_add_u32 v48, 40960, v34
    ds_read_b64_tr_b16 v[84:85], v44
    ds_read_b64_tr_b16 v[86:87], v44 offset:20480
    ds_read_b64_tr_b16 v[88:89], v45
    ds_read_b64_tr_b16 v[90:91], v45 offset:20480
    ds_read_b64_tr_b16 v[92:93], v46
    ds_read_b64_tr_b16 v[94:95], v46 offset:20480
    ds_read_b64_tr_b16 v[96:97], v47
    ds_read_b64_tr_b16 v[98:99], v47 offset:20480
    ds_read_b64_tr_b16 v[100:101], v48
    ds_read_b64_tr_b16 v[102:103], v48 offset:20480
    s_waitcnt lgkmcnt(8)
    buffer_store_dwordx4 v[84:87], v35, s[12:15], s67 offen offset:0 sc1
    s_waitcnt lgkmcnt(6)
    buffer_store_dwordx4 v[88:91], v35, s[12:15], s67 offen offset:1024 sc1
    s_waitcnt lgkmcnt(4)
    buffer_store_dwordx4 v[92:95], v35, s[12:15], s67 offen offset:2048 sc1
    s_waitcnt lgkmcnt(2)
    buffer_store_dwordx4 v[96:99], v35, s[12:15], s67 offen offset:3072 sc1
    s_waitcnt lgkmcnt(0)
    s_add_u32 s61, s67, 4096
    buffer_store_dwordx4 v[100:103], v35, s[12:15], s61 offen sc1
L_h_end:
    s_sub_u32 s76, s76, 200
    s_subb_u32 s77, s77, 0
    v_lshlrev_b32 v21, 4, v1
    s_lshl_b32 s60, s41, 3
    s_add_u32 s82, s60, 16924672
    s_add_u32 s61, s60, 16922624
    v_mov_b32 v36, s61
    s_mov_b32 s83, 1
    s_waitcnt vmcnt(0)
    s_barrier
    s_cmp_lg_u32 s40, 0
    s_cbranch_scc1 L_pub
    s_memrealtime s[78:79]
    s_mov_b64 exec, 1
    s_waitcnt lgkmcnt(0)
    v_mov_b32 v40, s78
    v_mov_b32 v41, s79
    buffer_store_dwordx2 v[40:41], v36, s[12:15], 0 offen offset:0 sc1
    s_mov_b64 exec, -1
    s_branch L_pub
L_k1_exit:
    s_endpgm
L_pub:
    s_and_b32 s60, s2, 7
    s_lshr_b32 s61, s2, 3
    s_and_b32 s62, s60, 3
    s_lshl_b32 s62, s62, 3
    s_and_b32 s41, s61, 7
    s_add_u32 s41, s41, s62
    s_lshr_b32 s60, s60, 2
    s_lshl_b32 s60, s60, 2
    s_lshr_b32 s42, s61, 3
    s_add_u32 s42, s42, s60
    s_mov_b32 s60, 16922624
    v_lshl_add_u32 v29, v1, 3, s60
    s_lshr_b32 s60, s41, 1
    s_lshl_b32 s60, s60, 7
    s_add_u32 s60, s60, 16916352
    v_lshl_add_u32 v2, v1, 3, s60
    v_cmp_le_u32 vcc, 16, v1
    s_nop 1
    v_cndmask_b32 v29, v29, v2, vcc
    s_and_b32 s60, s2, 7
    s_lshl_b32 s60, s60, 9
    s_add_u32 s60, s60, 16928768
    v_lshl_add_u32 v38, v1, 3, s60
    s_cmp_lg_u32 s40, 0
    s_cbranch_scc1 L_p2_a
    s_mov_b64 exec, 0xffff
    buffer_load_dwordx2 v[40:41], v29, s[12:15], 0 offen offset:0 sc1
    s_mov_b64 exec, -1
L_p2_a:
    s_and_b32 s43, s40, 3
    s_lshr_b32 s44, s40, 2
    v_lshlrev_b32 v10, 4, v1
    v_lshlrev_b32 v11, 3, v1
    s_lshl_b32 s45, s40, 10
    s_mul_i32 s50, s41, 303104
    s_add_u32 s50, s50, s45
    s_mov_b32 s8, s34
    s_and_b32 s9, s35, 0xffff
    s_mov_b32 s10, 0x280000
    s_mov_b32 s11, 0x20000
    v_mov_b32 v28, s82
    v_and_b32 v3, 15, v1
    s_mul_i32 s61, s44, 5120
    v_add_u32 v12, s61, v10
    v_add_u32 v13, 61440, v12
    v_add_u32 v18, 122880, v12
    v_lshrrev_b32 v4, 2, v3
    v_and_b32 v5, 3, v3
    v_mul_u32_u24 v6, 3, v4
    v_add_u32 v6, v6, v5
    v_cmp_gt_u32 vcc, 3, v5
    s_nop 1
    v_cndmask_b32 v7, 12, v6, vcc
    v_lshl_add_u32 v6, v4, 1, v5
    v_add_u32 v6, 13, v6
    v_cmp_gt_u32 vcc, 2, v5
    s_nop 1
    v_cndmask_b32 v8, 12, v6, vcc
    v_lshrrev_b32 v9, 4, v1
    v_lshlrev_b32 v4, 3, v9
    s_mul_i32 s61, s44, 16128
    s_add_u32 s61, s61, 122880
    v_mul_u32_u24 v7, 48, v7
    v_mul_u32_u24 v8, 48, v8
    v_add3_u32 v19, v7, v4, s61
    v_add3_u32 v20, v8, v4, s61
    v_cmp_eq_u32 vcc, 0, v9
    s_nop 1
    v_cndmask_b32 v5, 40, 32, vcc
    v_add3_u32 v30, v7, v5, s61
    v_add3_u32 v34, v8, v5, s61
    v_cmp_eq_u32 vcc, 1, v9
    s_nop 1
    v_cndmask_b32 v5, 40, 32, vcc
    v_add3_u32 v31, v7, v5, s61
    v_add3_u32 v35, v8, v5, s61
    v_cmp_eq_u32 vcc, 2, v9
    s_nop 1
    v_cndmask_b32 v5, 40, 32, vcc
    v_add3_u32 v32, v7, v5, s61
    v_add3_u32 v36, v8, v5, s61
    v_cmp_eq_u32 vcc, 3, v9
    s_nop 1
    v_cndmask_b32 v5, 40, 32, vcc
    v_add3_u32 v33, v7, v5, s61
    v_add3_u32 v37, v8, v5, s61
    s_lshl_b32 s60, s41, 6
    s_lshl_b32 s61, s43, 4
    s_add_u32 s60, s60, s61
    v_add_u32 v4, s60, v3
    v_mul_u32_u24 v4, 1280, v4
    v_lshl_add_u32 v4, v9, 3, v4
    s_mul_i32 s60, s42, 160
    s_mul_i32 s61, s44, 96
    s_add_u32 s60, s60, s61
    v_add_u32 v23, s60, v4
    v_lshlrev_b32 v25, 4, v0
    v_add_u32 v26, 122880, v25
    v_add_u32 v25, 16777216, v25
    s_mov_b32 s68, 0x358637bd
    v_mov_b32 v39, v38
    v_mov_b32 v15, v38
    v_mov_b32 v16, v38
    v_mov_b32 v17, v38
    s_and_b32 s60, s2, 3
    s_xor_b32 s61, s40, 7
    s_or_b32 s60, s60, s61
    s_cmp_eq_u32 s60, 0
    s_cselect_b32 s72, 1, 0
    s_cbranch_scc0 L_p2_r0
    s_lshr_b32 s60, s2, 3
    s_bfe_u32 s61, s2, 0x10002
    s_mul_i32 s62, s61, 55
    v_add_u32 v2, s62, v1
    s_mul_i32 s63, s60, 1680
    s_add_u32 s63, s63, 15728640
    v_lshl_add_u32 v15, v2, 4, s63
    v_mul_u32_u24 v3, 52, v2
    v_lshrrev_b32 v3, 8, v3
    v_mul_u32_u24 v4, 5, v3
    v_cmp_gt_u32 vcc, v4, v2
    s_nop 1
    v_subbrev_co_u32 v3, vcc, 0, v3, vcc
    v_mul_u32_u24 v4, 5, v3
    v_sub_u32 v4, v2, v4
    v_add_u32 v5, 1, v3
    v_cmp_le_u32 vcc, 12, v3
    s_nop 1
    v_cndmask_b32 v5, v3, v5, vcc
    v_cmp_eq_u32 vcc, 20, v3
    s_nop 1
    v_cndmask_b32 v5, v5, 12, vcc
    v_mul_u32_u24 v5, 48, v5
    s_mul_i32 s63, s60, 1008
    s_add_u32 s63, s63, 16777216
    v_lshl_add_u32 v5, v4, 3, v5
    v_add_u32 v16, s63, v5
    s_mul_i32 s62, s61, 5
    s_sub_u32 s62, 55, s62
    v_cmp_gt_u32 s[56:57], s62, v1
    v_cmp_eq_u32 s[58:59], 4, v4
    s_nop 0
    s_and_b64 s[58:59], s[58:59], s[56:57]
    s_lshr_b32 s60, s60, 3
    s_lshl_b32 s60, s60, 7
    s_add_u32 s60, s60, 16920576
    v_lshl_add_u32 v17, v1, 3, s60
    s_lshr_b32 s60, s2, 2
    s_lshl_b32 s60, s60, 3
    s_add_u32 s60, s60, 16928768
    v_lshl_add_u32 v39, v1, 9, s60
L_p2_r0:
    s_waitcnt vmcnt(0)
    s_mov_b64 exec, -1
    s_cmp_lg_u32 s40, 0
    s_cbranch_scc1 L_p2_b
    s_mov_b32 s65, 0
L_p2_sp1:
    s_mov_b64 exec, 0xffff
    v_mov_b32 v43, s77
    v_subrev_co_u32 v42, vcc, s76, v40
    s_nop 1
    v_subb_co_u32 v43, vcc, v41, v43, vcc
    v_lshrrev_b32 v42, 30, v42
    v_or_b32 v42, v42, v43
    v_cmp_ne_u32 vcc, 0, v42
    s_mov_b64 exec, -1
    s_cmp_eq_u64 vcc, 0
    s_cbranch_scc1 L_p2_b
    s_add_u32 s65, s65, 1
    s_cmp_ge_u32 s65, 0x400000
    s_cbranch_scc1 L_p2_b
    s_sleep 4
    s_mov_b64 exec, 0xffff
    buffer_load_dwordx2 v[40:41], v29, s[12:15], 0 offen offset:0 sc1
    s_mov_b64 exec, -1
    s_and_b32 s66, s65, 15
    s_cmp_lg_u32 s66, 0
    s_cbranch_scc1 L_p2_sp1_w
    v_mov_b32 v42, 0
    global_load_dwordx2 v[42:43], v42, s[36:37] sc1
    s_waitcnt vmcnt(0)
    v_readfirstlane_b32 s78, v42
    v_readfirstlane_b32 s79, v43
    s_nop 0
    s_cmp_eq_u64 s[78:79], 0
    s_cbranch_scc1 L_p2_sp1_w
    s_not_b64 s[78:79], s[78:79]
    s_sub_u32 s78, s78, 200
    s_subb_u32 s79, s79, 0
    s_sub_u32 s66, s78, s76
    s_subb_u32 s66, s79, s77
    s_cselect_b32 s76, s78, s76
    s_cselect_b32 s77, s79, s77
L_p2_sp1_w:
    s_waitcnt vmcnt(0)
    s_branch L_p2_sp1
L_p2_b:
    s_barrier
    s_cmp_lg_u32 s40, 0
    s_cbranch_scc1 L_p2_c
    s_memrealtime s[78:79]
    s_mov_b64 exec, 1
    s_waitcnt lgkmcnt(0)
    v_mov_b32 v40, s78
    v_mov_b32 v41, s79
    buffer_store_dwordx2 v[40:41], v28, s[12:15], 0 offen offset:0 sc1
    s_mov_b64 exec, -1
L_p2_c:
    s_cmp_lg_u32 s40, 1
    s_cbranch_scc1 L_p2_c2
    s_mov_b64 exec, 0x7ff0000
    buffer_load_dwordx2 v[40:41], v29, s[12:15], 0 offen offset:0 sc1
    s_mov_b64 exec, -1
L_p2_c2:
    s_cmp_eq_u32 s83, 0
    s_cbranch_scc1 L_p2_e0
    s_add_u32 m0, s16, 20480
    s_add_u32 s52, s3, 0
    s_cmp_eq_u32 s19, 0
    buffer_load_dwordx4 v21, s[12:15], s52 offen sc1 lds
    s_cbranch_scc1 L_p2_x37
    s_add_u32 m0, s17, 20480
    s_add_u32 s52, s52, s18
    buffer_load_dwordx4 v21, s[12:15], s52 offen sc1 lds
L_p2_x37:
    s_add_u32 m0, s16, 51200
    s_add_u32 s52, s3, 10240
    s_cmp_eq_u32 s19, 0
    buffer_load_dwordx4 v21, s[12:15], s52 offen sc1 lds
    s_cbranch_scc1 L_p2_x38
    s_add_u32 m0, s17, 51200
    s_add_u32 s52, s52, s18
    buffer_load_dwordx4 v21, s[12:15], s52 offen sc1 lds
L_p2_x38:
    s_add_u32 m0, s16, 61440
    s_add_u32 s52, s3, 20480
    s_cmp_eq_u32 s19, 0
    buffer_load_dwordx4 v21, s[12:15], s52 offen sc1 lds
    s_cbranch_scc1 L_p2_x39
    s_add_u32 m0, s17, 61440
    s_add_u32 s52, s52, s18
    buffer_load_dwordx4 v21, s[12:15], s52 offen sc1 lds
L_p2_x39:
    s_add_u32 m0, s16, 30720
    s_add_u32 s52, s3, 30720
    s_cmp_eq_u32 s19, 0
    buffer_load_dwordx4 v21, s[12:15], s52 offen sc1 lds
    s_cbranch_scc1 L_p2_x40
    s_add_u32 m0, s17, 30720
    s_add_u32 s52, s52, s18
    buffer_load_dwordx4 v21, s[12:15], s52 offen sc1 lds
L_p2_x40:
    s_add_u32 m0, s16, 40960
    s_add_u32 s52, s3, 40960
    s_cmp_eq_u32 s19, 0
    buffer_load_dwordx4 v21, s[12:15], s52 offen sc1 lds
    s_cbranch_scc1 L_p2_x41
    s_add_u32 m0, s17, 40960
    s_add_u32 s52, s52, s18
    buffer_load_dwordx4 v21, s[12:15], s52 offen sc1 lds
L_p2_x41:
    s_add_u32 m0, s16, 71680
    s_add_u32 s52, s3, 51200
    s_cmp_eq_u32 s19, 0
    buffer_load_dwordx4 v21, s[12:15], s52 offen sc1 lds
    s_cbranch_scc1 L_p2_x42
    s_add_u32 m0, s17, 71680
    s_add_u32 s52, s52, s18
    buffer_load_dwordx4 v21, s[12:15], s52 offen sc1 lds
L_p2_x42:
    s_add_u32 m0, s16, 81920
    s_add_u32 s52, s3, 61440
    s_cmp_eq_u32 s19, 0
    buffer_load_dwordx4 v21, s[12:15], s52 offen sc1 lds
    s_cbranch_scc1 L_p2_x43
    s_add_u32 m0, s17, 81920
    s_add_u32 s52, s52, s18
    buffer_load_dwordx4 v21, s[12:15], s52 offen sc1 lds
L_p2_x43:
    s_add_u32 m0, s16, 92160
    s_add_u32 s52, s3, 71680
    s_cmp_eq_u32 s19, 0
    buffer_load_dwordx4 v21, s[12:15], s52 offen sc1 lds
    s_cbranch_scc1 L_p2_x44
    s_add_u32 m0, s17, 92160
    s_add_u32 s52, s52, s18
    buffer_load_dwordx4 v21, s[12:15], s52 offen sc1 lds
L_p2_x44:
    s_add_u32 m0, s16, 102400
    s_add_u32 s52, s3, 81920
    s_cmp_eq_u32 s19, 0
    buffer_load_dwordx4 v21, s[12:15], s52 offen sc1 lds
    s_cbranch_scc1 L_p2_x45
    s_add_u32 m0, s17, 102400
    s_add_u32 s52, s52, s18
    buffer_load_dwordx4 v21, s[12:15], s52 offen sc1 lds
L_p2_x45:
    s_add_u32 m0, s16, 112640
    s_add_u32 s52, s3, 92160
    s_cmp_eq_u32 s19, 0
    buffer_load_dwordx4 v21, s[12:15], s52 offen sc1 lds
    s_cbranch_scc1 L_p2_x46
    s_add_u32 m0, s17, 112640
    s_add_u32 s52, s52, s18
    buffer_load_dwordx4 v21, s[12:15], s52 offen sc1 lds
L_p2_x46:
    s_add_u32 m0, s16, 0
    s_add_u32 s52, s3, 102400
    s_cmp_eq_u32 s19, 0
    buffer_load_dwordx4 v21, s[12:15], s52 offen sc1 lds
    s_cbranch_scc1 L_p2_x47
    s_add_u32 m0, s17, 0
    s_add_u32 s52, s52, s18
    buffer_load_dwordx4 v21, s[12:15], s52 offen sc1 lds
L_p2_x47:
    s_add_u32 m0, s16, 10240
    s_add_u32 s52, s3, 112640
    s_cmp_eq_u32 s19, 0
    buffer_load_dwordx4 v21, s[12:15], s52 offen sc1 lds
    s_cbranch_scc1 L_p2_x48
    s_add_u32 m0, s17, 10240
    s_add_u32 s52, s52, s18
    buffer_load_dwordx4 v21, s[12:15], s52 offen sc1 lds
L_p2_x48:
L_p2_e0:
    s_add_u32 m0, s16, 122880
    s_add_u32 s52, s3, 122880
    s_cmp_eq_u32 s19, 0
    buffer_load_dwordx4 v21, s[12:15], s52 offen sc1 lds
    s_cbranch_scc1 L_p2_x49
    s_add_u32 m0, s17, 122880
    s_add_u32 s52, s52, s18
    buffer_load_dwordx4 v21, s[12:15], s52 offen sc1 lds
L_p2_x49:
    s_cmp_eq_u32 s40, 1
    s_cbranch_scc1 L_p2_e2
    s_cmp_eq_u32 s40, 5
    s_cselect_b32 s19, 1, s19
    s_cselect_b32 s17, 1024, s17
    s_cselect_b32 s18, -4096, s18
    s_add_u32 m0, s16, 133120
    s_add_u32 s52, s3, 133120
    s_cmp_eq_u32 s19, 0
    buffer_load_dwordx4 v21, s[12:15], s52 offen sc1 lds
    s_cbranch_scc1 L_p2_x50
    s_add_u32 m0, s17, 133120
    s_add_u32 s52, s52, s18
    buffer_load_dwordx4 v21, s[12:15], s52 offen sc1 lds
L_p2_x50:
    s_add_u32 m0, s16, 143360
    s_add_u32 s52, s3, 143360
    s_cmp_eq_u32 s19, 0
    buffer_load_dwordx4 v21, s[12:15], s52 offen sc1 lds
    s_cbranch_scc1 L_p2_x51
    s_add_u32 m0, s17, 143360
    s_add_u32 s52, s52, s18
    buffer_load_dwordx4 v21, s[12:15], s52 offen sc1 lds
L_p2_x51:
    s_cmp_eq_u32 s40, 5
    s_cselect_b32 s19, 0, s19
L_p2_e2:
    s_cmp_lg_u32 s40, 1
    s_cbranch_scc1 L_p2_d
    s_waitcnt vmcnt(0)
    s_mov_b32 s65, 0
L_p2_sp2:
    s_mov_b64 exec, 0x7ff0000
    v_mov_b32 v43, s77
    v_subrev_co_u32 v42, vcc, s76, v40
    s_nop 1
    v_subb_co_u32 v43, vcc, v41, v43, vcc
    v_lshrrev_b32 v42, 30, v42
    v_or_b32 v42, v42, v43
    v_cmp_ne_u32 vcc, 0, v42
    s_mov_b64 exec, -1
    s_cmp_eq_u64 vcc, 0
    s_cbranch_scc1 L_p2_d
    s_add_u32 s65, s65, 1
    s_cmp_ge_u32 s65, 0x400000
    s_cbranch_scc1 L_p2_d
    s_mov_b64 exec, 0x7ff0000
    buffer_load_dwordx2 v[40:41], v29, s[12:15], 0 offen offset:0 sc1
    s_mov_b64 exec, -1
    s_and_b32 s66, s65, 15
    s_cmp_lg_u32 s66, 0
    s_cbranch_scc1 L_p2_sp2_w
    v_mov_b32 v42, 0
    global_load_dwordx2 v[42:43], v42, s[36:37] sc1
    s_waitcnt vmcnt(0)
    v_readfirstlane_b32 s78, v42
    v_readfirstlane_b32 s79, v43
    s_nop 0
    s_cmp_eq_u64 s[78:79], 0
    s_cbranch_scc1 L_p2_sp2_w
    s_not_b64 s[78:79], s[78:79]
    s_sub_u32 s78, s78, 200
    s_subb_u32 s79, s79, 0
    s_sub_u32 s66, s78, s76
    s_subb_u32 s66, s79, s77
    s_cselect_b32 s76, s78, s76
    s_cselect_b32 s77, s79, s77
L_p2_sp2_w:
    s_waitcnt vmcnt(0)
    s_branch L_p2_sp2
L_p2_d:
    s_waitcnt vmcnt(2)
    s_barrier
    s_add_u32 s54, s50, 0
    buffer_load_dwordx4 v[144:147], v10, s[12:15], s54 offen sc1
    s_add_u32 s54, s50, 8192
    buffer_load_dwordx4 v[148:151], v10, s[12:15], s54 offen sc1
    s_add_u32 s54, s50, 16384
    buffer_load_dwordx4 v[152:155], v10, s[12:15], s54 offen sc1
    s_add_u32 s54, s50, 24576
    buffer_load_dwordx4 v[156:159], v10, s[12:15], s54 offen sc1
    s_add_u32 s54, s50, 32768
    buffer_load_dwordx4 v[160:163], v10, s[12:15], s54 offen sc1
    ds_read_b128 v[84:87], v12 offset:20480
    ds_read_b128 v[88:91], v12 offset:21504
    ds_read_b128 v[92:95], v12 offset:22528
    ds_read_b128 v[96:99], v12 offset:23552
    ds_read_b128 v[100:103], v12 offset:24576
    s_waitcnt vmcnt(4)
    s_barrier
    s_add_u32 s54, s50, 40960
    buffer_load_dwordx4 v[164:167], v10, s[12:15], s54 offen sc1
    s_waitcnt lgkmcnt(0)
    v_mfma_f32_16x16x32_bf16 v[44:47], v[84:87], v[144:147], 0
    ds_read_b128 v[104:107], v12 offset:51200
    v_mfma_f32_16x16x32_bf16 v[48:51], v[88:91], v[144:147], 0
    ds_read_b128 v[108:111], v12 offset:52224
    v_mfma_f32_16x16x32_bf16 v[52:55], v[92:95], v[144:147], 0
    ds_read_b128 v[112:115], v12 offset:53248
    v_mfma_f32_16x16x32_bf16 v[56:59], v[96:99], v[144:147], 0
    ds_read_b128 v[116:119], v12 offset:54272
    v_mfma_f32_16x16x32_bf16 v[60:63], v[100:103], v[144:147], 0
    ds_read_b128 v[120:123], v12 offset:55296
    s_cmp_eq_u32 s72, 0
    s_cbranch_scc1 L_p2_h0
    s_mov_b64 exec, 0xffff
    buffer_load_dwordx2 v[40:41], v17, s[12:15], 0 offen offset:0 sc1
    s_mov_b64 exec, -1
L_p2_h0:
    s_waitcnt vmcnt(4)
    s_add_u32 s54, s50, 49152
    buffer_load_dwordx4 v[144:147], v10, s[12:15], s54 offen sc1
    s_waitcnt lgkmcnt(0)
    v_mfma_f32_16x16x32_bf16 v[44:47], v[104:107], v[148:151], v[44:47]
    ds_read_b128 v[84:87], v13 offset:0
    v_mfma_f32_16x16x32_bf16 v[48:51], v[108:111], v[148:151], v[48:51]
    ds_read_b128 v[88:91], v13 offset:1024
    v_mfma_f32_16x16x32_bf16 v[52:55], v[112:115], v[148:151], v[52:55]
    ds_read_b128 v[92:95], v13 offset:2048
    v_mfma_f32_16x16x32_bf16 v[56:59], v[116:119], v[148:151], v[56:59]
    ds_read_b128 v[96:99], v13 offset:3072
    v_mfma_f32_16x16x32_bf16 v[60:63], v[120:123], v[148:151], v[60:63]
    ds_read_b128 v[100:103], v13 offset:4096
    s_waitcnt vmcnt(4)
    s_add_u32 s54, s50, 57344
    buffer_load_dwordx4 v[148:151], v10, s[12:15], s54 offen sc1
    s_waitcnt lgkmcnt(0)
    v_mfma_f32_16x16x32_bf16 v[44:47], v[84:87], v[152:155], v[44:47]
    ds_read_b128 v[104:107], v12 offset:30720
    v_mfma_f32_16x16x32_bf16 v[48:51], v[88:91], v[152:155], v[48:51]
    ds_read_b128 v[108:111], v12 offset:31744
    v_mfma_f32_16x16x32_bf16 v[52:55], v[92:95], v[152:155], v[52:55]
    ds_read_b128 v[112:115], v12 offset:32768
    v_mfma_f32_16x16x32_bf16 v[56:59], v[96:99], v[152:155], v[56:59]
    ds_read_b128 v[116:119], v12 offset:33792
    v_mfma_f32_16x16x32_bf16 v[60:63], v[100:103], v[152:155], v[60:63]
    ds_read_b128 v[120:123], v12 offset:34816
    s_waitcnt vmcnt(4)
    s_barrier
    s_cmp_eq_u32 s72, 0
    s_cbranch_scc1 L_p2_r1
    s_waitcnt vmcnt(2)
    s_mov_b32 s65, 0
L_p2_rsp:
    s_mov_b64 exec, 0xffff
    v_mov_b32 v43, s77
    v_subrev_co_u32 v42, vcc, s76, v40
    s_nop 1
    v_subb_co_u32 v43, vcc, v41, v43, vcc
    v_lshrrev_b32 v42, 30, v42
    v_or_b32 v42, v42, v43
    v_cmp_ne_u32 vcc, 0, v42
    s_mov_b64 exec, -1
    s_cmp_eq_u64 vcc, 0
    s_cbranch_scc1 L_p2_r2
    s_add_u32 s65, s65, 1
    s_cmp_ge_u32 s65, 0x400000
    s_cbranch_scc1 L_p2_r2
    s_sleep 4
    s_mov_b64 exec, 0xffff
    buffer_load_dwordx2 v[40:41], v17, s[12:15], 0 offen offset:0 sc1
    s_mov_b64 exec, -1
    s_and_b32 s66, s65, 15
    s_cmp_lg_u32 s66, 0
    s_cbranch_scc1 L_p2_rsp_w
    v_mov_b32 v42, 0
    global_load_dwordx2 v[42:43], v42, s[36:37] sc1
    s_waitcnt vmcnt(0)
    v_readfirstlane_b32 s78, v42
    v_readfirstlane_b32 s79, v43
    s_nop 0
    s_cmp_eq_u64 s[78:79], 0
    s_cbranch_scc1 L_p2_rsp_w
    s_not_b64 s[78:79], s[78:79]
    s_sub_u32 s78, s78, 200
    s_subb_u32 s79, s79, 0
    s_sub_u32 s66, s78, s76
    s_subb_u32 s66, s79, s77
    s_cselect_b32 s76, s78, s76
    s_cselect_b32 s77, s79, s77
L_p2_rsp_w:
    s_waitcnt vmcnt(0)
    s_branch L_p2_rsp
L_p2_r2:
    s_mov_b32 s60, 0
    s_mov_b64 exec, s[56:57]
    buffer_load_dwordx4 v[176:179], v15, s[12:15], s60 offen sc1
    s_add_u32 s60, s60, 53760
    buffer_load_dwordx4 v[180:183], v15, s[12:15], s60 offen sc1
    s_add_u32 s60, s60, 53760
    buffer_load_dwordx4 v[184:187], v15, s[12:15], s60 offen sc1
    s_add_u32 s60, s60, 53760
    buffer_load_dwordx4 v[188:191], v15, s[12:15], s60 offen sc1
    s_add_u32 s60, s60, 53760
    buffer_load_dwordx4 v[192:195], v15, s[12:15], s60 offen sc1
    s_add_u32 s60, s60, 53760
    buffer_load_dwordx4 v[196:199], v15, s[12:15], s60 offen sc1
    s_add_u32 s60, s60, 53760
    buffer_load_dwordx4 v[200:203], v15, s[12:15], s60 offen sc1
    s_add_u32 s60, s60, 53760
    buffer_load_dwordx4 v[204:207], v15, s[12:15], s60 offen sc1
    s_add_u32 s60, s60, 53760
    buffer_load_dwordx4 v[208:211], v15, s[12:15], s60 offen sc1
    s_add_u32 s60, s60, 53760
    buffer_load_dwordx4 v[212:215], v15, s[12:15], s60 offen sc1
    s_add_u32 s60, s60, 53760
    buffer_load_dwordx4 v[216:219], v15, s[12:15], s60 offen sc1
    s_add_u32 s60, s60, 53760
    buffer_load_dwordx4 v[220:223], v15, s[12:15], s60 offen sc1
    s_add_u32 s60, s60, 53760
    buffer_load_dwordx4 v[224:227], v15, s[12:15], s60 offen sc1
    s_add_u32 s60, s60, 53760
    buffer_load_dwordx4 v[228:231], v15, s[12:15], s60 offen sc1
    s_add_u32 s60, s60, 53760
    buffer_load_dwordx4 v[232:235], v15, s[12:15], s60 offen sc1
    s_add_u32 s60, s60, 53760
    buffer_load_dwordx4 v[236:239], v15, s[12:15], s60 offen sc1
    s_add_u32 s60, s60, 53760
    s_mov_b64 exec, -1
L_p2_r1:
    s_add_u32 s54, s50, 65536
    buffer_load_dwordx4 v[152:155], v10, s[12:15], s54 offen sc1
    s_waitcnt lgkmcnt(0)
    v_mfma_f32_16x16x32_bf16 v[44:47], v[104:107], v[156:159], v[44:47]
    ds_read_b128 v[84:87], v12 offset:40960
    v_mfma_f32_16x16x32_bf16 v[48:51], v[108:111], v[156:159], v[48:51]
    ds_read_b128 v[88:91], v12 offset:41984
    v_mfma_f32_16x16x32_bf16 v[52:55], v[112:115], v[156:159], v[52:55]
    ds_read_b128 v[92:95], v12 offset:43008
    v_mfma_f32_16x16x32_bf16 v[56:59], v[116:119], v[156:159], v[56:59]
    ds_read_b128 v[96:99], v12 offset:44032
    v_mfma_f32_16x16x32_bf16 v[60:63], v[120:123], v[156:159], v[60:63]
    ds_read_b128 v[100:103], v12 offset:45056
    s_waitcnt vmcnt(4)
    s_add_u32 s54, s50, 73728
    buffer_load_dwordx4 v[156:159], v10, s[12:15], s54 offen sc1
    s_waitcnt lgkmcnt(0)
    v_mfma_f32_16x16x32_bf16 v[44:47], v[84:87], v[160:163], v[44:47]
    ds_read_b128 v[104:107], v13 offset:10240
    v_mfma_f32_16x16x32_bf16 v[48:51], v[88:91], v[160:163], v[48:51]
    ds_read_b128 v[108:111], v13 offset:11264
    v_mfma_f32_16x16x32_bf16 v[52:55], v[92:95], v[160:163], v[52:55]
    ds_read_b128 v[112:115], v13 offset:12288
    v_mfma_f32_16x16x32_bf16 v[56:59], v[96:99], v[160:163], v[56:59]
    ds_read_b128 v[116:119], v13 offset:13312
    v_mfma_f32_16x16x32_bf16 v[60:63], v[100:103], v[160:163], v[60:63]
    ds_read_b128 v[120:123], v13 offset:14336
    s_waitcnt vmcnt(4)
    s_add_u32 s54, s50, 81920
    buffer_load_dwordx4 v[160:163], v10, s[12:15], s54 offen sc1
    s_waitcnt lgkmcnt(0)
    v_mfma_f32_16x16x32_bf16 v[44:47], v[104:107], v[164:167], v[44:47]
    ds_read_b128 v[84:87], v13 offset:20480
    v_mfma_f32_16x16x32_bf16 v[48:51], v[108:111], v[164:167], v[48:51]
    ds_read_b128 v[88:91], v13 offset:21504
    v_mfma_f32_16x16x32_bf16 v[52:55], v[112:115], v[164:167], v[52:55]
    ds_read_b128 v[92:95], v13 offset:22528
    v_mfma_f32_16x16x32_bf16 v[56:59], v[116:119], v[164:167], v[56:59]
    ds_read_b128 v[96:99], v13 offset:23552
    v_mfma_f32_16x16x32_bf16 v[60:63], v[120:123], v[164:167], v[60:63]
    ds_read_b128 v[100:103], v13 offset:24576
    s_waitcnt vmcnt(4)
    s_barrier
    s_add_u32 s54, s50, 90112
    buffer_load_dwordx4 v[164:167], v10, s[12:15], s54 offen sc1
    s_waitcnt lgkmcnt(0)
    v_mfma_f32_16x16x32_bf16 v[44:47], v[84:87], v[144:147], v[44:47]
    ds_read_b128 v[104:107], v13 offset:30720
    v_mfma_f32_16x16x32_bf16 v[48:51], v[88:91], v[144:147], v[48:51]
    ds_read_b128 v[108:111], v13 offset:31744
    v_mfma_f32_16x16x32_bf16 v[52:55], v[92:95], v[144:147], v[52:55]
    ds_read_b128 v[112:115], v13 offset:32768
    v_mfma_f32_16x16x32_bf16 v[56:59], v[96:99], v[144:147], v[56:59]
    ds_read_b128 v[116:119], v13 offset:33792
    v_mfma_f32_16x16x32_bf16 v[60:63], v[100:103], v[144:147], v[60:63]
    ds_read_b128 v[120:123], v13 offset:34816
    s_waitcnt vmcnt(4)
    s_cmp_eq_u32 s72, 0
    s_cbranch_scc1 L_p2_h3
    s_waitcnt vmcnt(4)
    v_add_f32 v176, v176, v180
    v_add_f32 v177, v177, v181
    v_add_f32 v178, v178, v182
    v_add_f32 v179, v179, v183
    v_add_f32 v176, v176, v184
    v_add_f32 v177, v177, v185
    v_add_f32 v178, v178, v186
    v_add_f32 v179, v179, v187
    v_add_f32 v176, v176, v188
    v_add_f32 v177, v177, v189
    v_add_f32 v178, v178, v190
    v_add_f32 v179, v179, v191
    v_add_f32 v176, v176, v192
    v_add_f32 v177, v177, v193
    v_add_f32 v178, v178, v194
    v_add_f32 v179, v179, v195
    v_add_f32 v176, v176, v196
    v_add_f32 v177, v177, v197
    v_add_f32 v178, v178, v198
    v_add_f32 v179, v179, v199
    v_add_f32 v176, v176, v200
    v_add_f32 v177, v177, v201
    v_add_f32 v178, v178, v202
    v_add_f32 v179, v179, v203
    v_add_f32 v176, v176, v204
    v_add_f32 v177, v177, v205
    v_add_f32 v178, v178, v206
    v_add_f32 v179, v179, v207
    v_add_f32 v176, v176, v208
    v_add_f32 v177, v177, v209
    v_add_f32 v178, v178, v210
    v_add_f32 v179, v179, v211
    v_add_f32 v176, v176, v212
    v_add_f32 v177, v177, v213
    v_add_f32 v178, v178, v214
    v_add_f32 v179, v179, v215
    v_add_f32 v176, v176, v216
    v_add_f32 v177, v177, v217
    v_add_f32 v178, v178, v218
    v_add_f32 v179, v179, v219
    v_add_f32 v176, v176, v220
    v_add_f32 v177, v177, v221
    v_add_f32 v178, v178, v222
    v_add_f32 v179, v179, v223
    v_add_f32 v176, v176, v224
    v_add_f32 v177, v177, v225
    v_add_f32 v178, v178, v226
    v_add_f32 v179, v179, v227
    v_add_f32 v176, v176, v228
    v_add_f32 v177, v177, v229
    v_add_f32 v178, v178, v230
    v_add_f32 v179, v179, v231
    v_add_f32 v176, v176, v232
    v_add_f32 v177, v177, v233
    v_add_f32 v178, v178, v234
    v_add_f32 v179, v179, v235
    v_add_f32 v176, v176, v236
    v_add_f32 v177, v177, v237
    v_add_f32 v178, v178, v238
    v_add_f32 v179, v179, v239
    v_cvt_pk_bf16_f32 v2, v176, v177
    v_cvt_pk_bf16_f32 v3, v178, v179
    v_mov_b32 v4, 0
    v_mov_b32 v5, 0
    s_mov_b64 exec, s[56:57]
    buffer_store_dwordx2 v[2:3], v16, s[12:15], 0 offen sc1
    s_mov_b64 exec, s[58:59]
    buffer_store_dwordx2 v[4:5], v16, s[12:15], 0 offen offset:8 sc1
    s_mov_b64 exec, -1
L_p2_h3:
    s_add_u32 s54, s50, 98304
    buffer_load_dwordx4 v[144:147], v10, s[12:15], s54 offen sc1
    s_add_u32 m0, s16, 20480
    s_add_u32 s52, s3, 153600
    s_cmp_eq_u32 s19, 0
    buffer_load_dwordx4 v21, s[12:15], s52 offen sc1 lds
    s_cbranch_scc1 L_p2_x52
    s_add_u32 m0, s17, 20480
    s_add_u32 s52, s52, s18
    buffer_load_dwordx4 v21, s[12:15], s52 offen sc1 lds
L_p2_x52:
    s_waitcnt lgkmcnt(0)
    v_mfma_f32_16x16x32_bf16 v[44:47], v[104:107], v[148:151], v[44:47]
    ds_read_b128 v[84:87], v13 offset:40960
    v_mfma_f32_16x16x32_bf16 v[48:51], v[108:111], v[148:151], v[48:51]
    ds_read_b128 v[88:91], v13 offset:41984
    v_mfma_f32_16x16x32_bf16 v[52:55], v[112:115], v[148:151], v[52:55]
    ds_read_b128 v[92:95], v13 offset:43008
    v_mfma_f32_16x16x32_bf16 v[56:59], v[116:119], v[148:151], v[56:59]
    ds_read_b128 v[96:99], v13 offset:44032
    v_mfma_f32_16x16x32_bf16 v[60:63], v[120:123], v[148:151], v[60:63]
    ds_read_b128 v[100:103], v13 offset:45056
    s_waitcnt vmcnt(5)
    s_add_u32 s54, s50, 106496
    buffer_load_dwordx4 v[148:151], v10, s[12:15], s54 offen sc1
    s_add_u32 m0, s16, 51200
    s_add_u32 s52, s3, 163840
    s_cmp_eq_u32 s19, 0
    buffer_load_dwordx4 v21, s[12:15], s52 offen sc1 lds
    s_cbranch_scc1 L_p2_x53
    s_add_u32 m0, s17, 51200
    s_add_u32 s52, s52, s18
    buffer_load_dwordx4 v21, s[12:15], s52 offen sc1 lds
L_p2_x53:
    s_waitcnt lgkmcnt(0)
    v_mfma_f32_16x16x32_bf16 v[44:47], v[84:87], v[152:155], v[44:47]
    ds_read_b128 v[104:107], v13 offset:51200
    v_mfma_f32_16x16x32_bf16 v[48:51], v[88:91], v[152:155], v[48:51]
    ds_read_b128 v[108:111], v13 offset:52224
    v_mfma_f32_16x16x32_bf16 v[52:55], v[92:95], v[152:155], v[52:55]
    ds_read_b128 v[112:115], v13 offset:53248
    v_mfma_f32_16x16x32_bf16 v[56:59], v[96:99], v[152:155], v[56:59]
    ds_read_b128 v[116:119], v13 offset:54272
    v_mfma_f32_16x16x32_bf16 v[60:63], v[100:103], v[152:155], v[60:63]
    ds_read_b128 v[120:123], v13 offset:55296
    s_waitcnt vmcnt(6)
    s_barrier
    s_add_u32 s54, s50, 114688
    buffer_load_dwordx4 v[152:155], v10, s[12:15], s54 offen sc1
    s_add_u32 m0, s16, 61440
    s_add_u32 s52, s3, 174080
    s_cmp_eq_u32 s19, 0
    buffer_load_dwordx4 v21, s[12:15], s52 offen sc1 lds
    s_cbranch_scc1 L_p2_x54
    s_add_u32 m0, s17, 61440
    s_add_u32 s52, s52, s18
    buffer_load_dwordx4 v21, s[12:15], s52 offen sc1 lds
L_p2_x54:
    s_waitcnt lgkmcnt(0)
    v_mfma_f32_16x16x32_bf16 v[44:47], v[104:107], v[156:159], v[44:47]
    ds_read_b128 v[84:87], v12 offset:0
    v_mfma_f32_16x16x32_bf16 v[48:51], v[108:111], v[156:159], v[48:51]
    ds_read_b128 v[88:91], v12 offset:1024
    v_mfma_f32_16x16x32_bf16 v[52:55], v[112:115], v[156:159], v[52:55]
    ds_read_b128 v[92:95], v12 offset:2048
    v_mfma_f32_16x16x32_bf16 v[56:59], v[116:119], v[156:159], v[56:59]
    ds_read_b128 v[96:99], v12 offset:3072
    v_mfma_f32_16x16x32_bf16 v[60:63], v[120:123], v[156:159], v[60:63]
    ds_read_b128 v[100:103], v12 offset:4096
    s_waitcnt vmcnt(7)
    s_cmp_eq_u32 s72, 0
    s_cbranch_scc1 L_p2_nf
    s_waitcnt vmcnt(0)
    s_memrealtime s[78:79]
    s_mov_b64 exec, 255
    s_waitcnt lgkmcnt(0)
    v_mov_b32 v40, s78
    v_mov_b32 v41, s79
    buffer_store_dwordx2 v[40:41], v39, s[12:15], 0 offen offset:0 sc1
    s_mov_b64 exec, -1
L_p2_nf:
    s_add_u32 s54, s50, 122880
    buffer_load_dwordx4 v[156:159], v10, s[12:15], s54 offen sc1
    s_add_u32 m0, s16, 30720
    s_add_u32 s52, s3, 184320
    s_cmp_eq_u32 s19, 0
    buffer_load_dwordx4 v21, s[12:15], s52 offen sc1 lds
    s_cbranch_scc1 L_p2_x55
    s_add_u32 m0, s17, 30720
    s_add_u32 s52, s52, s18
    buffer_load_dwordx4 v21, s[12:15], s52 offen sc1 lds
L_p2_x55:
    s_waitcnt lgkmcnt(0)
    v_mfma_f32_16x16x32_bf16 v[44:47], v[84:87], v[160:163], v[44:47]
    ds_read_b128 v[104:107], v12 offset:10240
    v_mfma_f32_16x16x32_bf16 v[48:51], v[88:91], v[160:163], v[48:51]
    ds_read_b128 v[108:111], v12 offset:11264
    v_mfma_f32_16x16x32_bf16 v[52:55], v[92:95], v[160:163], v[52:55]
    ds_read_b128 v[112:115], v12 offset:12288
    v_mfma_f32_16x16x32_bf16 v[56:59], v[96:99], v[160:163], v[56:59]
    ds_read_b128 v[116:119], v12 offset:13312
    v_mfma_f32_16x16x32_bf16 v[60:63], v[100:103], v[160:163], v[60:63]
    ds_read_b128 v[120:123], v12 offset:14336
    s_waitcnt vmcnt(8)
    s_add_u32 s54, s50, 131072
    buffer_load_dwordx4 v[160:163], v10, s[12:15], s54 offen sc1
    s_add_u32 m0, s16, 40960
    s_add_u32 s52, s3, 194560
    s_cmp_eq_u32 s19, 0
    buffer_load_dwordx4 v21, s[12:15], s52 offen sc1 lds
    s_cbranch_scc1 L_p2_x56
    s_add_u32 m0, s17, 40960
    s_add_u32 s52, s52, s18
    buffer_load_dwordx4 v21, s[12:15], s52 offen sc1 lds
L_p2_x56:
    s_waitcnt lgkmcnt(0)
    v_mfma_f32_16x16x32_bf16 v[44:47], v[104:107], v[164:167], v[44:47]
    ds_read_b128 v[84:87], v18 offset:0
    v_mfma_f32_16x16x32_bf16 v[48:51], v[108:111], v[164:167], v[48:51]
    ds_read_b128 v[88:91], v18 offset:1024
    v_mfma_f32_16x16x32_bf16 v[52:55], v[112:115], v[164:167], v[52:55]
    ds_read_b128 v[92:95], v18 offset:2048
    v_mfma_f32_16x16x32_bf16 v[56:59], v[116:119], v[164:167], v[56:59]
    ds_read_b128 v[96:99], v18 offset:3072
    v_mfma_f32_16x16x32_bf16 v[60:63], v[120:123], v[164:167], v[60:63]
    ds_read_b128 v[100:103], v18 offset:4096
    s_waitcnt vmcnt(8)
    s_barrier
    s_add_u32 s54, s50, 139264
    buffer_load_dwordx4 v[164:167], v10, s[12:15], s54 offen sc1
    s_add_u32 m0, s16, 71680
    s_add_u32 s52, s3, 204800
    s_cmp_eq_u32 s19, 0
    buffer_load_dwordx4 v21, s[12:15], s52 offen sc1 lds
    s_cbranch_scc1 L_p2_x57
    s_add_u32 m0, s17, 71680
    s_add_u32 s52, s52, s18
    buffer_load_dwordx4 v21, s[12:15], s52 offen sc1 lds
L_p2_x57:
    s_waitcnt lgkmcnt(0)
    v_mfma_f32_16x16x32_bf16 v[44:47], v[84:87], v[144:147], v[44:47]
    ds_read_b128 v[104:107], v18 offset:10240
    v_mfma_f32_16x16x32_bf16 v[48:51], v[88:91], v[144:147], v[48:51]
    ds_read_b128 v[108:111], v18 offset:11264
    v_mfma_f32_16x16x32_bf16 v[52:55], v[92:95], v[144:147], v[52:55]
    ds_read_b128 v[112:115], v18 offset:12288
    v_mfma_f32_16x16x32_bf16 v[56:59], v[96:99], v[144:147], v[56:59]
    ds_read_b128 v[116:119], v18 offset:13312
    v_mfma_f32_16x16x32_bf16 v[60:63], v[100:103], v[144:147], v[60:63]
    ds_read_b128 v[120:123], v18 offset:14336
    s_waitcnt vmcnt(9)
    s_add_u32 s54, s50, 147456
    buffer_load_dwordx4 v[144:147], v10, s[12:15], s54 offen sc1
    s_add_u32 m0, s16, 81920
    s_add_u32 s52, s3, 215040
    s_cmp_eq_u32 s19, 0
    buffer_load_dwordx4 v21, s[12:15], s52 offen sc1 lds
    s_cbranch_scc1 L_p2_x58
    s_add_u32 m0, s17, 81920
    s_add_u32 s52, s52, s18
    buffer_load_dwordx4 v21, s[12:15], s52 offen sc1 lds
L_p2_x58:
    s_waitcnt lgkmcnt(0)
    v_mfma_f32_16x16x32_bf16 v[44:47], v[104:107], v[148:151], v[44:47]
    ds_read_b128 v[84:87], v18 offset:20480
    v_mfma_f32_16x16x32_bf16 v[48:51], v[108:111], v[148:151], v[48:51]
    ds_read_b128 v[88:91], v18 offset:21504
    v_mfma_f32_16x16x32_bf16 v[52:55], v[112:115], v[148:151], v[52:55]
    ds_read_b128 v[92:95], v18 offset:22528
    v_mfma_f32_16x16x32_bf16 v[56:59], v[116:119], v[148:151], v[56:59]
    ds_read_b128 v[96:99], v18 offset:23552
    v_mfma_f32_16x16x32_bf16 v[60:63], v[120:123], v[148:151], v[60:63]
    ds_read_b128 v[100:103], v18 offset:24576
    s_waitcnt vmcnt(9)
    s_add_u32 s54, s50, 155648
    buffer_load_dwordx4 v[148:151], v10, s[12:15], s54 offen sc1
    s_add_u32 m0, s16, 92160
    s_add_u32 s52, s3, 225280
    s_cmp_eq_u32 s19, 0
    buffer_load_dwordx4 v21, s[12:15], s52 offen sc1 lds
    s_cbranch_scc1 L_p2_x59
    s_add_u32 m0, s17, 92160
    s_add_u32 s52, s52, s18
    buffer_load_dwordx4 v21, s[12:15], s52 offen sc1 lds
L_p2_x59:
    s_waitcnt lgkmcnt(0)
    v_mfma_f32_16x16x32_bf16 v[44:47], v[84:87], v[152:155], v[44:47]
    ds_read_b128 v[104:107], v12 offset:20480
    v_mfma_f32_16x16x32_bf16 v[48:51], v[88:91], v[152:155], v[48:51]
    ds_read_b128 v[108:111], v12 offset:21504
    v_mfma_f32_16x16x32_bf16 v[52:55], v[92:95], v[152:155], v[52:55]
    ds_read_b128 v[112:115], v12 offset:22528
    v_mfma_f32_16x16x32_bf16 v[56:59], v[96:99], v[152:155], v[56:59]
    ds_read_b128 v[116:119], v12 offset:23552
    v_mfma_f32_16x16x32_bf16 v[60:63], v[100:103], v[152:155], v[60:63]
    ds_read_b128 v[120:123], v12 offset:24576
    s_waitcnt vmcnt(8)
    s_barrier
    s_add_u32 s54, s50, 163840
    buffer_load_dwordx4 v[152:155], v10, s[12:15], s54 offen sc1
    s_add_u32 m0, s16, 102400
    s_add_u32 s52, s3, 235520
    s_cmp_eq_u32 s19, 0
    buffer_load_dwordx4 v21, s[12:15], s52 offen sc1 lds
    s_cbranch_scc1 L_p2_x60
    s_add_u32 m0, s17, 102400
    s_add_u32 s52, s52, s18
    buffer_load_dwordx4 v21, s[12:15], s52 offen sc1 lds
L_p2_x60:
    s_waitcnt lgkmcnt(0)
    v_mfma_f32_16x16x32_bf16 v[44:47], v[104:107], v[156:159], v[44:47]
    ds_read_b128 v[84:87], v12 offset:51200
    v_mfma_f32_16x16x32_bf16 v[48:51], v[108:111], v[156:159], v[48:51]
    ds_read_b128 v[88:91], v12 offset:52224
    v_mfma_f32_16x16x32_bf16 v[52:55], v[112:115], v[156:159], v[52:55]
    ds_read_b128 v[92:95], v12 offset:53248
    v_mfma_f32_16x16x32_bf16 v[56:59], v[116:119], v[156:159], v[56:59]
    ds_read_b128 v[96:99], v12 offset:54272
    v_mfma_f32_16x16x32_bf16 v[60:63], v[120:123], v[156:159], v[60:63]
    ds_read_b128 v[100:103], v12 offset:55296
    s_waitcnt vmcnt(9)
    s_add_u32 s54, s50, 172032
    buffer_load_dwordx4 v[156:159], v10, s[12:15], s54 offen sc1
    s_add_u32 m0, s16, 112640
    s_add_u32 s52, s3, 245760
    s_cmp_eq_u32 s19, 0
    buffer_load_dwordx4 v21, s[12:15], s52 offen sc1 lds
    s_cbranch_scc1 L_p2_x61
    s_add_u32 m0, s17, 112640
    s_add_u32 s52, s52, s18
    buffer_load_dwordx4 v21, s[12:15], s52 offen sc1 lds
L_p2_x61:
    s_waitcnt lgkmcnt(0)
    v_mfma_f32_16x16x32_bf16 v[44:47], v[84:87], v[160:163], v[44:47]
    ds_read_b128 v[104:107], v13 offset:0
    v_mfma_f32_16x16x32_bf16 v[48:51], v[88:91], v[160:163], v[48:51]
    ds_read_b128 v[108:111], v13 offset:1024
    v_mfma_f32_16x16x32_bf16 v[52:55], v[92:95], v[160:163], v[52:55]
    ds_read_b128 v[112:115], v13 offset:2048
    v_mfma_f32_16x16x32_bf16 v[56:59], v[96:99], v[160:163], v[56:59]
    ds_read_b128 v[116:119], v13 offset:3072
    v_mfma_f32_16x16x32_bf16 v[60:63], v[100:103], v[160:163], v[60:63]
    ds_read_b128 v[120:123], v13 offset:4096
    s_waitcnt vmcnt(9)
    s_add_u32 s54, s50, 180224
    buffer_load_dwordx4 v[160:163], v10, s[12:15], s54 offen sc1
    s_add_u32 m0, s16, 0
    s_add_u32 s52, s3, 256000
    s_cmp_eq_u32 s19, 0
    buffer_load_dwordx4 v21, s[12:15], s52 offen sc1 lds
    s_cbranch_scc1 L_p2_x62
    s_add_u32 m0, s17, 0
    s_add_u32 s52, s52, s18
    buffer_load_dwordx4 v21, s[12:15], s52 offen sc1 lds
L_p2_x62:
    s_waitcnt lgkmcnt(0)
    v_mfma_f32_16x16x32_bf16 v[44:47], v[104:107], v[164:167], v[44:47]
    ds_read_b128 v[84:87], v12 offset:30720
    v_mfma_f32_16x16x32_bf16 v[48:51], v[108:111], v[164:167], v[48:51]
    ds_read_b128 v[88:91], v12 offset:31744
    v_mfma_f32_16x16x32_bf16 v[52:55], v[112:115], v[164:167], v[52:55]
    ds_read_b128 v[92:95], v12 offset:32768
    v_mfma_f32_16x16x32_bf16 v[56:59], v[116:119], v[164:167], v[56:59]
    ds_read_b128 v[96:99], v12 offset:33792
    v_mfma_f32_16x16x32_bf16 v[60:63], v[120:123], v[164:167], v[60:63]
    ds_read_b128 v[100:103], v12 offset:34816
    s_waitcnt vmcnt(8)
    s_barrier
    s_add_u32 s54, s50, 188416
    buffer_load_dwordx4 v[164:167], v10, s[12:15], s54 offen sc1
    s_add_u32 m0, s16, 10240
    s_add_u32 s52, s3, 266240
    s_cmp_eq_u32 s19, 0
    buffer_load_dwordx4 v21, s[12:15], s52 offen sc1 lds
    s_cbranch_scc1 L_p2_x63
    s_add_u32 m0, s17, 10240
    s_add_u32 s52, s52, s18
    buffer_load_dwordx4 v21, s[12:15], s52 offen sc1 lds
L_p2_x63:
    s_waitcnt lgkmcnt(0)
    v_mfma_f32_16x16x32_bf16 v[44:47], v[84:87], v[144:147], v[44:47]
    ds_read_b128 v[104:107], v12 offset:40960
    v_mfma_f32_16x16x32_bf16 v[48:51], v[88:91], v[144:147], v[48:51]
    ds_read_b128 v[108:111], v12 offset:41984
    v_mfma_f32_16x16x32_bf16 v[52:55], v[92:95], v[144:147], v[52:55]
    ds_read_b128 v[112:115], v12 offset:43008
    v_mfma_f32_16x16x32_bf16 v[56:59], v[96:99], v[144:147], v[56:59]
    ds_read_b128 v[116:119], v12 offset:44032
    v_mfma_f32_16x16x32_bf16 v[60:63], v[100:103], v[144:147], v[60:63]
    ds_read_b128 v[120:123], v12 offset:45056
    s_waitcnt vmcnt(9)
    s_add_u32 s54, s50, 196608
    buffer_load_dwordx4 v[144:147], v10, s[12:15], s54 offen sc1
    s_add_u32 m0, s16, 20480
    s_add_u32 s52, s3, 276480
    s_cmp_eq_u32 s19, 0
    buffer_load_dwordx4 v21, s[12:15], s52 offen sc1 lds
    s_cbranch_scc1 L_p2_x64
    s_add_u32 m0, s17, 20480
    s_add_u32 s52, s52, s18
    buffer_load_dwordx4 v21, s[12:15], s52 offen sc1 lds
L_p2_x64:
    s_waitcnt lgkmcnt(0)
    v_mfma_f32_16x16x32_bf16 v[44:47], v[104:107], v[148:151], v[44:47]
    ds_read_b128 v[84:87], v13 offset:10240
    v_mfma_f32_16x16x32_bf16 v[48:51], v[108:111], v[148:151], v[48:51]
    ds_read_b128 v[88:91], v13 offset:11264
    v_mfma_f32_16x16x32_bf16 v[52:55], v[112:115], v[148:151], v[52:55]
    ds_read_b128 v[92:95], v13 offset:12288
    v_mfma_f32_16x16x32_bf16 v[56:59], v[116:119], v[148:151], v[56:59]
    ds_read_b128 v[96:99], v13 offset:13312
    v_mfma_f32_16x16x32_bf16 v[60:63], v[120:123], v[148:151], v[60:63]
    ds_read_b128 v[100:103], v13 offset:14336
    s_cmp_lg_u32 s40, 0
    s_cbranch_scc1 L_p2_nopoll
    s_mov_b64 exec, -1
    buffer_load_dwordx2 v[40:41], v38, s[12:15], 0 offen offset:0 sc1
    s_mov_b64 exec, -1
L_p2_nopoll:
    s_waitcnt vmcnt(9)
    s_add_u32 s54, s50, 204800
    buffer_load_dwordx4 v[148:151], v10, s[12:15], s54 offen sc1
    s_add_u32 m0, s16, 51200
    s_add_u32 s52, s3, 286720
    s_cmp_eq_u32 s19, 0
    buffer_load_dwordx4 v21, s[12:15], s52 offen sc1 lds
    s_cbranch_scc1 L_p2_x65
    s_add_u32 m0, s17, 51200
    s_add_u32 s52, s52, s18
    buffer_load_dwordx4 v21, s[12:15], s52 offen sc1 lds
L_p2_x65:
    s_waitcnt lgkmcnt(0)
    v_mfma_f32_16x16x32_bf16 v[44:47], v[84:87], v[152:155], v[44:47]
    ds_read_b128 v[104:107], v13 offset:20480
    v_mfma_f32_16x16x32_bf16 v[48:51], v[88:91], v[152:155], v[48:51]
    ds_read_b128 v[108:111], v13 offset:21504
    v_mfma_f32_16x16x32_bf16 v[52:55], v[92:95], v[152:155], v[52:55]
    ds_read_b128 v[112:115], v13 offset:22528
    v_mfma_f32_16x16x32_bf16 v[56:59], v[96:99], v[152:155], v[56:59]
    ds_read_b128 v[116:119], v13 offset:23552
    v_mfma_f32_16x16x32_bf16 v[60:63], v[100:103], v[152:155], v[60:63]
    ds_read_b128 v[120:123], v13 offset:24576
    s_waitcnt vmcnt(8)
    s_barrier
    s_add_u32 s54, s50, 212992
    buffer_load_dwordx4 v[152:155], v10, s[12:15], s54 offen sc1
    s_add_u32 m0, s16, 61440
    s_add_u32 s52, s3, 296960
    s_cmp_eq_u32 s19, 0
    buffer_load_dwordx4 v21, s[12:15], s52 offen sc1 lds
    s_cbranch_scc1 L_p2_x66
    s_add_u32 m0, s17, 61440
    s_add_u32 s52, s52, s18
    buffer_load_dwordx4 v21, s[12:15], s52 offen sc1 lds
L_p2_x66:
    s_waitcnt lgkmcnt(0)
    v_mfma_f32_16x16x32_bf16 v[44:47], v[104:107], v[156:159], v[44:47]
    ds_read_b128 v[84:87], v13 offset:30720
    v_mfma_f32_16x16x32_bf16 v[48:51], v[108:111], v[156:159], v[48:51]
    ds_read_b128 v[88:91], v13 offset:31744
    v_mfma_f32_16x16x32_bf16 v[52:55], v[112:115], v[156:159], v[52:55]
    ds_read_b128 v[92:95], v13 offset:32768
    v_mfma_f32_16x16x32_bf16 v[56:59], v[116:119], v[156:159], v[56:59]
    ds_read_b128 v[96:99], v13 offset:33792
    v_mfma_f32_16x16x32_bf16 v[60:63], v[120:123], v[156:159], v[60:63]
    ds_read_b128 v[100:103], v13 offset:34816
    s_cmp_lg_u32 s40, 0
    s_cbranch_scc1 L_p2_chk_ret
    s_waitcnt vmcnt(4)
    s_mov_b32 s65, 0
L_p2_sp3:
    s_mov_b64 exec, -1
    v_mov_b32 v43, s77
    v_subrev_co_u32 v42, vcc, s76, v40
    s_nop 1
    v_subb_co_u32 v43, vcc, v41, v43, vcc
    v_lshrrev_b32 v42, 30, v42
    v_or_b32 v42, v42, v43
    v_cmp_ne_u32 vcc, 0, v42
    s_mov_b64 exec, -1
    s_cmp_eq_u64 vcc, 0
    s_cbranch_scc1 L_p2_chk_ret
    s_add_u32 s65, s65, 1
    s_cmp_ge_u32 s65, 0x400000
    s_cbranch_scc1 L_p2_chk_ret
    s_sleep 4
    s_mov_b64 exec, -1
    buffer_load_dwordx2 v[40:41], v38, s[12:15], 0 offen offset:0 sc1
    s_mov_b64 exec, -1
    s_and_b32 s66, s65, 15
    s_cmp_lg_u32 s66, 0
    s_cbranch_scc1 L_p2_sp3_w
    v_mov_b32 v42, 0
    global_load_dwordx2 v[42:43], v42, s[36:37] sc1
    s_waitcnt vmcnt(0)
    v_readfirstlane_b32 s78, v42
    v_readfirstlane_b32 s79, v43
    s_nop 0
    s_cmp_eq_u64 s[78:79], 0
    s_cbranch_scc1 L_p2_sp3_w
    s_not_b64 s[78:79], s[78:79]
    s_sub_u32 s78, s78, 200
    s_subb_u32 s79, s79, 0
    s_sub_u32 s66, s78, s76
    s_subb_u32 s66, s79, s77
    s_cselect_b32 s76, s78, s76
    s_cselect_b32 s77, s79, s77
L_p2_sp3_w:
    s_waitcnt vmcnt(0)
    s_branch L_p2_sp3
L_p2_chk_ret:
    s_waitcnt vmcnt(9)
    s_barrier
    s_mov_b32 s60, 0
    buffer_load_dwordx4 v[192:195], v25, s[12:15], s60 offen sc1
    s_add_u32 s60, s60, 8192
    buffer_load_dwordx4 v[196:199], v25, s[12:15], s60 offen sc1
    s_add_u32 s60, s60, 8192
    buffer_load_dwordx4 v[200:203], v25, s[12:15], s60 offen sc1
    s_add_u32 s60, s60, 8192
    buffer_load_dwordx4 v[204:207], v25, s[12:15], s60 offen sc1
    s_add_u32 s60, s60, 8192
    s_add_u32 s54, s50, 221184
    buffer_load_dwordx4 v[156:159], v10, s[12:15], s54 offen sc1
    s_add_u32 m0, s16, 30720
    s_add_u32 s52, s3, 307200
    s_cmp_eq_u32 s19, 0
    buffer_load_dwordx4 v21, s[12:15], s52 offen sc1 lds
    s_cbranch_scc1 L_p2_x67
    s_add_u32 m0, s17, 30720
    s_add_u32 s52, s52, s18
    buffer_load_dwordx4 v21, s[12:15], s52 offen sc1 lds
L_p2_x67:
    s_waitcnt lgkmcnt(0)
    v_mfma_f32_16x16x32_bf16 v[44:47], v[84:87], v[160:163], v[44:47]
    ds_read_b128 v[104:107], v13 offset:40960
    v_mfma_f32_16x16x32_bf16 v[48:51], v[88:91], v[160:163], v[48:51]
    ds_read_b128 v[108:111], v13 offset:41984
    v_mfma_f32_16x16x32_bf16 v[52:55], v[92:95], v[160:163], v[52:55]
    ds_read_b128 v[112:115], v13 offset:43008
    v_mfma_f32_16x16x32_bf16 v[56:59], v[96:99], v[160:163], v[56:59]
    ds_read_b128 v[116:119], v13 offset:44032
    v_mfma_f32_16x16x32_bf16 v[60:63], v[100:103], v[160:163], v[60:63]
    ds_read_b128 v[120:123], v13 offset:45056
    s_waitcnt vmcnt(13)
    s_add_u32 s54, s50, 229376
    buffer_load_dwordx4 v[160:163], v10, s[12:15], s54 offen sc1
    s_add_u32 m0, s16, 40960
    s_add_u32 s52, s3, 317440
    s_cmp_eq_u32 s19, 0
    buffer_load_dwordx4 v21, s[12:15], s52 offen sc1 lds
    s_cbranch_scc1 L_p2_x68
    s_add_u32 m0, s17, 40960
    s_add_u32 s52, s52, s18
    buffer_load_dwordx4 v21, s[12:15], s52 offen sc1 lds
L_p2_x68:
    s_waitcnt lgkmcnt(0)
    v_mfma_f32_16x16x32_bf16 v[44:47], v[104:107], v[164:167], v[44:47]
    ds_read_b128 v[84:87], v13 offset:51200
    v_mfma_f32_16x16x32_bf16 v[48:51], v[108:111], v[164:167], v[48:51]
    ds_read_b128 v[88:91], v13 offset:52224
    v_mfma_f32_16x16x32_bf16 v[52:55], v[112:115], v[164:167], v[52:55]
    ds_read_b128 v[92:95], v13 offset:53248
    v_mfma_f32_16x16x32_bf16 v[56:59], v[116:119], v[164:167], v[56:59]
    ds_read_b128 v[96:99], v13 offset:54272
    v_mfma_f32_16x16x32_bf16 v[60:63], v[120:123], v[164:167], v[60:63]
    ds_read_b128 v[100:103], v13 offset:55296
    s_waitcnt vmcnt(12)
    s_barrier
    s_add_u32 s54, s50, 237568
    buffer_load_dwordx4 v[164:167], v10, s[12:15], s54 offen sc1
    s_add_u32 m0, s16, 71680
    s_add_u32 s52, s3, 327680
    s_cmp_eq_u32 s19, 0
    buffer_load_dwordx4 v21, s[12:15], s52 offen sc1 lds
    s_cbranch_scc1 L_p2_x69
    s_add_u32 m0, s17, 71680
    s_add_u32 s52, s52, s18
    buffer_load_dwordx4 v21, s[12:15], s52 offen sc1 lds
L_p2_x69:
    s_waitcnt lgkmcnt(0)
    v_mfma_f32_16x16x32_bf16 v[44:47], v[84:87], v[144:147], v[44:47]
    ds_read_b128 v[104:107], v12 offset:0
    v_mfma_f32_16x16x32_bf16 v[48:51], v[88:91], v[144:147], v[48:51]
    ds_read_b128 v[108:111], v12 offset:1024
    v_mfma_f32_16x16x32_bf16 v[52:55], v[92:95], v[144:147], v[52:55]
    ds_read_b128 v[112:115], v12 offset:2048
    v_mfma_f32_16x16x32_bf16 v[56:59], v[96:99], v[144:147], v[56:59]
    ds_read_b128 v[116:119], v12 offset:3072
    v_mfma_f32_16x16x32_bf16 v[60:63], v[100:103], v[144:147], v[60:63]
    ds_read_b128 v[120:123], v12 offset:4096
    s_waitcnt vmcnt(13)
    s_add_u32 s54, s50, 245760
    buffer_load_dwordx4 v[144:147], v10, s[12:15], s54 offen sc1
    s_add_u32 m0, s16, 81920
    s_add_u32 s52, s3, 337920
    s_cmp_eq_u32 s19, 0
    buffer_load_dwordx4 v21, s[12:15], s52 offen sc1 lds
    s_cbranch_scc1 L_p2_x70
    s_add_u32 m0, s17, 81920
    s_add_u32 s52, s52, s18
    buffer_load_dwordx4 v21, s[12:15], s52 offen sc1 lds
L_p2_x70:
    s_waitcnt lgkmcnt(0)
    v_mfma_f32_16x16x32_bf16 v[44:47], v[104:107], v[148:151], v[44:47]
    ds_read_b128 v[84:87], v12 offset:10240
    v_mfma_f32_16x16x32_bf16 v[48:51], v[108:111], v[148:151], v[48:51]
    ds_read_b128 v[88:91], v12 offset:11264
    v_mfma_f32_16x16x32_bf16 v[52:55], v[112:115], v[148:151], v[52:55]
    ds_read_b128 v[92:95], v12 offset:12288
    v_mfma_f32_16x16x32_bf16 v[56:59], v[116:119], v[148:151], v[56:59]
    ds_read_b128 v[96:99], v12 offset:13312
    v_mfma_f32_16x16x32_bf16 v[60:63], v[120:123], v[148:151], v[60:63]
    ds_read_b128 v[100:103], v12 offset:14336
    s_waitcnt vmcnt(8)
    ds_write_b128 v26, v[192:195] offset:0
    ds_write_b128 v26, v[196:199] offset:8192
    ds_write_b128 v26, v[200:203] offset:16384
    v_cmp_gt_u32 vcc, 480, v0
    s_nop 0
    s_and_saveexec_b64 s[60:61], vcc
    ds_write_b128 v26, v[204:207] offset:24576
    s_mov_b64 exec, s[60:61]
    s_add_u32 s54, s50, 253952
    buffer_load_dwordx4 v[148:151], v10, s[12:15], s54 offen sc1
    s_add_u32 m0, s16, 92160
    s_add_u32 s52, s3, 348160
    s_cmp_eq_u32 s19, 0
    buffer_load_dwordx4 v21, s[12:15], s52 offen sc1 lds
    s_cbranch_scc1 L_p2_x71
    s_add_u32 m0, s17, 92160
    s_add_u32 s52, s52, s18
    buffer_load_dwordx4 v21, s[12:15], s52 offen sc1 lds
L_p2_x71:
    s_waitcnt lgkmcnt(0)
    v_mfma_f32_16x16x32_bf16 v[44:47], v[84:87], v[152:155], v[44:47]
    v_mfma_f32_16x16x32_bf16 v[48:51], v[88:91], v[152:155], v[48:51]
    v_mfma_f32_16x16x32_bf16 v[52:55], v[92:95], v[152:155], v[52:55]
    v_mfma_f32_16x16x32_bf16 v[56:59], v[96:99], v[152:155], v[56:59]
    v_mfma_f32_16x16x32_bf16 v[60:63], v[100:103], v[152:155], v[60:63]
    s_waitcnt vmcnt(8)
    s_barrier
    s_add_u32 s54, s50, 262144
    buffer_load_dwordx4 v[152:155], v10, s[12:15], s54 offen sc1
    s_add_u32 m0, s16, 102400
    s_add_u32 s52, s3, 358400
    s_cmp_eq_u32 s19, 0
    buffer_load_dwordx4 v21, s[12:15], s52 offen sc1 lds
    s_cbranch_scc1 L_p2_x72
    s_add_u32 m0, s17, 102400
    s_add_u32 s52, s52, s18
    buffer_load_dwordx4 v21, s[12:15], s52 offen sc1 lds
L_p2_x72:
    v_mov_b32 v172, v156
    v_mov_b32 v173, v157
    v_mov_b32 v174, v158
    v_mov_b32 v175, v159
    s_waitcnt lgkmcnt(0)
    ds_read_b64 v[176:177], v19 offset:0
    ds_read_b64 v[178:179], v30 offset:0
    ds_read_b64 v[180:181], v20 offset:0
    ds_read_b64 v[182:183], v34 offset:0
    ds_read_b64 v[184:185], v19 offset:1008
    ds_read_b64 v[186:187], v31 offset:1008
    ds_read_b64 v[188:189], v20 offset:1008
    ds_read_b64 v[190:191], v35 offset:1008
    s_waitcnt vmcnt(9)
    s_add_u32 s54, s50, 270336
    buffer_load_dwordx4 v[156:159], v10, s[12:15], s54 offen sc1
    s_add_u32 m0, s16, 112640
    s_add_u32 s52, s3, 368640
    s_cmp_eq_u32 s19, 0
    buffer_load_dwordx4 v21, s[12:15], s52 offen sc1 lds
    s_cbranch_scc1 L_p2_x73
    s_add_u32 m0, s17, 112640
    s_add_u32 s52, s52, s18
    buffer_load_dwordx4 v21, s[12:15], s52 offen sc1 lds
L_p2_x73:
    v_mov_b32 v168, v162
    v_mov_b32 v169, v163
    v_mov_b32 v162, v172
    v_mov_b32 v163, v173
    v_mov_b32 v170, v172
    v_mov_b32 v171, v173
    s_waitcnt lgkmcnt(0)
    v_mfma_f32_16x16x32_bf16 v[208:211], v[176:179], v[160:163], 0
    ds_read_b128 v[84:87], v12 offset:20480
    ds_read_b128 v[88:91], v12 offset:21504
    v_mfma_f32_16x16x32_bf16 v[212:215], v[180:183], v[160:163], 0
    ds_read_b128 v[92:95], v12 offset:22528
    ds_read_b128 v[96:99], v12 offset:23552
    v_mfma_f32_16x16x32_bf16 v[216:219], v[184:187], v[168:171], 0
    ds_read_b128 v[100:103], v12 offset:24576
    v_mfma_f32_16x16x32_bf16 v[220:223], v[188:191], v[168:171], 0
    ds_read_b64 v[176:177], v19 offset:2016
    ds_read_b64 v[178:179], v32 offset:2016
    ds_read_b64 v[180:181], v20 offset:2016
    ds_read_b64 v[182:183], v36 offset:2016
    ds_read_b64 v[184:185], v19 offset:3024
    ds_read_b64 v[186:187], v33 offset:3024
    ds_read_b64 v[188:189], v20 offset:3024
    ds_read_b64 v[190:191], v37 offset:3024
    s_waitcnt vmcnt(9)
    s_add_u32 s54, s50, 278528
    buffer_load_dwordx4 v[160:163], v10, s[12:15], s54 offen sc1
    v_mov_b32 v168, v166
    v_mov_b32 v169, v167
    v_mov_b32 v166, v172
    v_mov_b32 v167, v173
    v_add_f32 v244, s68, v211
    v_add_f32 v245, s68, v219
    v_rcp_f32 v244, v244
    v_rcp_f32 v245, v245
    v_mul_f32 v208, v208, v244
    s_waitcnt lgkmcnt(0)
    v_mfma_f32_16x16x32_bf16 v[192:195], v[176:179], v[164:167], 0
    ds_read_b128 v[104:107], v12 offset:51200
    ds_read_b128 v[108:111], v12 offset:52224
    v_mfma_f32_16x16x32_bf16 v[196:199], v[180:183], v[164:167], 0
    ds_read_b128 v[112:115], v12 offset:53248
    ds_read_b128 v[116:119], v12 offset:54272
    v_mfma_f32_16x16x32_bf16 v[200:203], v[184:187], v[168:171], 0
    ds_read_b128 v[120:123], v12 offset:55296
    v_mfma_f32_16x16x32_bf16 v[204:207], v[188:191], v[168:171], 0
    ds_read_b64 v[176:177], v19 offset:4032
    v_mul_f32 v209, v209, v244
    v_mul_f32 v210, v210, v244
    ds_read_b64 v[178:179], v30 offset:4032
    v_mul_f32 v212, v212, v244
    v_mul_f32 v213, v213, v244
    ds_read_b64 v[180:181], v20 offset:4032
    v_mul_f32 v216, v216, v245
    v_mul_f32 v217, v217, v245
    ds_read_b64 v[182:183], v34 offset:4032
    v_mul_f32 v218, v218, v245
    v_mul_f32 v220, v220, v245
    ds_read_b64 v[184:185], v19 offset:5040
    v_mul_f32 v221, v221, v245
    v_cvt_pk_bf16_f32 v224, v208, v209
    ds_read_b64 v[186:187], v31 offset:5040
    v_cvt_pk_bf16_f32 v225, v210, v212
    v_cvt_pk_bf16_f32 v226, v213, v216
    ds_read_b64 v[188:189], v20 offset:5040
    v_cvt_pk_bf16_f32 v227, v217, v218
    v_cvt_pk_bf16_f32 v228, v220, v221
    ds_read_b64 v[190:191], v35 offset:5040
    v_mfma_f32_16x16x32_bf16 v[64:67], v[84:87], v[224:227], 0
    v_mfma_f32_16x16x32_bf16 v[68:71], v[88:91], v[224:227], 0
    v_mfma_f32_16x16x32_bf16 v[72:75], v[92:95], v[224:227], 0
    v_mfma_f32_16x16x32_bf16 v[76:79], v[96:99], v[224:227], 0
    v_mfma_f32_16x16x32_bf16 v[80:83], v[100:103], v[224:227], 0
    s_waitcnt vmcnt(7)
    s_barrier
    s_add_u32 s54, s50, 286720
    buffer_load_dwordx4 v[164:167], v10, s[12:15], s54 offen sc1
    v_mov_b32 v168, v146
    v_mov_b32 v169, v147
    v_mov_b32 v146, v174
    v_mov_b32 v147, v175
    v_mov_b32 v170, v174
    v_mov_b32 v171, v175
    v_add_f32 v244, s68, v195
    v_add_f32 v245, s68, v203
    v_rcp_f32 v244, v244
    v_rcp_f32 v245, v245
    v_mul_f32 v192, v192, v244
    s_waitcnt lgkmcnt(0)
    v_mfma_f32_16x16x32_bf16 v[208:211], v[176:179], v[144:147], 0
    ds_read_b128 v[84:87], v13 offset:0
    ds_read_b128 v[88:91], v13 offset:1024
    v_mfma_f32_16x16x32_bf16 v[212:215], v[180:183], v[144:147], 0
    ds_read_b128 v[92:95], v13 offset:2048
    ds_read_b128 v[96:99], v13 offset:3072
    v_mfma_f32_16x16x32_bf16 v[216:219], v[184:187], v[168:171], 0
    ds_read_b128 v[100:103], v13 offset:4096
    v_mfma_f32_16x16x32_bf16 v[220:223], v[188:191], v[168:171], 0
    ds_read_b64 v[176:177], v19 offset:6048
    v_mul_f32 v193, v193, v244
    v_mul_f32 v194, v194, v244
    ds_read_b64 v[178:179], v32 offset:6048
    v_mul_f32 v196, v196, v244
    v_mul_f32 v197, v197, v244
    ds_read_b64 v[180:181], v20 offset:6048
    v_mul_f32 v200, v200, v245
    v_mul_f32 v201, v201, v245
    ds_read_b64 v[182:183], v36 offset:6048
    v_mul_f32 v202, v202, v245
    v_mul_f32 v204, v204, v245
    ds_read_b64 v[184:185], v19 offset:7056
    v_mul_f32 v205, v205, v245
    v_cvt_pk_bf16_f32 v229, v192, v193
    ds_read_b64 v[186:187], v33 offset:7056
    v_cvt_pk_bf16_f32 v230, v194, v196
    v_cvt_pk_bf16_f32 v231, v197, v200
    ds_read_b64 v[188:189], v20 offset:7056
    v_cvt_pk_bf16_f32 v232, v201, v202
    v_cvt_pk_bf16_f32 v233, v204, v205
    ds_read_b64 v[190:191], v37 offset:7056
    v_mfma_f32_16x16x32_bf16 v[64:67], v[104:107], v[228:231], v[64:67]
    v_mfma_f32_16x16x32_bf16 v[68:71], v[108:111], v[228:231], v[68:71]
    v_mfma_f32_16x16x32_bf16 v[72:75], v[112:115], v[228:231], v[72:75]
    v_mfma_f32_16x16x32_bf16 v[76:79], v[116:119], v[228:231], v[76:79]
    v_mfma_f32_16x16x32_bf16 v[80:83], v[120:123], v[228:231], v[80:83]
    s_waitcnt vmcnt(7)
    s_add_u32 s54, s50, 294912
    buffer_load_dwordx4 v[144:147], v10, s[12:15], s54 offen sc1
    v_mov_b32 v168, v150
    v_mov_b32 v169, v151
    v_mov_b32 v150, v174
    v_mov_b32 v151, v175
    v_add_f32 v244, s68, v211
    v_add_f32 v245, s68, v219
    v_rcp_f32 v244, v244
    v_rcp_f32 v245, v245
    v_mul_f32 v208, v208, v244
    s_waitcnt lgkmcnt(0)
    v_mfma_f32_16x16x32_bf16 v[192:195], v[176:179], v[148:151], 0
    ds_read_b128 v[104:107], v12 offset:30720
    ds_read_b128 v[108:111], v12 offset:31744
    ds_read_b128 v[112:115], v12 offset:32768
    v_mfma_f32_16x16x32_bf16 v[196:199], v[180:183], v[148:151], 0
    ds_read_b128 v[116:119], v12 offset:33792
    ds_read_b128 v[120:123], v12 offset:34816
    ds_read_b128 v[124:127], v12 offset:40960
    v_mfma_f32_16x16x32_bf16 v[200:203], v[184:187], v[168:171], 0
    ds_read_b128 v[128:131], v12 offset:41984
    ds_read_b128 v[132:135], v12 offset:43008
    ds_read_b128 v[136:139], v12 offset:44032
    v_mfma_f32_16x16x32_bf16 v[204:207], v[188:191], v[168:171], 0
    ds_read_b128 v[140:143], v12 offset:45056
    v_mul_f32 v209, v209, v244
    v_mul_f32 v210, v210, v244
    v_mul_f32 v212, v212, v244
    v_mul_f32 v213, v213, v244
    v_mul_f32 v216, v216, v245
    v_mul_f32 v217, v217, v245
    v_mul_f32 v218, v218, v245
    v_mul_f32 v220, v220, v245
    v_mul_f32 v221, v221, v245
    v_cvt_pk_bf16_f32 v234, v208, v209
    v_cvt_pk_bf16_f32 v235, v210, v212
    v_cvt_pk_bf16_f32 v236, v213, v216
    v_cvt_pk_bf16_f32 v237, v217, v218
    v_cvt_pk_bf16_f32 v238, v220, v221
    v_mfma_f32_16x16x32_bf16 v[64:67], v[84:87], v[232:235], v[64:67]
    v_mfma_f32_16x16x32_bf16 v[68:71], v[88:91], v[232:235], v[68:71]
    v_mfma_f32_16x16x32_bf16 v[72:75], v[92:95], v[232:235], v[72:75]
    v_mfma_f32_16x16x32_bf16 v[76:79], v[96:99], v[232:235], v[76:79]
    v_mfma_f32_16x16x32_bf16 v[80:83], v[100:103], v[232:235], v[80:83]
    buffer_load_dwordx2 v[248:249], v23, s[4:7], 0 offen offset:0
    buffer_load_dwordx2 v[250:251], v23, s[4:7], 0 offen offset:32
    buffer_load_dwordx2 v[252:253], v23, s[4:7], 0 offen offset:64
    s_waitcnt vmcnt(9)
    v_mov_b32 v172, v152
    v_mov_b32 v173, v153
    v_mov_b32 v174, v154
    v_mov_b32 v175, v155
    v_add_f32 v244, s68, v195
    v_add_f32 v245, s68, v203
    v_rcp_f32 v244, v244
    v_rcp_f32 v245, v245
    v_mul_f32 v192, v192, v244
    s_waitcnt lgkmcnt(0)
    ds_read_b64 v[176:177], v19 offset:8064
    v_mul_f32 v193, v193, v244
    v_mul_f32 v194, v194, v244
    ds_read_b64 v[178:179], v30 offset:8064
    v_mul_f32 v196, v196, v244
    v_mul_f32 v197, v197, v244
    ds_read_b64 v[180:181], v20 offset:8064
    v_mul_f32 v200, v200, v245
    v_mul_f32 v201, v201, v245
    ds_read_b64 v[182:183], v34 offset:8064
    v_mul_f32 v202, v202, v245
    v_mul_f32 v204, v204, v245
    ds_read_b64 v[184:185], v19 offset:9072
    v_mul_f32 v205, v205, v245
    v_cvt_pk_bf16_f32 v239, v192, v193
    ds_read_b64 v[186:187], v31 offset:9072
    v_cvt_pk_bf16_f32 v240, v194, v196
    v_cvt_pk_bf16_f32 v241, v197, v200
    ds_read_b64 v[188:189], v20 offset:9072
    v_cvt_pk_bf16_f32 v242, v201, v202
    v_cvt_pk_bf16_f32 v243, v204, v205
    ds_read_b64 v[190:191], v35 offset:9072
    v_mfma_f32_16x16x32_bf16 v[64:67], v[104:107], v[236:239], v[64:67]
    v_mfma_f32_16x16x32_bf16 v[68:71], v[108:111], v[236:239], v[68:71]
    v_mfma_f32_16x16x32_bf16 v[72:75], v[112:115], v[236:239], v[72:75]
    v_mfma_f32_16x16x32_bf16 v[76:79], v[116:119], v[236:239], v[76:79]
    v_mfma_f32_16x16x32_bf16 v[80:83], v[120:123], v[236:239], v[80:83]
    v_mfma_f32_16x16x32_bf16 v[64:67], v[124:127], v[240:243], v[64:67]
    v_mfma_f32_16x16x32_bf16 v[68:71], v[128:131], v[240:243], v[68:71]
    v_mfma_f32_16x16x32_bf16 v[72:75], v[132:135], v[240:243], v[72:75]
    v_mfma_f32_16x16x32_bf16 v[76:79], v[136:139], v[240:243], v[76:79]
    v_mfma_f32_16x16x32_bf16 v[80:83], v[140:143], v[240:243], v[80:83]
    s_waitcnt vmcnt(6)
    s_barrier
    v_mov_b32 v168, v158
    v_mov_b32 v169, v159
    v_mov_b32 v158, v172
    v_mov_b32 v159, v173
    v_mov_b32 v170, v172
    v_mov_b32 v171, v173
    s_waitcnt lgkmcnt(0)
    v_mfma_f32_16x16x32_bf16 v[192:195], v[176:179], v[156:159], 0
    ds_read_b128 v[84:87], v13 offset:10240
    ds_read_b128 v[88:91], v13 offset:11264
    v_mfma_f32_16x16x32_bf16 v[196:199], v[180:183], v[156:159], 0
    ds_read_b128 v[92:95], v13 offset:12288
    ds_read_b128 v[96:99], v13 offset:13312
    v_mfma_f32_16x16x32_bf16 v[200:203], v[184:187], v[168:171], 0
    ds_read_b128 v[100:103], v13 offset:14336
    v_mfma_f32_16x16x32_bf16 v[204:207], v[188:191], v[168:171], 0
    ds_read_b64 v[176:177], v19 offset:10080
    ds_read_b64 v[178:179], v32 offset:10080
    ds_read_b64 v[180:181], v20 offset:10080
    ds_read_b64 v[182:183], v36 offset:10080
    ds_read_b64 v[184:185], v19 offset:11088
    ds_read_b64 v[186:187], v33 offset:11088
    ds_read_b64 v[188:189], v20 offset:11088
    ds_read_b64 v[190:191], v37 offset:11088
    s_waitcnt vmcnt(5)
    v_mov_b32 v168, v162
    v_mov_b32 v169, v163
    v_mov_b32 v162, v172
    v_mov_b32 v163, v173
    v_add_f32 v244, s68, v195
    v_add_f32 v245, s68, v203
    v_rcp_f32 v244, v244
    v_rcp_f32 v245, v245
    v_mul_f32 v192, v192, v244
    s_waitcnt lgkmcnt(0)
    v_mfma_f32_16x16x32_bf16 v[208:211], v[176:179], v[160:163], 0
    ds_read_b128 v[104:107], v13 offset:20480
    ds_read_b128 v[108:111], v13 offset:21504
    v_mfma_f32_16x16x32_bf16 v[212:215], v[180:183], v[160:163], 0
    ds_read_b128 v[112:115], v13 offset:22528
    ds_read_b128 v[116:119], v13 offset:23552
    v_mfma_f32_16x16x32_bf16 v[216:219], v[184:187], v[168:171], 0
    ds_read_b128 v[120:123], v13 offset:24576
    v_mfma_f32_16x16x32_bf16 v[220:223], v[188:191], v[168:171], 0
    ds_read_b64 v[176:177], v19 offset:12096
    v_mul_f32 v193, v193, v244
    v_mul_f32 v194, v194, v244
    ds_read_b64 v[178:179], v30 offset:12096
    v_mul_f32 v196, v196, v244
    v_mul_f32 v197, v197, v244
    ds_read_b64 v[180:181], v20 offset:12096
    v_mul_f32 v200, v200, v245
    v_mul_f32 v201, v201, v245
    ds_read_b64 v[182:183], v34 offset:12096
    v_mul_f32 v202, v202, v245
    v_mul_f32 v204, v204, v245
    ds_read_b64 v[184:185], v19 offset:13104
    v_mul_f32 v205, v205, v245
    v_cvt_pk_bf16_f32 v224, v192, v193
    ds_read_b64 v[186:187], v31 offset:13104
    v_cvt_pk_bf16_f32 v225, v194, v196
    v_cvt_pk_bf16_f32 v226, v197, v200
    ds_read_b64 v[188:189], v20 offset:13104
    v_cvt_pk_bf16_f32 v227, v201, v202
    v_cvt_pk_bf16_f32 v228, v204, v205
    ds_read_b64 v[190:191], v35 offset:13104
    v_mfma_f32_16x16x32_bf16 v[64:67], v[84:87], v[224:227], v[64:67]
    v_mfma_f32_16x16x32_bf16 v[68:71], v[88:91], v[224:227], v[68:71]
    v_mfma_f32_16x16x32_bf16 v[72:75], v[92:95], v[224:227], v[72:75]
    v_mfma_f32_16x16x32_bf16 v[76:79], v[96:99], v[224:227], v[76:79]
    v_mfma_f32_16x16x32_bf16 v[80:83], v[100:103], v[224:227], v[80:83]
    s_waitcnt vmcnt(4)
    v_mov_b32 v168, v166
    v_mov_b32 v169, v167
    v_mov_b32 v166, v174
    v_mov_b32 v167, v175
    v_mov_b32 v170, v174
    v_mov_b32 v171, v175
    v_add_f32 v244, s68, v211
    v_add_f32 v245, s68, v219
    v_rcp_f32 v244, v244
    v_rcp_f32 v245, v245
    v_mul_f32 v208, v208, v244
    s_waitcnt lgkmcnt(0)
    v_mfma_f32_16x16x32_bf16 v[192:195], v[176:179], v[164:167], 0
    ds_read_b128 v[84:87], v13 offset:30720
    ds_read_b128 v[88:91], v13 offset:31744
    v_mfma_f32_16x16x32_bf16 v[196:199], v[180:183], v[164:167], 0
    ds_read_b128 v[92:95], v13 offset:32768
    ds_read_b128 v[96:99], v13 offset:33792
    v_mfma_f32_16x16x32_bf16 v[200:203], v[184:187], v[168:171], 0
    ds_read_b128 v[100:103], v13 offset:34816
    v_mfma_f32_16x16x32_bf16 v[204:207], v[188:191], v[168:171], 0
    ds_read_b64 v[176:177], v19 offset:14112
    v_mul_f32 v209, v209, v244
    v_mul_f32 v210, v210, v244
    ds_read_b64 v[178:179], v32 offset:14112
    v_mul_f32 v212, v212, v244
    v_mul_f32 v213, v213, v244
    ds_read_b64 v[180:181], v20 offset:14112
    v_mul_f32 v216, v216, v245
    v_mul_f32 v217, v217, v245
    ds_read_b64 v[182:183], v36 offset:14112
    v_mul_f32 v218, v218, v245
    v_mul_f32 v220, v220, v245
    ds_read_b64 v[184:185], v19 offset:15120
    v_mul_f32 v221, v221, v245
    v_cvt_pk_bf16_f32 v229, v208, v209
    ds_read_b64 v[186:187], v33 offset:15120
    v_cvt_pk_bf16_f32 v230, v210, v212
    v_cvt_pk_bf16_f32 v231, v213, v216
    ds_read_b64 v[188:189], v20 offset:15120
    v_cvt_pk_bf16_f32 v232, v217, v218
    v_cvt_pk_bf16_f32 v233, v220, v221
    ds_read_b64 v[190:191], v37 offset:15120
    v_mfma_f32_16x16x32_bf16 v[64:67], v[104:107], v[228:231], v[64:67]
    v_mfma_f32_16x16x32_bf16 v[68:71], v[108:111], v[228:231], v[68:71]
    v_mfma_f32_16x16x32_bf16 v[72:75], v[112:115], v[228:231], v[72:75]
    v_mfma_f32_16x16x32_bf16 v[76:79], v[116:119], v[228:231], v[76:79]
    v_mfma_f32_16x16x32_bf16 v[80:83], v[120:123], v[228:231], v[80:83]
    s_waitcnt vmcnt(3)
    s_barrier
    v_mov_b32 v168, v146
    v_mov_b32 v169, v147
    v_mov_b32 v146, v174
    v_mov_b32 v147, v175
    v_add_f32 v244, s68, v195
    v_add_f32 v245, s68, v203
    v_rcp_f32 v244, v244
    v_rcp_f32 v245, v245
    v_mul_f32 v192, v192, v244
    s_waitcnt lgkmcnt(0)
    v_mfma_f32_16x16x32_bf16 v[208:211], v[176:179], v[144:147], 0
    ds_read_b128 v[104:107], v13 offset:40960
    ds_read_b128 v[108:111], v13 offset:41984
    ds_read_b128 v[112:115], v13 offset:43008
    v_mfma_f32_16x16x32_bf16 v[212:215], v[180:183], v[144:147], 0
    ds_read_b128 v[116:119], v13 offset:44032
    ds_read_b128 v[120:123], v13 offset:45056
    ds_read_b128 v[124:127], v13 offset:51200
    v_mfma_f32_16x16x32_bf16 v[216:219], v[184:187], v[168:171], 0
    ds_read_b128 v[128:131], v13 offset:52224
    ds_read_b128 v[132:135], v13 offset:53248
    ds_read_b128 v[136:139], v13 offset:54272
    v_mfma_f32_16x16x32_bf16 v[220:223], v[188:191], v[168:171], 0
    ds_read_b128 v[140:143], v13 offset:55296
    v_mul_f32 v193, v193, v244
    v_mul_f32 v194, v194, v244
    v_mul_f32 v196, v196, v244
    v_mul_f32 v197, v197, v244
    v_mul_f32 v200, v200, v245
    v_mul_f32 v201, v201, v245
    v_mul_f32 v202, v202, v245
    v_mul_f32 v204, v204, v245
    v_mul_f32 v205, v205, v245
    v_cvt_pk_bf16_f32 v234, v192, v193
    v_cvt_pk_bf16_f32 v235, v194, v196
    v_cvt_pk_bf16_f32 v236, v197, v200
    v_cvt_pk_bf16_f32 v237, v201, v202
    v_cvt_pk_bf16_f32 v238, v204, v205
    v_mfma_f32_16x16x32_bf16 v[64:67], v[84:87], v[232:235], v[64:67]
    v_mfma_f32_16x16x32_bf16 v[68:71], v[88:91], v[232:235], v[68:71]
    v_mfma_f32_16x16x32_bf16 v[72:75], v[92:95], v[232:235], v[72:75]
    v_mfma_f32_16x16x32_bf16 v[76:79], v[96:99], v[232:235], v[76:79]
    v_mfma_f32_16x16x32_bf16 v[80:83], v[100:103], v[232:235], v[80:83]
    v_add_f32 v244, s68, v211
    v_add_f32 v245, s68, v219
    v_rcp_f32 v244, v244
    v_rcp_f32 v245, v245
    v_mul_f32 v208, v208, v244
    s_waitcnt lgkmcnt(0)
    v_mul_f32 v209, v209, v244
    v_mul_f32 v210, v210, v244
    v_mul_f32 v212, v212, v244
    v_mul_f32 v213, v213, v244
    v_mul_f32 v216, v216, v245
    v_mul_f32 v217, v217, v245
    v_mul_f32 v218, v218, v245
    v_mul_f32 v220, v220, v245
    v_mul_f32 v221, v221, v245
    v_cvt_pk_bf16_f32 v239, v208, v209
    v_cvt_pk_bf16_f32 v240, v210, v212
    v_cvt_pk_bf16_f32 v241, v213, v216
    v_cvt_pk_bf16_f32 v242, v217, v218
    v_cvt_pk_bf16_f32 v243, v220, v221
    v_mfma_f32_16x16x32_bf16 v[64:67], v[104:107], v[236:239], v[64:67]
    v_mfma_f32_16x16x32_bf16 v[68:71], v[108:111], v[236:239], v[68:71]
    v_mfma_f32_16x16x32_bf16 v[72:75], v[112:115], v[236:239], v[72:75]
    v_mfma_f32_16x16x32_bf16 v[76:79], v[116:119], v[236:239], v[76:79]
    v_mfma_f32_16x16x32_bf16 v[80:83], v[120:123], v[236:239], v[80:83]
    v_mfma_f32_16x16x32_bf16 v[64:67], v[124:127], v[240:243], v[64:67]
    v_mfma_f32_16x16x32_bf16 v[68:71], v[128:131], v[240:243], v[68:71]
    v_mfma_f32_16x16x32_bf16 v[72:75], v[132:135], v[240:243], v[72:75]
    v_mfma_f32_16x16x32_bf16 v[76:79], v[136:139], v[240:243], v[76:79]
    v_mfma_f32_16x16x32_bf16 v[80:83], v[140:143], v[240:243], v[80:83]
    s_mul_i32 s60, s40, 6144
    s_add_u32 s60, s60, 20480
    v_add_u32 v2, s60, v10
    s_xor_b32 s61, s40, 4
    s_mul_i32 s61, s61, 6144
    s_add_u32 s61, s61, 20480
    v_add_u32 v3, s61, v10
    s_mov_b32 s62, 0xbfb8aa3b
    s_mov_b32 s73, 0xffff0000
    s_cmp_eq_u32 s44, 0
    s_cbranch_scc0 L_p2_e1
    ds_write_b128 v2, v[56:59] offset:0
    ds_write_b128 v2, v[60:63] offset:2048
    ds_write_b128 v2, v[76:79] offset:1024
    ds_write_b128 v2, v[80:83] offset:3072
    s_waitcnt vmcnt(0)
    v_lshlrev_b32 v180, 16, v248
    v_and_b32 v181, s73, v248
    v_lshlrev_b32 v182, 16, v249
    v_and_b32 v183, s73, v249
    v_lshlrev_b32 v188, 16, v250
    v_and_b32 v189, s73, v250
    v_lshlrev_b32 v190, 16, v251
    v_and_b32 v191, s73, v251
    v_lshlrev_b32 v196, 16, v252
    v_and_b32 v197, s73, v252
    v_lshlrev_b32 v198, 16, v253
    v_and_b32 v199, s73, v253
    s_waitcnt lgkmcnt(0)
    s_barrier
    ds_read_b128 v[144:147], v3 offset:0
    ds_read_b128 v[148:151], v3 offset:1024
    ds_read_b128 v[152:155], v3 offset:2048
    ds_read_b128 v[156:159], v3 offset:3072
    ds_read_b128 v[160:163], v3 offset:4096
    ds_read_b128 v[164:167], v3 offset:5120
    s_waitcnt lgkmcnt(4)
    v_add_f32 v44, v44, v144
    v_add_f32 v45, v45, v145
    v_add_f32 v46, v46, v146
    v_add_f32 v47, v47, v147
    v_mul_f32 v176, s62, v44
    v_add_f32 v64, v64, v148
    v_mul_f32 v177, s62, v45
    v_add_f32 v65, v65, v149
    v_mul_f32 v178, s62, v46
    v_add_f32 v66, v66, v150
    v_mul_f32 v179, s62, v47
    v_add_f32 v67, v67, v151
    v_exp_f32 v176, v176
    v_mul_f32 v64, v64, v44
    v_exp_f32 v177, v177
    v_mul_f32 v65, v65, v45
    v_exp_f32 v178, v178
    v_mul_f32 v66, v66, v46
    v_exp_f32 v179, v179
    v_mul_f32 v67, v67, v47
    v_add_f32 v176, 1.0, v176
    v_add_f32 v177, 1.0, v177
    v_add_f32 v178, 1.0, v178
    v_add_f32 v179, 1.0, v179
    v_rcp_f32 v176, v176
    v_rcp_f32 v177, v177
    v_rcp_f32 v178, v178
    v_rcp_f32 v179, v179
    v_fma_f32 v176, v176, v64, v180
    v_fma_f32 v177, v177, v65, v181
    v_fma_f32 v178, v178, v66, v182
    v_fma_f32 v179, v179, v67, v183
    v_cvt_pk_bf16_f32 v176, v176, v177
    v_cvt_pk_bf16_f32 v177, v178, v179
    buffer_store_dwordx2 v[176:177], v23, s[8:11], 0 offen offset:0
    s_waitcnt lgkmcnt(2)
    v_add_f32 v48, v48, v152
    v_add_f32 v49, v49, v153
    v_add_f32 v50, v50, v154
    v_add_f32 v51, v51, v155
    v_mul_f32 v184, s62, v48
    v_add_f32 v68, v68, v156
    v_mul_f32 v185, s62, v49
    v_add_f32 v69, v69, v157
    v_mul_f32 v186, s62, v50
    v_add_f32 v70, v70, v158
    v_mul_f32 v187, s62, v51
    v_add_f32 v71, v71, v159
    v_exp_f32 v184, v184
    v_mul_f32 v68, v68, v48
    v_exp_f32 v185, v185
    v_mul_f32 v69, v69, v49
    v_exp_f32 v186, v186
    v_mul_f32 v70, v70, v50
    v_exp_f32 v187, v187
    v_mul_f32 v71, v71, v51
    v_add_f32 v184, 1.0, v184
    v_add_f32 v185, 1.0, v185
    v_add_f32 v186, 1.0, v186
    v_add_f32 v187, 1.0, v187
    v_rcp_f32 v184, v184
    v_rcp_f32 v185, v185
    v_rcp_f32 v186, v186
    v_rcp_f32 v187, v187
    v_fma_f32 v184, v184, v68, v188
    v_fma_f32 v185, v185, v69, v189
    v_fma_f32 v186, v186, v70, v190
    v_fma_f32 v187, v187, v71, v191
    v_cvt_pk_bf16_f32 v184, v184, v185
    v_cvt_pk_bf16_f32 v185, v186, v187
    buffer_store_dwordx2 v[184:185], v23, s[8:11], 0 offen offset:32
    s_waitcnt lgkmcnt(0)
    v_add_f32 v52, v52, v160
    v_add_f32 v53, v53, v161
    v_add_f32 v54, v54, v162
    v_add_f32 v55, v55, v163
    v_mul_f32 v192, s62, v52
    v_add_f32 v72, v72, v164
    v_mul_f32 v193, s62, v53
    v_add_f32 v73, v73, v165
    v_mul_f32 v194, s62, v54
    v_add_f32 v74, v74, v166
    v_mul_f32 v195, s62, v55
    v_add_f32 v75, v75, v167
    v_exp_f32 v192, v192
    v_mul_f32 v72, v72, v52
    v_exp_f32 v193, v193
    v_mul_f32 v73, v73, v53
    v_exp_f32 v194, v194
    v_mul_f32 v74, v74, v54
    v_exp_f32 v195, v195
    v_mul_f32 v75, v75, v55
    v_add_f32 v192, 1.0, v192
    v_add_f32 v193, 1.0, v193
    v_add_f32 v194, 1.0, v194
    v_add_f32 v195, 1.0, v195
    v_rcp_f32 v192, v192
    v_rcp_f32 v193, v193
    v_rcp_f32 v194, v194
    v_rcp_f32 v195, v195
    v_fma_f32 v192, v192, v72, v196
    v_fma_f32 v193, v193, v73, v197
    v_fma_f32 v194, v194, v74, v198
    v_fma_f32 v195, v195, v75, v199
    v_cvt_pk_bf16_f32 v192, v192, v193
    v_cvt_pk_bf16_f32 v193, v194, v195
    buffer_store_dwordx2 v[192:193], v23, s[8:11], 0 offen offset:64
    s_endpgm
L_p2_e1:
    ds_write_b128 v2, v[44:47] offset:0
    ds_write_b128 v2, v[48:51] offset:2048
    ds_write_b128 v2, v[52:55] offset:4096
    ds_write_b128 v2, v[64:67] offset:1024
    ds_write_b128 v2, v[68:71] offset:3072
    ds_write_b128 v2, v[72:75] offset:5120
    s_waitcnt vmcnt(0)
    v_lshlrev_b32 v180, 16, v248
    v_and_b32 v181, s73, v248
    v_lshlrev_b32 v182, 16, v249
    v_and_b32 v183, s73, v249
    v_lshlrev_b32 v188, 16, v250
    v_and_b32 v189, s73, v250
    v_lshlrev_b32 v190, 16, v251
    v_and_b32 v191, s73, v251
    s_waitcnt lgkmcnt(0)
    s_barrier
    ds_read_b128 v[144:147], v3 offset:0
    ds_read_b128 v[148:151], v3 offset:1024
    ds_read_b128 v[152:155], v3 offset:2048
    ds_read_b128 v[156:159], v3 offset:3072
    s_waitcnt lgkmcnt(2)
    v_add_f32 v56, v56, v144
    v_add_f32 v57, v57, v145
    v_add_f32 v58, v58, v146
    v_add_f32 v59, v59, v147
    v_mul_f32 v176, s62, v56
    v_add_f32 v76, v76, v148
    v_mul_f32 v177, s62, v57
    v_add_f32 v77, v77, v149
    v_mul_f32 v178, s62, v58
    v_add_f32 v78, v78, v150
    v_mul_f32 v179, s62, v59
    v_add_f32 v79, v79, v151
    v_exp_f32 v176, v176
    v_mul_f32 v76, v76, v56
    v_exp_f32 v177, v177
    v_mul_f32 v77, v77, v57
    v_exp_f32 v178, v178
    v_mul_f32 v78, v78, v58
    v_exp_f32 v179, v179
    v_mul_f32 v79, v79, v59
    v_add_f32 v176, 1.0, v176
    v_add_f32 v177, 1.0, v177
    v_add_f32 v178, 1.0, v178
    v_add_f32 v179, 1.0, v179
    v_rcp_f32 v176, v176
    v_rcp_f32 v177, v177
    v_rcp_f32 v178, v178
    v_rcp_f32 v179, v179
    v_fma_f32 v176, v176, v76, v180
    v_fma_f32 v177, v177, v77, v181
    v_fma_f32 v178, v178, v78, v182
    v_fma_f32 v179, v179, v79, v183
    v_cvt_pk_bf16_f32 v176, v176, v177
    v_cvt_pk_bf16_f32 v177, v178, v179
    buffer_store_dwordx2 v[176:177], v23, s[8:11], 0 offen offset:0
    s_waitcnt lgkmcnt(0)
    v_add_f32 v60, v60, v152
    v_add_f32 v61, v61, v153
    v_add_f32 v62, v62, v154
    v_add_f32 v63, v63, v155
    v_mul_f32 v184, s62, v60
    v_add_f32 v80, v80, v156
    v_mul_f32 v185, s62, v61
    v_add_f32 v81, v81, v157
    v_mul_f32 v186, s62, v62
    v_add_f32 v82, v82, v158
    v_mul_f32 v187, s62, v63
    v_add_f32 v83, v83, v159
    v_exp_f32 v184, v184
    v_mul_f32 v80, v80, v60
    v_exp_f32 v185, v185
    v_mul_f32 v81, v81, v61
    v_exp_f32 v186, v186
    v_mul_f32 v82, v82, v62
    v_exp_f32 v187, v187
    v_mul_f32 v83, v83, v63
    v_add_f32 v184, 1.0, v184
    v_add_f32 v185, 1.0, v185
    v_add_f32 v186, 1.0, v186
    v_add_f32 v187, 1.0, v187
    v_rcp_f32 v184, v184
    v_rcp_f32 v185, v185
    v_rcp_f32 v186, v186
    v_rcp_f32 v187, v187
    v_fma_f32 v184, v184, v80, v188
    v_fma_f32 v185, v185, v81, v189
    v_fma_f32 v186, v186, v82, v190
    v_fma_f32 v187, v187, v83, v191
    v_cvt_pk_bf16_f32 v184, v184, v185
    v_cvt_pk_bf16_f32 v185, v186, v187
    buffer_store_dwordx2 v[184:185], v23, s[8:11], 0 offen offset:32
    s_endpgm
L_code_end:
.section .rodata,"a"
.p2align 6
.amdhsa_kernel recurrent_scan__linear_attn_block__glu_gated_reglu__prompt_kernel
  .amdhsa_next_free_vgpr 256
  .amdhsa_next_free_sgpr 102
  .amdhsa_accum_offset 256
  .amdhsa_group_segment_fixed_size 0
  .amdhsa_kernarg_size 80
  .amdhsa_user_sgpr_count 2
  .amdhsa_user_sgpr_kernarg_segment_ptr 1
  .amdhsa_system_sgpr_workgroup_id_x 1
.end_amdhsa_kernel
```
